```python
import torch

def _softmax(x, axis=-1):
    return torch.softmax(x, dim=axis)
def _gelu(x):
    return torch.nn.functional.gelu(x, approximate="tanh")
def _silu(x):
    return torch.nn.functional.silu(x)
def _sigmoid(x):
    return torch.sigmoid(x)
def _layernorm(x, axis=-1, eps=1e-5):
    m = x.mean(dim=axis, keepdim=True)
    v = x.var(dim=axis, keepdim=True, unbiased=False)
    return (x - m) / torch.sqrt(v + eps)
def _scatter_add(tgt, idx, src, axis=0):
    return tgt.clone().index_add_(axis, idx, src)
def _segment_sum(src, seg, n):
    out = torch.zeros((n,) + src.shape[1:], dtype=src.dtype)
    return out.index_add_(0, seg, src)
def _pad(x, pw):
    flat = tuple(v for pair in reversed(pw) for v in pair)
    return torch.nn.functional.pad(x, flat)

kernel_name = 'sequential_preLN__sliding_block__mixer_token_mlp__prompt'

def setup_inputs():

    _w = (lambda a: (lambda t: t.to(torch.bfloat16) if t.is_floating_point() else t)(torch.as_tensor(a)))
    def _A_setup():
        B, S, D = 1, 2048, 576
        return {
            "x": _w((lambda *s: torch.randn(*s, dtype=torch.bfloat16) * 0.05)(B, S, D)),
            "wqkv": _w((lambda *s: torch.randn(*s, dtype=torch.bfloat16) * 0.05)(D, 3 * D)),
            "wo": _w((lambda *s: torch.randn(*s, dtype=torch.bfloat16) * 0.05)(D, D)),
        }
    _A_in = _A_setup()

    def _B_setup():
        B, S, D, F = 1, 2048, 576, 4608
        return {
            "x": _w((lambda *s: torch.randn(*s, dtype=torch.bfloat16) * 0.05)(B, S, D)),
            "w1": _w((lambda *s: torch.randn(*s, dtype=torch.bfloat16) * 0.8)(S, F) * (S ** -0.5)),
            "b1": _w((lambda *s: torch.randn(*s, dtype=torch.bfloat16) * 0.8)(F) * 0.02),
            "w2": _w((lambda *s: torch.randn(*s, dtype=torch.bfloat16) * 0.8)(F, S) * (F ** -0.5)),
            "b2": _w((lambda *s: torch.randn(*s, dtype=torch.bfloat16) * 0.8)(S) * 0.02),
        }
    _B_in = _B_setup()

    return {
        "A_x": _A_in["x"],
        "A_wqkv": _A_in["wqkv"],
        "A_wo": _A_in["wo"],
        "B_x": _B_in["x"],
        "B_w1": _B_in["w1"],
        "B_b1": _B_in["b1"],
        "B_w2": _B_in["w2"],
        "B_b2": _B_in["b2"],
    }

def reference(A_x, A_wqkv, A_wo, B_x, B_w1, B_b1, B_w2, B_b2):
    def _A_ref(x, wqkv, wo):
        B, S, D = x.shape
        H = 32; Dh = D // H; W = 256
        qkv = (lambda x, *d: x.permute(*d))((x @ wqkv).reshape(B, S, 3, H, Dh), 2, 0, 3, 1, 4)
        q, k, v = qkv[0], qkv[1], qkv[2]
        scores = torch.einsum("bhqd,bhkd->bhqk", q, k) * (Dh ** -0.5)
        idx = torch.arange(S)
        mask = (idx[:, None] - idx[None, :] >= 0) & (idx[:, None] - idx[None, :] < W)
        scores = torch.where(mask[None, None], scores, -1e9)
        p = _softmax(scores, axis=-1)
        o = torch.einsum("bhqk,bhkd->bhqd", p, v)
        return (lambda x, *d: x.permute(*d))(o, 0, 2, 1, 3).reshape(B, S, D) @ wo

    def _B_ref(x, w1, b1, w2, b2):
        B, S, D = x.shape
        h = _layernorm(x, axis=-1)
        u = torch.einsum("bsd,sf->bdf", h, w1) + b1
        u = _gelu(u)
        y = torch.einsum("bdf,fs->bds", u, w2) + b2
        return (lambda x, *d: x.permute(*d))(y, 0, 2, 1)

    x = A_x
    h = x + _A_ref(_layernorm(x, axis=-1), A_wqkv, A_wo)
    h2 = h + _B_ref(_layernorm(h, axis=-1), B_w1, B_b1, B_w2, B_b2)
    return h2
```

```asm
; @launch grid=(256,1,1) block=(512,1,1) lds=160832
.amdgcn_target "amdgcn-amd-amdhsa--gfx950"
.text
L_text_begin:
.globl sequential_preLN__sliding_block__mixer_token_mlp__prompt_kernel
.p2align 8
.type sequential_preLN__sliding_block__mixer_token_mlp__prompt_kernel,@function
sequential_preLN__sliding_block__mixer_token_mlp__prompt_kernel:
    s_cmp_ge_u32 s2, 256
    s_cbranch_scc1 END_m_1
    s_load_dwordx16 s[64:79], s[0:1], 0
    s_load_dwordx4 s[80:83], s[0:1], 64
    s_load_dwordx2 s[84:85], s[0:1], 80
    s_and_b32 s10, s2, 7
    s_lshr_b32 s11, s2, 3
    s_cmp_lt_u32 s2, 192
    s_cbranch_scc1 SKC_m_3
    s_getpc_b64 s[60:61]
PC_m_2:
    s_sub_u32 s60, s60, PC_m_2-L_text_begin
    s_subb_u32 s61, s61, 0
    s_sub_u32 s62, s11, 24
    s_lshl_b32 s62, s62, 7
    v_lshlrev_b32 v5, 10, v0
    v_add_u32 v5, s62, v5
    s_mov_b32 s62, L_text_end-L_text_begin
    v_cmp_gt_u32 vcc, s62, v5
    s_nop 0
    s_and_saveexec_b64 s[62:63], vcc
    s_cbranch_execz SKC_m_3
    global_load_dword v234, v5, s[60:61]
SKC_m_3:
    s_mov_b64 exec, -1
    v_and_b32 v1, 63, v0
    v_lshrrev_b32 v2, 6, v0
    s_nop 0
    v_readfirstlane_b32 s28, v2
    s_and_b32 s24, s10, 3
    s_lshl_b32 s24, s24, 2
    s_and_b32 s25, s11, 3
    s_add_u32 s24, s24, s25
    s_lshr_b32 s25, s10, 2
    s_mul_i32 s25, s25, 6
    s_lshr_b32 s29, s11, 2
    s_add_u32 s25, s25, s29
    v_lshrrev_b32 v3, 4, v1
    v_and_b32 v4, 15, v1
    s_cmp_ge_u32 s11, 24
    s_cbranch_scc1 P1PF_m_10
    s_cmp_lt_u32 s28, 4
    s_cbranch_scc1 P1CONS_m_12
P1PROD_m_9:
    s_and_b32 s38, s11, 3
    s_lshl_b32 s38, s38, 1
    s_lshr_b32 s39, s11, 2
    s_mul_i32 s39, s39, 43
    s_lshr_b32 s39, s39, 5
    s_add_u32 s38, s38, s39
    s_and_b32 s38, s38, 7
    s_and_b32 s29, s28, 1
    s_cmp_ge_u32 s28, 6
    s_cbranch_scc1 P1PX_m_11
    s_mov_b32 s30, 3168
    v_add_u32 v5, 0, v1
    v_mul_u32_u24 v6, 3641, v5
    v_lshrrev_b32 v6, 16, v6
    v_lshlrev_b32 v5, 4, v5
    v_mad_u32_u24 v10, v6, s30, v5
    v_add_u32 v5, 64, v1
    v_mul_u32_u24 v6, 3641, v5
    v_lshrrev_b32 v6, 16, v6
    v_lshlrev_b32 v5, 4, v5
    v_mad_u32_u24 v11, v6, s30, v5
    v_add_u32 v5, 128, v1
    v_mul_u32_u24 v6, 3641, v5
    v_lshrrev_b32 v6, 16, v6
    v_lshlrev_b32 v5, 4, v5
    v_mad_u32_u24 v12, v6, s30, v5
    v_add_u32 v5, 192, v1
    v_mul_u32_u24 v6, 3641, v5
    v_lshrrev_b32 v6, 16, v6
    v_lshlrev_b32 v5, 4, v5
    v_mad_u32_u24 v13, v6, s30, v5
    v_add_u32 v5, 256, v1
    v_mul_u32_u24 v6, 3641, v5
    v_lshrrev_b32 v6, 16, v6
    v_lshlrev_b32 v5, 4, v5
    v_mad_u32_u24 v14, v6, s30, v5
    v_add_u32 v5, 320, v1
    v_mul_u32_u24 v6, 3641, v5
    v_lshrrev_b32 v6, 16, v6
    v_lshlrev_b32 v5, 4, v5
    v_mad_u32_u24 v15, v6, s30, v5
    v_add_u32 v5, 384, v1
    v_mul_u32_u24 v6, 3641, v5
    v_lshrrev_b32 v6, 16, v6
    v_lshlrev_b32 v5, 4, v5
    v_mad_u32_u24 v16, v6, s30, v5
    v_add_u32 v5, 448, v1
    v_mul_u32_u24 v6, 3641, v5
    v_lshrrev_b32 v6, 16, v6
    v_lshlrev_b32 v5, 4, v5
    v_mad_u32_u24 v17, v6, s30, v5
    v_add_u32 v5, 512, v1
    v_mul_u32_u24 v6, 3641, v5
    v_lshrrev_b32 v6, 16, v6
    v_lshlrev_b32 v5, 4, v5
    v_mad_u32_u24 v18, v6, s30, v5
    s_mul_i32 s33, s25, 288
    s_mul_i32 s30, s29, 110592
    s_add_u32 s33, s33, s30
    s_mul_i32 s34, s29, 9216
    s_waitcnt lgkmcnt(0)
    s_mov_b32 s16, s66
    s_and_b32 s17, s67, 0xffff
    s_mov_b32 s18, 1990656
    s_mov_b32 s19, 0x20000
    s_add_u32 m0, s34, 0
    s_nop 0
    buffer_load_dwordx4 v10, s[16:19], s33 offen lds
    s_add_u32 m0, s34, 1024
    s_nop 0
    buffer_load_dwordx4 v11, s[16:19], s33 offen lds
    s_add_u32 m0, s34, 2048
    s_nop 0
    buffer_load_dwordx4 v12, s[16:19], s33 offen lds
    s_add_u32 m0, s34, 3072
    s_nop 0
    buffer_load_dwordx4 v13, s[16:19], s33 offen lds
    s_add_u32 m0, s34, 4096
    s_nop 0
    buffer_load_dwordx4 v14, s[16:19], s33 offen lds
    s_add_u32 m0, s34, 5120
    s_nop 0
    buffer_load_dwordx4 v15, s[16:19], s33 offen lds
    s_add_u32 m0, s34, 6144
    s_nop 0
    buffer_load_dwordx4 v16, s[16:19], s33 offen lds
    s_add_u32 m0, s34, 7168
    s_nop 0
    buffer_load_dwordx4 v17, s[16:19], s33 offen lds
    s_add_u32 m0, s34, 8192
    s_nop 0
    buffer_load_dwordx4 v18, s[16:19], s33 offen lds
    s_add_u32 s38, s38, 1
    s_mul_i32 s39, s38, 221184
    s_add_u32 s33, s33, s39
    s_add_u32 m0, s34, 34816
    s_nop 0
    buffer_load_dwordx4 v10, s[16:19], s33 offen lds
    s_add_u32 m0, s34, 35840
    s_nop 0
    buffer_load_dwordx4 v11, s[16:19], s33 offen lds
    s_add_u32 m0, s34, 36864
    s_nop 0
    buffer_load_dwordx4 v12, s[16:19], s33 offen lds
    s_add_u32 m0, s34, 37888
    s_nop 0
    buffer_load_dwordx4 v13, s[16:19], s33 offen lds
    s_add_u32 m0, s34, 38912
    s_nop 0
    buffer_load_dwordx4 v14, s[16:19], s33 offen lds
    s_add_u32 m0, s34, 39936
    s_nop 0
    buffer_load_dwordx4 v15, s[16:19], s33 offen lds
    s_add_u32 m0, s34, 40960
    s_nop 0
    buffer_load_dwordx4 v16, s[16:19], s33 offen lds
    s_add_u32 m0, s34, 41984
    s_nop 0
    buffer_load_dwordx4 v17, s[16:19], s33 offen lds
    s_add_u32 m0, s34, 43008
    s_nop 0
    buffer_load_dwordx4 v18, s[16:19], s33 offen lds
    s_add_u32 s33, s33, 221184
    s_sub_u32 s39, s33, 1769472
    s_add_u32 s38, s38, 1
    s_cmp_eq_u32 s38, 9
    s_cselect_b32 s33, s39, s33
    s_waitcnt vmcnt(9)
    s_barrier
    s_add_u32 m0, s34, 69632
    s_nop 0
    buffer_load_dwordx4 v10, s[16:19], s33 offen lds
    s_add_u32 m0, s34, 70656
    s_nop 0
    buffer_load_dwordx4 v11, s[16:19], s33 offen lds
    s_add_u32 m0, s34, 71680
    s_nop 0
    buffer_load_dwordx4 v12, s[16:19], s33 offen lds
    s_add_u32 m0, s34, 72704
    s_nop 0
    buffer_load_dwordx4 v13, s[16:19], s33 offen lds
    s_add_u32 m0, s34, 73728
    s_nop 0
    buffer_load_dwordx4 v14, s[16:19], s33 offen lds
    s_add_u32 m0, s34, 74752
    s_nop 0
    buffer_load_dwordx4 v15, s[16:19], s33 offen lds
    s_add_u32 m0, s34, 75776
    s_nop 0
    buffer_load_dwordx4 v16, s[16:19], s33 offen lds
    s_add_u32 m0, s34, 76800
    s_nop 0
    buffer_load_dwordx4 v17, s[16:19], s33 offen lds
    s_add_u32 m0, s34, 77824
    s_nop 0
    buffer_load_dwordx4 v18, s[16:19], s33 offen lds
    s_add_u32 s33, s33, 221184
    s_sub_u32 s39, s33, 1769472
    s_add_u32 s38, s38, 1
    s_cmp_eq_u32 s38, 9
    s_cselect_b32 s33, s39, s33
    s_add_u32 m0, s34, 104448
    s_nop 0
    buffer_load_dwordx4 v10, s[16:19], s33 offen lds
    s_add_u32 m0, s34, 105472
    s_nop 0
    buffer_load_dwordx4 v11, s[16:19], s33 offen lds
    s_add_u32 m0, s34, 106496
    s_nop 0
    buffer_load_dwordx4 v12, s[16:19], s33 offen lds
    s_add_u32 m0, s34, 107520
    s_nop 0
    buffer_load_dwordx4 v13, s[16:19], s33 offen lds
    s_add_u32 m0, s34, 108544
    s_nop 0
    buffer_load_dwordx4 v14, s[16:19], s33 offen lds
    s_add_u32 m0, s34, 109568
    s_nop 0
    buffer_load_dwordx4 v15, s[16:19], s33 offen lds
    s_add_u32 m0, s34, 110592
    s_nop 0
    buffer_load_dwordx4 v16, s[16:19], s33 offen lds
    s_add_u32 m0, s34, 111616
    s_nop 0
    buffer_load_dwordx4 v17, s[16:19], s33 offen lds
    s_add_u32 m0, s34, 112640
    s_nop 0
    buffer_load_dwordx4 v18, s[16:19], s33 offen lds
    s_add_u32 s33, s33, 221184
    s_sub_u32 s39, s33, 1769472
    s_add_u32 s38, s38, 1
    s_cmp_eq_u32 s38, 9
    s_cselect_b32 s33, s39, s33
    s_waitcnt vmcnt(18)
    s_barrier
    s_waitcnt vmcnt(9)
    s_barrier
    s_add_u32 m0, s34, 0
    s_nop 0
    buffer_load_dwordx4 v10, s[16:19], s33 offen lds
    s_add_u32 m0, s34, 1024
    s_nop 0
    buffer_load_dwordx4 v11, s[16:19], s33 offen lds
    s_add_u32 m0, s34, 2048
    s_nop 0
    buffer_load_dwordx4 v12, s[16:19], s33 offen lds
    s_add_u32 m0, s34, 3072
    s_nop 0
    buffer_load_dwordx4 v13, s[16:19], s33 offen lds
    s_add_u32 m0, s34, 4096
    s_nop 0
    buffer_load_dwordx4 v14, s[16:19], s33 offen lds
    s_add_u32 m0, s34, 5120
    s_nop 0
    buffer_load_dwordx4 v15, s[16:19], s33 offen lds
    s_add_u32 m0, s34, 6144
    s_nop 0
    buffer_load_dwordx4 v16, s[16:19], s33 offen lds
    s_add_u32 m0, s34, 7168
    s_nop 0
    buffer_load_dwordx4 v17, s[16:19], s33 offen lds
    s_add_u32 m0, s34, 8192
    s_nop 0
    buffer_load_dwordx4 v18, s[16:19], s33 offen lds
    s_add_u32 s33, s33, 221184
    s_sub_u32 s39, s33, 1769472
    s_add_u32 s38, s38, 1
    s_cmp_eq_u32 s38, 9
    s_cselect_b32 s33, s39, s33
    s_waitcnt vmcnt(9)
    s_barrier
    s_add_u32 m0, s34, 34816
    s_nop 0
    buffer_load_dwordx4 v10, s[16:19], s33 offen lds
    s_add_u32 m0, s34, 35840
    s_nop 0
    buffer_load_dwordx4 v11, s[16:19], s33 offen lds
    s_add_u32 m0, s34, 36864
    s_nop 0
    buffer_load_dwordx4 v12, s[16:19], s33 offen lds
    s_add_u32 m0, s34, 37888
    s_nop 0
    buffer_load_dwordx4 v13, s[16:19], s33 offen lds
    s_add_u32 m0, s34, 38912
    s_nop 0
    buffer_load_dwordx4 v14, s[16:19], s33 offen lds
    s_add_u32 m0, s34, 39936
    s_nop 0
    buffer_load_dwordx4 v15, s[16:19], s33 offen lds
    s_add_u32 m0, s34, 40960
    s_nop 0
    buffer_load_dwordx4 v16, s[16:19], s33 offen lds
    s_add_u32 m0, s34, 41984
    s_nop 0
    buffer_load_dwordx4 v17, s[16:19], s33 offen lds
    s_add_u32 m0, s34, 43008
    s_nop 0
    buffer_load_dwordx4 v18, s[16:19], s33 offen lds
    s_add_u32 s33, s33, 221184
    s_sub_u32 s39, s33, 1769472
    s_add_u32 s38, s38, 1
    s_cmp_eq_u32 s38, 9
    s_cselect_b32 s33, s39, s33
    s_waitcnt vmcnt(9)
    s_barrier
    s_add_u32 m0, s34, 69632
    s_nop 0
    buffer_load_dwordx4 v10, s[16:19], s33 offen lds
    s_add_u32 m0, s34, 70656
    s_nop 0
    buffer_load_dwordx4 v11, s[16:19], s33 offen lds
    s_add_u32 m0, s34, 71680
    s_nop 0
    buffer_load_dwordx4 v12, s[16:19], s33 offen lds
    s_add_u32 m0, s34, 72704
    s_nop 0
    buffer_load_dwordx4 v13, s[16:19], s33 offen lds
    s_add_u32 m0, s34, 73728
    s_nop 0
    buffer_load_dwordx4 v14, s[16:19], s33 offen lds
    s_add_u32 m0, s34, 74752
    s_nop 0
    buffer_load_dwordx4 v15, s[16:19], s33 offen lds
    s_add_u32 m0, s34, 75776
    s_nop 0
    buffer_load_dwordx4 v16, s[16:19], s33 offen lds
    s_add_u32 m0, s34, 76800
    s_nop 0
    buffer_load_dwordx4 v17, s[16:19], s33 offen lds
    s_add_u32 m0, s34, 77824
    s_nop 0
    buffer_load_dwordx4 v18, s[16:19], s33 offen lds
    s_add_u32 s33, s33, 221184
    s_sub_u32 s39, s33, 1769472
    s_add_u32 s38, s38, 1
    s_cmp_eq_u32 s38, 9
    s_cselect_b32 s33, s39, s33
    s_waitcnt vmcnt(9)
    s_barrier
    s_add_u32 m0, s34, 104448
    s_nop 0
    buffer_load_dwordx4 v10, s[16:19], s33 offen lds
    s_add_u32 m0, s34, 105472
    s_nop 0
    buffer_load_dwordx4 v11, s[16:19], s33 offen lds
    s_add_u32 m0, s34, 106496
    s_nop 0
    buffer_load_dwordx4 v12, s[16:19], s33 offen lds
    s_add_u32 m0, s34, 107520
    s_nop 0
    buffer_load_dwordx4 v13, s[16:19], s33 offen lds
    s_add_u32 m0, s34, 108544
    s_nop 0
    buffer_load_dwordx4 v14, s[16:19], s33 offen lds
    s_add_u32 m0, s34, 109568
    s_nop 0
    buffer_load_dwordx4 v15, s[16:19], s33 offen lds
    s_add_u32 m0, s34, 110592
    s_nop 0
    buffer_load_dwordx4 v16, s[16:19], s33 offen lds
    s_add_u32 m0, s34, 111616
    s_nop 0
    buffer_load_dwordx4 v17, s[16:19], s33 offen lds
    s_add_u32 m0, s34, 112640
    s_nop 0
    buffer_load_dwordx4 v18, s[16:19], s33 offen lds
    s_add_u32 s33, s33, 221184
    s_sub_u32 s39, s33, 1769472
    s_add_u32 s38, s38, 1
    s_cmp_eq_u32 s38, 9
    s_cselect_b32 s33, s39, s33
    s_waitcnt vmcnt(9)
    s_barrier
    s_add_u32 m0, s34, 0
    s_nop 0
    buffer_load_dwordx4 v10, s[16:19], s33 offen lds
    s_add_u32 m0, s34, 1024
    s_nop 0
    buffer_load_dwordx4 v11, s[16:19], s33 offen lds
    s_add_u32 m0, s34, 2048
    s_nop 0
    buffer_load_dwordx4 v12, s[16:19], s33 offen lds
    s_add_u32 m0, s34, 3072
    s_nop 0
    buffer_load_dwordx4 v13, s[16:19], s33 offen lds
    s_add_u32 m0, s34, 4096
    s_nop 0
    buffer_load_dwordx4 v14, s[16:19], s33 offen lds
    s_add_u32 m0, s34, 5120
    s_nop 0
    buffer_load_dwordx4 v15, s[16:19], s33 offen lds
    s_add_u32 m0, s34, 6144
    s_nop 0
    buffer_load_dwordx4 v16, s[16:19], s33 offen lds
    s_add_u32 m0, s34, 7168
    s_nop 0
    buffer_load_dwordx4 v17, s[16:19], s33 offen lds
    s_add_u32 m0, s34, 8192
    s_nop 0
    buffer_load_dwordx4 v18, s[16:19], s33 offen lds
    s_add_u32 s33, s33, 221184
    s_sub_u32 s39, s33, 1769472
    s_add_u32 s38, s38, 1
    s_cmp_eq_u32 s38, 9
    s_cselect_b32 s33, s39, s33
    s_waitcnt vmcnt(9)
    s_barrier
    s_waitcnt vmcnt(0)
    v_subrev_u32 v40, 256, v0
    s_barrier
    s_branch P2B_m_5
P1PX_m_11:
    v_lshrrev_b32 v5, 3, v1
    v_add_u32 v5, 0, v5
    v_bfe_u32 v6, v5, 1, 3
    v_and_b32 v7, 7, v1
    v_xor_b32 v6, v6, v7
    v_lshlrev_b32 v6, 4, v6
    v_mul_u32_u24 v5, 1152, v5
    v_add_u32 v10, v5, v6
    v_lshrrev_b32 v5, 3, v1
    v_add_u32 v5, 8, v5
    v_bfe_u32 v6, v5, 1, 3
    v_and_b32 v7, 7, v1
    v_xor_b32 v6, v6, v7
    v_lshlrev_b32 v6, 4, v6
    v_mul_u32_u24 v5, 1152, v5
    v_add_u32 v11, v5, v6
    v_add_u32 v12, 18432, v10
    v_add_u32 v13, 18432, v11
    v_add_u32 v14, 18432, v12
    v_add_u32 v15, 18432, v13
    v_add_u32 v16, 18432, v14
    v_add_u32 v17, 18432, v15
    s_lshl_b32 s32, s24, 7
    s_lshl_b32 s30, s29, 6
    s_add_u32 s32, s32, s30
    s_mul_i32 s32, s32, 1152
    s_lshl_b32 s35, s29, 13
    s_add_u32 s35, s35, 18432
    s_waitcnt lgkmcnt(0)
    s_mov_b32 s12, s64
    s_and_b32 s13, s65, 0xffff
    s_mov_b32 s14, 2359296
    s_mov_b32 s15, 0x20000
    s_add_u32 m0, s35, 0
    s_nop 0
    buffer_load_dwordx4 v10, s[12:15], s32 offen lds
    s_add_u32 m0, s35, 1024
    s_nop 0
    buffer_load_dwordx4 v11, s[12:15], s32 offen lds
    s_add_u32 m0, s35, 2048
    s_nop 0
    buffer_load_dwordx4 v12, s[12:15], s32 offen lds
    s_add_u32 m0, s35, 3072
    s_nop 0
    buffer_load_dwordx4 v13, s[12:15], s32 offen lds
    s_add_u32 m0, s35, 4096
    s_nop 0
    buffer_load_dwordx4 v14, s[12:15], s32 offen lds
    s_add_u32 m0, s35, 5120
    s_nop 0
    buffer_load_dwordx4 v15, s[12:15], s32 offen lds
    s_add_u32 m0, s35, 6144
    s_nop 0
    buffer_load_dwordx4 v16, s[12:15], s32 offen lds
    s_add_u32 m0, s35, 7168
    s_nop 0
    buffer_load_dwordx4 v17, s[12:15], s32 offen lds
    s_add_u32 s38, s38, 1
    s_mul_i32 s39, s38, 128
    s_add_u32 s32, s32, s39
    s_add_u32 m0, s35, 34816
    s_nop 0
    buffer_load_dwordx4 v10, s[12:15], s32 offen lds
    s_add_u32 m0, s35, 35840
    s_nop 0
    buffer_load_dwordx4 v11, s[12:15], s32 offen lds
    s_add_u32 m0, s35, 36864
    s_nop 0
    buffer_load_dwordx4 v12, s[12:15], s32 offen lds
    s_add_u32 m0, s35, 37888
    s_nop 0
    buffer_load_dwordx4 v13, s[12:15], s32 offen lds
    s_add_u32 m0, s35, 38912
    s_nop 0
    buffer_load_dwordx4 v14, s[12:15], s32 offen lds
    s_add_u32 m0, s35, 39936
    s_nop 0
    buffer_load_dwordx4 v15, s[12:15], s32 offen lds
    s_add_u32 m0, s35, 40960
    s_nop 0
    buffer_load_dwordx4 v16, s[12:15], s32 offen lds
    s_add_u32 m0, s35, 41984
    s_nop 0
    buffer_load_dwordx4 v17, s[12:15], s32 offen lds
    s_add_u32 s32, s32, 128
    s_sub_u32 s39, s32, 1024
    s_add_u32 s38, s38, 1
    s_cmp_eq_u32 s38, 9
    s_cselect_b32 s32, s39, s32
    s_waitcnt vmcnt(8)
    s_barrier
    s_add_u32 m0, s35, 69632
    s_nop 0
    buffer_load_dwordx4 v10, s[12:15], s32 offen lds
    s_add_u32 m0, s35, 70656
    s_nop 0
    buffer_load_dwordx4 v11, s[12:15], s32 offen lds
    s_add_u32 m0, s35, 71680
    s_nop 0
    buffer_load_dwordx4 v12, s[12:15], s32 offen lds
    s_add_u32 m0, s35, 72704
    s_nop 0
    buffer_load_dwordx4 v13, s[12:15], s32 offen lds
    s_add_u32 m0, s35, 73728
    s_nop 0
    buffer_load_dwordx4 v14, s[12:15], s32 offen lds
    s_add_u32 m0, s35, 74752
    s_nop 0
    buffer_load_dwordx4 v15, s[12:15], s32 offen lds
    s_add_u32 m0, s35, 75776
    s_nop 0
    buffer_load_dwordx4 v16, s[12:15], s32 offen lds
    s_add_u32 m0, s35, 76800
    s_nop 0
    buffer_load_dwordx4 v17, s[12:15], s32 offen lds
    s_add_u32 s32, s32, 128
    s_sub_u32 s39, s32, 1024
    s_add_u32 s38, s38, 1
    s_cmp_eq_u32 s38, 9
    s_cselect_b32 s32, s39, s32
    s_add_u32 m0, s35, 104448
    s_nop 0
    buffer_load_dwordx4 v10, s[12:15], s32 offen lds
    s_add_u32 m0, s35, 105472
    s_nop 0
    buffer_load_dwordx4 v11, s[12:15], s32 offen lds
    s_add_u32 m0, s35, 106496
    s_nop 0
    buffer_load_dwordx4 v12, s[12:15], s32 offen lds
    s_add_u32 m0, s35, 107520
    s_nop 0
    buffer_load_dwordx4 v13, s[12:15], s32 offen lds
    s_add_u32 m0, s35, 108544
    s_nop 0
    buffer_load_dwordx4 v14, s[12:15], s32 offen lds
    s_add_u32 m0, s35, 109568
    s_nop 0
    buffer_load_dwordx4 v15, s[12:15], s32 offen lds
    s_add_u32 m0, s35, 110592
    s_nop 0
    buffer_load_dwordx4 v16, s[12:15], s32 offen lds
    s_add_u32 m0, s35, 111616
    s_nop 0
    buffer_load_dwordx4 v17, s[12:15], s32 offen lds
    s_add_u32 s32, s32, 128
    s_sub_u32 s39, s32, 1024
    s_add_u32 s38, s38, 1
    s_cmp_eq_u32 s38, 9
    s_cselect_b32 s32, s39, s32
    s_waitcnt vmcnt(16)
    s_barrier
    s_waitcnt vmcnt(8)
    s_barrier
    s_add_u32 m0, s35, 0
    s_nop 0
    buffer_load_dwordx4 v10, s[12:15], s32 offen lds
    s_add_u32 m0, s35, 1024
    s_nop 0
    buffer_load_dwordx4 v11, s[12:15], s32 offen lds
    s_add_u32 m0, s35, 2048
    s_nop 0
    buffer_load_dwordx4 v12, s[12:15], s32 offen lds
    s_add_u32 m0, s35, 3072
    s_nop 0
    buffer_load_dwordx4 v13, s[12:15], s32 offen lds
    s_add_u32 m0, s35, 4096
    s_nop 0
    buffer_load_dwordx4 v14, s[12:15], s32 offen lds
    s_add_u32 m0, s35, 5120
    s_nop 0
    buffer_load_dwordx4 v15, s[12:15], s32 offen lds
    s_add_u32 m0, s35, 6144
    s_nop 0
    buffer_load_dwordx4 v16, s[12:15], s32 offen lds
    s_add_u32 m0, s35, 7168
    s_nop 0
    buffer_load_dwordx4 v17, s[12:15], s32 offen lds
    s_add_u32 s32, s32, 128
    s_sub_u32 s39, s32, 1024
    s_add_u32 s38, s38, 1
    s_cmp_eq_u32 s38, 9
    s_cselect_b32 s32, s39, s32
    s_waitcnt vmcnt(8)
    s_barrier
    s_add_u32 m0, s35, 34816
    s_nop 0
    buffer_load_dwordx4 v10, s[12:15], s32 offen lds
    s_add_u32 m0, s35, 35840
    s_nop 0
    buffer_load_dwordx4 v11, s[12:15], s32 offen lds
    s_add_u32 m0, s35, 36864
    s_nop 0
    buffer_load_dwordx4 v12, s[12:15], s32 offen lds
    s_add_u32 m0, s35, 37888
    s_nop 0
    buffer_load_dwordx4 v13, s[12:15], s32 offen lds
    s_add_u32 m0, s35, 38912
    s_nop 0
    buffer_load_dwordx4 v14, s[12:15], s32 offen lds
    s_add_u32 m0, s35, 39936
    s_nop 0
    buffer_load_dwordx4 v15, s[12:15], s32 offen lds
    s_add_u32 m0, s35, 40960
    s_nop 0
    buffer_load_dwordx4 v16, s[12:15], s32 offen lds
    s_add_u32 m0, s35, 41984
    s_nop 0
    buffer_load_dwordx4 v17, s[12:15], s32 offen lds
    s_add_u32 s32, s32, 128
    s_sub_u32 s39, s32, 1024
    s_add_u32 s38, s38, 1
    s_cmp_eq_u32 s38, 9
    s_cselect_b32 s32, s39, s32
    s_waitcnt vmcnt(8)
    s_barrier
    s_add_u32 m0, s35, 69632
    s_nop 0
    buffer_load_dwordx4 v10, s[12:15], s32 offen lds
    s_add_u32 m0, s35, 70656
    s_nop 0
    buffer_load_dwordx4 v11, s[12:15], s32 offen lds
    s_add_u32 m0, s35, 71680
    s_nop 0
    buffer_load_dwordx4 v12, s[12:15], s32 offen lds
    s_add_u32 m0, s35, 72704
    s_nop 0
    buffer_load_dwordx4 v13, s[12:15], s32 offen lds
    s_add_u32 m0, s35, 73728
    s_nop 0
    buffer_load_dwordx4 v14, s[12:15], s32 offen lds
    s_add_u32 m0, s35, 74752
    s_nop 0
    buffer_load_dwordx4 v15, s[12:15], s32 offen lds
    s_add_u32 m0, s35, 75776
    s_nop 0
    buffer_load_dwordx4 v16, s[12:15], s32 offen lds
    s_add_u32 m0, s35, 76800
    s_nop 0
    buffer_load_dwordx4 v17, s[12:15], s32 offen lds
    s_add_u32 s32, s32, 128
    s_sub_u32 s39, s32, 1024
    s_add_u32 s38, s38, 1
    s_cmp_eq_u32 s38, 9
    s_cselect_b32 s32, s39, s32
    s_waitcnt vmcnt(8)
    s_barrier
    s_add_u32 m0, s35, 104448
    s_nop 0
    buffer_load_dwordx4 v10, s[12:15], s32 offen lds
    s_add_u32 m0, s35, 105472
    s_nop 0
    buffer_load_dwordx4 v11, s[12:15], s32 offen lds
    s_add_u32 m0, s35, 106496
    s_nop 0
    buffer_load_dwordx4 v12, s[12:15], s32 offen lds
    s_add_u32 m0, s35, 107520
    s_nop 0
    buffer_load_dwordx4 v13, s[12:15], s32 offen lds
    s_add_u32 m0, s35, 108544
    s_nop 0
    buffer_load_dwordx4 v14, s[12:15], s32 offen lds
    s_add_u32 m0, s35, 109568
    s_nop 0
    buffer_load_dwordx4 v15, s[12:15], s32 offen lds
    s_add_u32 m0, s35, 110592
    s_nop 0
    buffer_load_dwordx4 v16, s[12:15], s32 offen lds
    s_add_u32 m0, s35, 111616
    s_nop 0
    buffer_load_dwordx4 v17, s[12:15], s32 offen lds
    s_add_u32 s32, s32, 128
    s_sub_u32 s39, s32, 1024
    s_add_u32 s38, s38, 1
    s_cmp_eq_u32 s38, 9
    s_cselect_b32 s32, s39, s32
    s_waitcnt vmcnt(8)
    s_barrier
    s_add_u32 m0, s35, 0
    s_nop 0
    buffer_load_dwordx4 v10, s[12:15], s32 offen lds
    s_add_u32 m0, s35, 1024
    s_nop 0
    buffer_load_dwordx4 v11, s[12:15], s32 offen lds
    s_add_u32 m0, s35, 2048
    s_nop 0
    buffer_load_dwordx4 v12, s[12:15], s32 offen lds
    s_add_u32 m0, s35, 3072
    s_nop 0
    buffer_load_dwordx4 v13, s[12:15], s32 offen lds
    s_add_u32 m0, s35, 4096
    s_nop 0
    buffer_load_dwordx4 v14, s[12:15], s32 offen lds
    s_add_u32 m0, s35, 5120
    s_nop 0
    buffer_load_dwordx4 v15, s[12:15], s32 offen lds
    s_add_u32 m0, s35, 6144
    s_nop 0
    buffer_load_dwordx4 v16, s[12:15], s32 offen lds
    s_add_u32 m0, s35, 7168
    s_nop 0
    buffer_load_dwordx4 v17, s[12:15], s32 offen lds
    s_add_u32 s32, s32, 128
    s_sub_u32 s39, s32, 1024
    s_add_u32 s38, s38, 1
    s_cmp_eq_u32 s38, 9
    s_cselect_b32 s32, s39, s32
    s_waitcnt vmcnt(8)
    s_barrier
    s_waitcnt vmcnt(0)
    v_subrev_u32 v40, 256, v0
    s_barrier
    s_branch P2B_m_5
P1CONS_m_12:
    v_lshlrev_b32 v5, 2, v1
    v_add_u32 v5, 160768, v5
    v_mov_b32 v6, 0
    s_mov_b64 exec, 0xffff
    ds_write_b32 v5, v6
    s_mov_b64 exec, -1
    s_lshr_b32 s26, s25, 2
    s_and_b32 s27, s25, 3
    v_bfe_u32 v5, v1, 2, 2
    v_lshl_add_u32 v5, v3, 2, v5
    v_mul_u32_u24 v5, 288, v5
    v_and_b32 v6, 3, v1
    v_lshl_add_u32 v10, v6, 3, v5
    v_mul_u32_u24 v6, 72, v6
    v_add3_u32 v11, v5, v6, 32
    v_lshrrev_b32 v5, 1, v4
    v_lshrrev_b32 v6, 1, v3
    v_xor_b32 v5, v5, v6
    v_lshlrev_b32 v5, 4, v5
    v_lshl_add_u32 v5, v4, 7, v5
    v_and_b32 v6, 1, v3
    v_lshl_add_u32 v5, v6, 3, v5
    s_lshl_b32 s30, s28, 12
    s_add_u32 s30, s30, 18432
    v_add_u32 v12, s30, v5
    v_xor_b32 v13, 32, v12
    v_xor_b32 v14, 64, v12
    v_xor_b32 v15, 96, v12
    v_mov_b32 v108, 0
    v_mov_b32 v109, 0
    v_mov_b32 v110, 0
    v_mov_b32 v111, 0
    v_mov_b32 v112, 0
    v_mov_b32 v113, 0
    v_mov_b32 v114, 0
    v_mov_b32 v115, 0
    v_mov_b32 v116, 0
    v_mov_b32 v117, 0
    v_mov_b32 v118, 0
    v_mov_b32 v119, 0
    v_mov_b32 v120, 0
    v_mov_b32 v121, 0
    v_mov_b32 v122, 0
    v_mov_b32 v123, 0
    v_mov_b32 v124, 0
    v_mov_b32 v125, 0
    v_mov_b32 v126, 0
    v_mov_b32 v127, 0
    v_mov_b32 v128, 0
    v_mov_b32 v129, 0
    v_mov_b32 v130, 0
    v_mov_b32 v131, 0
    v_mov_b32 v132, 0
    v_mov_b32 v133, 0
    v_mov_b32 v134, 0
    v_mov_b32 v135, 0
    v_mov_b32 v136, 0
    v_mov_b32 v137, 0
    v_mov_b32 v138, 0
    v_mov_b32 v139, 0
    v_mov_b32 v140, 0
    v_mov_b32 v141, 0
    v_mov_b32 v142, 0
    v_mov_b32 v143, 0
    v_mov_b32 v144, 0
    v_mov_b32 v145, 0
    v_mov_b32 v146, 0
    v_mov_b32 v147, 0
    v_mov_b32 v148, 0
    v_mov_b32 v149, 0
    v_mov_b32 v150, 0
    v_mov_b32 v151, 0
    v_mov_b32 v152, 0
    v_mov_b32 v153, 0
    v_mov_b32 v154, 0
    v_mov_b32 v155, 0
    v_mov_b32 v156, 0
    v_mov_b32 v157, 0
    v_mov_b32 v158, 0
    v_mov_b32 v159, 0
    v_mov_b32 v160, 0
    v_mov_b32 v161, 0
    v_mov_b32 v162, 0
    v_mov_b32 v163, 0
    v_mov_b32 v164, 0
    v_mov_b32 v165, 0
    v_mov_b32 v166, 0
    v_mov_b32 v167, 0
    v_mov_b32 v168, 0
    v_mov_b32 v169, 0
    v_mov_b32 v170, 0
    v_mov_b32 v171, 0
    v_mov_b32 v172, 0
    v_mov_b32 v173, 0
    v_mov_b32 v174, 0
    v_mov_b32 v175, 0
    v_mov_b32 v176, 0
    v_mov_b32 v177, 0
    v_mov_b32 v178, 0
    v_mov_b32 v179, 0
    v_mov_b32 v16, 0
    v_mul_u32_u24 v5, 4682, v1
    v_lshrrev_b32 v5, 16, v5
    v_mul_u32_u24 v6, 14, v5
    v_sub_u32 v6, v1, v6
    v_lshrrev_b32 v7, 1, v5
    v_mul_u32_u24 v7, 62, v7
    v_add_u32 v5, v5, v7
    v_mul_u32_u24 v5, 3456, v5
    v_lshl_add_u32 v5, v6, 7, v5
    v_lshlrev_b32 v6, 7, v1
    s_add_u32 s30, s28, 1
    s_mul_i32 s30, s30, 442368
    s_mul_i32 s31, s11, 6912
    s_add_u32 s30, s30, s31
    s_lshr_b32 s31, s10, 2
    s_mul_i32 s31, s31, 1664
    s_add_u32 s30, s30, s31
    s_and_b32 s31, s10, 3
    s_mul_i32 s31, s31, 589824
    s_mul_i32 s29, s11, 18432
    s_add_u32 s31, s31, s29
    s_mul_i32 s29, s28, 4608
    s_add_u32 s31, s31, s29
    s_waitcnt lgkmcnt(0)
    s_mov_b32 s12, s64
    s_and_b32 s13, s65, 0xffff
    s_mov_b32 s14, 2359296
    s_mov_b32 s15, 0x20000
    s_mov_b32 s16, s66
    s_and_b32 s17, s67, 0xffff
    s_mov_b32 s18, 1990656
    s_mov_b32 s19, 0x20000
    s_mov_b32 s20, s84
    s_and_b32 s21, s85, 0xffff
    s_mov_b32 s22, 54525952
    s_mov_b32 s23, 0x20000
    s_mov_b32 s56, s82
    s_and_b32 s57, s83, 0xffff
    s_mov_b32 s58, 256
    s_mov_b32 s59, 0x20000
    s_mul_i32 s50, s25, 599040
    s_lshl_b32 s30, s24, 2
    s_add_u32 s30, s30, s28
    s_lshl_b32 s49, s30, 7
    s_lshl_b32 s30, s30, 10
    s_add_u32 s50, s50, s30
    s_add_u32 s49, s49, 23068672
    s_mul_i32 s51, s25, 576
    s_add_u32 s51, s51, 23085056
    s_lshl_b32 s48, s27, 4
    s_add_u32 s48, s48, s24
    s_lshl_b32 s48, s48, 2
    s_add_u32 s48, s48, s26
    s_lshl_b32 s48, s48, 7
    s_add_u32 s48, s48, 21168128
    s_cmp_eq_u32 s26, 2
    s_cbranch_scc1 VOR_m_13
    s_barrier
    ds_read_b64 v[20:21], v12 offset:0
    ds_read_b64 v[22:23], v13 offset:0
    ds_read_b64 v[24:25], v12 offset:2048
    ds_read_b64 v[26:27], v13 offset:2048
    ds_read_b64_tr_b16 v[36:37], v10 offset:0
    ds_read_b64_tr_b16 v[38:39], v10 offset:4608
    ds_read_b64_tr_b16 v[40:41], v10 offset:40
    ds_read_b64_tr_b16 v[42:43], v10 offset:4648
    ds_read_b64_tr_b16 v[44:45], v10 offset:72
    ds_read_b64_tr_b16 v[46:47], v10 offset:4680
    ds_read_b64_tr_b16 v[48:49], v10 offset:112
    ds_read_b64_tr_b16 v[50:51], v10 offset:4720
    ds_read_b64_tr_b16 v[52:53], v10 offset:144
    ds_read_b64_tr_b16 v[54:55], v10 offset:4752
    ds_read_b64_tr_b16 v[56:57], v10 offset:184
    ds_read_b64_tr_b16 v[58:59], v10 offset:4792
    ds_read_b64_tr_b16 v[60:61], v10 offset:216
    ds_read_b64_tr_b16 v[62:63], v10 offset:4824
    ds_read_b64_tr_b16 v[64:65], v10 offset:256
    ds_read_b64_tr_b16 v[66:67], v10 offset:4864
    ds_read_b64_tr_b16 v[68:69], v11 offset:0
    ds_read_b64_tr_b16 v[70:71], v11 offset:4608
    s_mov_b32 s36, 2
CL_m_14:
    s_waitcnt lgkmcnt(12)
    v_mfma_f32_16x16x32_bf16 v[108:111], v[36:39], v[20:23], v[108:111]
    ds_read_b64 v[28:29], v14 offset:0
    ds_read_b64 v[30:31], v15 offset:0
    v_mfma_f32_16x16x32_bf16 v[112:115], v[36:39], v[24:27], v[112:115]
    ds_read_b64 v[32:33], v14 offset:2048
    ds_read_b64 v[34:35], v15 offset:2048
    v_mfma_f32_16x16x32_bf16 v[116:119], v[40:43], v[20:23], v[116:119]
    ds_read_b64_tr_b16 v[72:73], v10 offset:9216
    ds_read_b64_tr_b16 v[74:75], v10 offset:13824
    v_mfma_f32_16x16x32_bf16 v[120:123], v[40:43], v[24:27], v[120:123]
    ds_read_b64_tr_b16 v[76:77], v10 offset:9256
    ds_read_b64_tr_b16 v[78:79], v10 offset:13864
    v_mfma_f32_16x16x32_bf16 v[124:127], v[44:47], v[20:23], v[124:127]
    ds_read_b64_tr_b16 v[80:81], v10 offset:9288
    ds_read_b64_tr_b16 v[82:83], v10 offset:13896
    v_mfma_f32_16x16x32_bf16 v[128:131], v[44:47], v[24:27], v[128:131]
    s_waitcnt lgkmcnt(15)
    v_mfma_f32_16x16x32_bf16 v[132:135], v[48:51], v[20:23], v[132:135]
    ds_read_b64_tr_b16 v[84:85], v10 offset:9328
    ds_read_b64_tr_b16 v[86:87], v10 offset:13936
    v_mfma_f32_16x16x32_bf16 v[136:139], v[48:51], v[24:27], v[136:139]
    ds_read_b64_tr_b16 v[88:89], v10 offset:9360
    ds_read_b64_tr_b16 v[90:91], v10 offset:13968
    v_mfma_f32_16x16x32_bf16 v[140:143], v[52:55], v[20:23], v[140:143]
    ds_read_b64_tr_b16 v[92:93], v10 offset:9400
    v_mfma_f32_16x16x32_bf16 v[144:147], v[52:55], v[24:27], v[144:147]
    ds_read_b64_tr_b16 v[94:95], v10 offset:14008
    v_mfma_f32_16x16x32_bf16 v[148:151], v[56:59], v[20:23], v[148:151]
    ds_read_b64_tr_b16 v[96:97], v10 offset:9432
    v_mfma_f32_16x16x32_bf16 v[152:155], v[56:59], v[24:27], v[152:155]
    s_waitcnt lgkmcnt(15)
    v_mfma_f32_16x16x32_bf16 v[156:159], v[60:63], v[20:23], v[156:159]
    ds_read_b64_tr_b16 v[98:99], v10 offset:14040
    v_mfma_f32_16x16x32_bf16 v[160:163], v[60:63], v[24:27], v[160:163]
    ds_read_b64_tr_b16 v[100:101], v10 offset:9472
    v_mfma_f32_16x16x32_bf16 v[164:167], v[64:67], v[20:23], v[164:167]
    ds_read_b64_tr_b16 v[102:103], v10 offset:14080
    v_mfma_f32_16x16x32_bf16 v[168:171], v[64:67], v[24:27], v[168:171]
    ds_read_b64_tr_b16 v[104:105], v11 offset:9216
    v_mfma_f32_16x16x32_bf16 v[172:175], v[68:71], v[20:23], v[172:175]
    ds_read_b64_tr_b16 v[106:107], v11 offset:13824
    v_mfma_f32_16x16x32_bf16 v[176:179], v[68:71], v[24:27], v[176:179]
    s_barrier
    s_waitcnt lgkmcnt(12)
    v_mfma_f32_16x16x32_bf16 v[108:111], v[72:75], v[28:31], v[108:111]
    v_add_u32 v12, 34816, v12
    v_add_u32 v13, 34816, v13
    v_mfma_f32_16x16x32_bf16 v[112:115], v[72:75], v[32:35], v[112:115]
    v_add_u32 v14, 34816, v14
    v_add_u32 v15, 34816, v15
    v_mfma_f32_16x16x32_bf16 v[116:119], v[76:79], v[28:31], v[116:119]
    v_add_u32 v10, 34816, v10
    v_add_u32 v11, 34816, v11
    v_mfma_f32_16x16x32_bf16 v[120:123], v[76:79], v[32:35], v[120:123]
    ds_read_b64 v[20:21], v12 offset:0
    ds_read_b64 v[22:23], v13 offset:0
    v_mfma_f32_16x16x32_bf16 v[124:127], v[80:83], v[28:31], v[124:127]
    ds_read_b64 v[24:25], v12 offset:2048
    ds_read_b64 v[26:27], v13 offset:2048
    v_mfma_f32_16x16x32_bf16 v[128:131], v[80:83], v[32:35], v[128:131]
    s_waitcnt lgkmcnt(10)
    v_mfma_f32_16x16x32_bf16 v[132:135], v[84:87], v[28:31], v[132:135]
    ds_read_b64_tr_b16 v[36:37], v10 offset:0
    ds_read_b64_tr_b16 v[38:39], v10 offset:4608
    v_mfma_f32_16x16x32_bf16 v[136:139], v[84:87], v[32:35], v[136:139]
    ds_read_b64_tr_b16 v[40:41], v10 offset:40
    ds_read_b64_tr_b16 v[42:43], v10 offset:4648
    v_mfma_f32_16x16x32_bf16 v[140:143], v[88:91], v[28:31], v[140:143]
    ds_read_b64_tr_b16 v[44:45], v10 offset:72
    ds_read_b64_tr_b16 v[46:47], v10 offset:4680
    v_mfma_f32_16x16x32_bf16 v[144:147], v[88:91], v[32:35], v[144:147]
    ds_read_b64_tr_b16 v[48:49], v10 offset:112
    ds_read_b64_tr_b16 v[50:51], v10 offset:4720
    v_mfma_f32_16x16x32_bf16 v[148:151], v[92:95], v[28:31], v[148:151]
    ds_read_b64_tr_b16 v[52:53], v10 offset:144
    ds_read_b64_tr_b16 v[54:55], v10 offset:4752
    v_mfma_f32_16x16x32_bf16 v[152:155], v[92:95], v[32:35], v[152:155]
    s_waitcnt lgkmcnt(14)
    v_mfma_f32_16x16x32_bf16 v[156:159], v[96:99], v[28:31], v[156:159]
    ds_read_b64_tr_b16 v[56:57], v10 offset:184
    ds_read_b64_tr_b16 v[58:59], v10 offset:4792
    v_mfma_f32_16x16x32_bf16 v[160:163], v[96:99], v[32:35], v[160:163]
    ds_read_b64_tr_b16 v[60:61], v10 offset:216
    ds_read_b64_tr_b16 v[62:63], v10 offset:4824
    v_mfma_f32_16x16x32_bf16 v[164:167], v[100:103], v[28:31], v[164:167]
    ds_read_b64_tr_b16 v[64:65], v10 offset:256
    ds_read_b64_tr_b16 v[66:67], v10 offset:4864
    v_mfma_f32_16x16x32_bf16 v[168:171], v[100:103], v[32:35], v[168:171]
    ds_read_b64_tr_b16 v[68:69], v11 offset:0
    v_mfma_f32_16x16x32_bf16 v[172:175], v[104:107], v[28:31], v[172:175]
    ds_read_b64_tr_b16 v[70:71], v11 offset:4608
    v_mfma_f32_16x16x32_bf16 v[176:179], v[104:107], v[32:35], v[176:179]
    s_waitcnt lgkmcnt(12)
    v_mfma_f32_16x16x32_bf16 v[108:111], v[36:39], v[20:23], v[108:111]
    ds_read_b64 v[28:29], v14 offset:0
    ds_read_b64 v[30:31], v15 offset:0
    v_mfma_f32_16x16x32_bf16 v[112:115], v[36:39], v[24:27], v[112:115]
    ds_read_b64 v[32:33], v14 offset:2048
    ds_read_b64 v[34:35], v15 offset:2048
    v_mfma_f32_16x16x32_bf16 v[116:119], v[40:43], v[20:23], v[116:119]
    ds_read_b64_tr_b16 v[72:73], v10 offset:9216
    ds_read_b64_tr_b16 v[74:75], v10 offset:13824
    v_mfma_f32_16x16x32_bf16 v[120:123], v[40:43], v[24:27], v[120:123]
    ds_read_b64_tr_b16 v[76:77], v10 offset:9256
    ds_read_b64_tr_b16 v[78:79], v10 offset:13864
    v_mfma_f32_16x16x32_bf16 v[124:127], v[44:47], v[20:23], v[124:127]
    ds_read_b64_tr_b16 v[80:81], v10 offset:9288
    ds_read_b64_tr_b16 v[82:83], v10 offset:13896
    v_mfma_f32_16x16x32_bf16 v[128:131], v[44:47], v[24:27], v[128:131]
    s_waitcnt lgkmcnt(15)
    v_mfma_f32_16x16x32_bf16 v[132:135], v[48:51], v[20:23], v[132:135]
    ds_read_b64_tr_b16 v[84:85], v10 offset:9328
    ds_read_b64_tr_b16 v[86:87], v10 offset:13936
    v_mfma_f32_16x16x32_bf16 v[136:139], v[48:51], v[24:27], v[136:139]
    ds_read_b64_tr_b16 v[88:89], v10 offset:9360
    ds_read_b64_tr_b16 v[90:91], v10 offset:13968
    v_mfma_f32_16x16x32_bf16 v[140:143], v[52:55], v[20:23], v[140:143]
    ds_read_b64_tr_b16 v[92:93], v10 offset:9400
    v_mfma_f32_16x16x32_bf16 v[144:147], v[52:55], v[24:27], v[144:147]
    ds_read_b64_tr_b16 v[94:95], v10 offset:14008
    v_mfma_f32_16x16x32_bf16 v[148:151], v[56:59], v[20:23], v[148:151]
    ds_read_b64_tr_b16 v[96:97], v10 offset:9432
    v_mfma_f32_16x16x32_bf16 v[152:155], v[56:59], v[24:27], v[152:155]
    s_waitcnt lgkmcnt(15)
    v_mfma_f32_16x16x32_bf16 v[156:159], v[60:63], v[20:23], v[156:159]
    ds_read_b64_tr_b16 v[98:99], v10 offset:14040
    v_mfma_f32_16x16x32_bf16 v[160:163], v[60:63], v[24:27], v[160:163]
    ds_read_b64_tr_b16 v[100:101], v10 offset:9472
    v_mfma_f32_16x16x32_bf16 v[164:167], v[64:67], v[20:23], v[164:167]
    ds_read_b64_tr_b16 v[102:103], v10 offset:14080
    v_mfma_f32_16x16x32_bf16 v[168:171], v[64:67], v[24:27], v[168:171]
    ds_read_b64_tr_b16 v[104:105], v11 offset:9216
    v_mfma_f32_16x16x32_bf16 v[172:175], v[68:71], v[20:23], v[172:175]
    ds_read_b64_tr_b16 v[106:107], v11 offset:13824
    v_mfma_f32_16x16x32_bf16 v[176:179], v[68:71], v[24:27], v[176:179]
    s_barrier
    s_waitcnt lgkmcnt(12)
    v_mfma_f32_16x16x32_bf16 v[108:111], v[72:75], v[28:31], v[108:111]
    v_add_u32 v12, 34816, v12
    v_add_u32 v13, 34816, v13
    v_mfma_f32_16x16x32_bf16 v[112:115], v[72:75], v[32:35], v[112:115]
    v_add_u32 v14, 34816, v14
    v_add_u32 v15, 34816, v15
    v_mfma_f32_16x16x32_bf16 v[116:119], v[76:79], v[28:31], v[116:119]
    v_add_u32 v10, 34816, v10
    v_add_u32 v11, 34816, v11
    v_mfma_f32_16x16x32_bf16 v[120:123], v[76:79], v[32:35], v[120:123]
    ds_read_b64 v[20:21], v12 offset:0
    ds_read_b64 v[22:23], v13 offset:0
    v_mfma_f32_16x16x32_bf16 v[124:127], v[80:83], v[28:31], v[124:127]
    ds_read_b64 v[24:25], v12 offset:2048
    ds_read_b64 v[26:27], v13 offset:2048
    v_mfma_f32_16x16x32_bf16 v[128:131], v[80:83], v[32:35], v[128:131]
    s_waitcnt lgkmcnt(10)
    v_mfma_f32_16x16x32_bf16 v[132:135], v[84:87], v[28:31], v[132:135]
    ds_read_b64_tr_b16 v[36:37], v10 offset:0
    ds_read_b64_tr_b16 v[38:39], v10 offset:4608
    v_mfma_f32_16x16x32_bf16 v[136:139], v[84:87], v[32:35], v[136:139]
    ds_read_b64_tr_b16 v[40:41], v10 offset:40
    ds_read_b64_tr_b16 v[42:43], v10 offset:4648
    v_mfma_f32_16x16x32_bf16 v[140:143], v[88:91], v[28:31], v[140:143]
    ds_read_b64_tr_b16 v[44:45], v10 offset:72
    ds_read_b64_tr_b16 v[46:47], v10 offset:4680
    v_mfma_f32_16x16x32_bf16 v[144:147], v[88:91], v[32:35], v[144:147]
    ds_read_b64_tr_b16 v[48:49], v10 offset:112
    ds_read_b64_tr_b16 v[50:51], v10 offset:4720
    v_mfma_f32_16x16x32_bf16 v[148:151], v[92:95], v[28:31], v[148:151]
    ds_read_b64_tr_b16 v[52:53], v10 offset:144
    ds_read_b64_tr_b16 v[54:55], v10 offset:4752
    v_mfma_f32_16x16x32_bf16 v[152:155], v[92:95], v[32:35], v[152:155]
    s_waitcnt lgkmcnt(14)
    v_mfma_f32_16x16x32_bf16 v[156:159], v[96:99], v[28:31], v[156:159]
    ds_read_b64_tr_b16 v[56:57], v10 offset:184
    ds_read_b64_tr_b16 v[58:59], v10 offset:4792
    v_mfma_f32_16x16x32_bf16 v[160:163], v[96:99], v[32:35], v[160:163]
    ds_read_b64_tr_b16 v[60:61], v10 offset:216
    ds_read_b64_tr_b16 v[62:63], v10 offset:4824
    v_mfma_f32_16x16x32_bf16 v[164:167], v[100:103], v[28:31], v[164:167]
    ds_read_b64_tr_b16 v[64:65], v10 offset:256
    ds_read_b64_tr_b16 v[66:67], v10 offset:4864
    v_mfma_f32_16x16x32_bf16 v[168:171], v[100:103], v[32:35], v[168:171]
    ds_read_b64_tr_b16 v[68:69], v11 offset:0
    v_mfma_f32_16x16x32_bf16 v[172:175], v[104:107], v[28:31], v[172:175]
    ds_read_b64_tr_b16 v[70:71], v11 offset:4608
    v_mfma_f32_16x16x32_bf16 v[176:179], v[104:107], v[32:35], v[176:179]
    s_waitcnt lgkmcnt(12)
    v_mfma_f32_16x16x32_bf16 v[108:111], v[36:39], v[20:23], v[108:111]
    ds_read_b64 v[28:29], v14 offset:0
    ds_read_b64 v[30:31], v15 offset:0
    v_mfma_f32_16x16x32_bf16 v[112:115], v[36:39], v[24:27], v[112:115]
    ds_read_b64 v[32:33], v14 offset:2048
    ds_read_b64 v[34:35], v15 offset:2048
    v_mfma_f32_16x16x32_bf16 v[116:119], v[40:43], v[20:23], v[116:119]
    ds_read_b64_tr_b16 v[72:73], v10 offset:9216
    ds_read_b64_tr_b16 v[74:75], v10 offset:13824
    v_mfma_f32_16x16x32_bf16 v[120:123], v[40:43], v[24:27], v[120:123]
    ds_read_b64_tr_b16 v[76:77], v10 offset:9256
    ds_read_b64_tr_b16 v[78:79], v10 offset:13864
    v_mfma_f32_16x16x32_bf16 v[124:127], v[44:47], v[20:23], v[124:127]
    ds_read_b64_tr_b16 v[80:81], v10 offset:9288
    ds_read_b64_tr_b16 v[82:83], v10 offset:13896
    v_mfma_f32_16x16x32_bf16 v[128:131], v[44:47], v[24:27], v[128:131]
    s_waitcnt lgkmcnt(15)
    v_mfma_f32_16x16x32_bf16 v[132:135], v[48:51], v[20:23], v[132:135]
    ds_read_b64_tr_b16 v[84:85], v10 offset:9328
    ds_read_b64_tr_b16 v[86:87], v10 offset:13936
    v_mfma_f32_16x16x32_bf16 v[136:139], v[48:51], v[24:27], v[136:139]
    ds_read_b64_tr_b16 v[88:89], v10 offset:9360
    ds_read_b64_tr_b16 v[90:91], v10 offset:13968
    v_mfma_f32_16x16x32_bf16 v[140:143], v[52:55], v[20:23], v[140:143]
    ds_read_b64_tr_b16 v[92:93], v10 offset:9400
    v_mfma_f32_16x16x32_bf16 v[144:147], v[52:55], v[24:27], v[144:147]
    ds_read_b64_tr_b16 v[94:95], v10 offset:14008
    v_mfma_f32_16x16x32_bf16 v[148:151], v[56:59], v[20:23], v[148:151]
    ds_read_b64_tr_b16 v[96:97], v10 offset:9432
    v_mfma_f32_16x16x32_bf16 v[152:155], v[56:59], v[24:27], v[152:155]
    s_waitcnt lgkmcnt(15)
    v_mfma_f32_16x16x32_bf16 v[156:159], v[60:63], v[20:23], v[156:159]
    ds_read_b64_tr_b16 v[98:99], v10 offset:14040
    v_mfma_f32_16x16x32_bf16 v[160:163], v[60:63], v[24:27], v[160:163]
    ds_read_b64_tr_b16 v[100:101], v10 offset:9472
    v_mfma_f32_16x16x32_bf16 v[164:167], v[64:67], v[20:23], v[164:167]
    ds_read_b64_tr_b16 v[102:103], v10 offset:14080
    v_mfma_f32_16x16x32_bf16 v[168:171], v[64:67], v[24:27], v[168:171]
    ds_read_b64_tr_b16 v[104:105], v11 offset:9216
    v_mfma_f32_16x16x32_bf16 v[172:175], v[68:71], v[20:23], v[172:175]
    ds_read_b64_tr_b16 v[106:107], v11 offset:13824
    v_mfma_f32_16x16x32_bf16 v[176:179], v[68:71], v[24:27], v[176:179]
    s_barrier
    s_waitcnt lgkmcnt(12)
    v_mfma_f32_16x16x32_bf16 v[108:111], v[72:75], v[28:31], v[108:111]
    v_add_u32 v12, 34816, v12
    v_add_u32 v13, 34816, v13
    v_mfma_f32_16x16x32_bf16 v[112:115], v[72:75], v[32:35], v[112:115]
    v_add_u32 v14, 34816, v14
    v_add_u32 v15, 34816, v15
    v_mfma_f32_16x16x32_bf16 v[116:119], v[76:79], v[28:31], v[116:119]
    v_add_u32 v10, 34816, v10
    v_add_u32 v11, 34816, v11
    v_mfma_f32_16x16x32_bf16 v[120:123], v[76:79], v[32:35], v[120:123]
    ds_read_b64 v[20:21], v12 offset:0
    ds_read_b64 v[22:23], v13 offset:0
    v_mfma_f32_16x16x32_bf16 v[124:127], v[80:83], v[28:31], v[124:127]
    ds_read_b64 v[24:25], v12 offset:2048
    ds_read_b64 v[26:27], v13 offset:2048
    v_mfma_f32_16x16x32_bf16 v[128:131], v[80:83], v[32:35], v[128:131]
    s_waitcnt lgkmcnt(10)
    v_mfma_f32_16x16x32_bf16 v[132:135], v[84:87], v[28:31], v[132:135]
    ds_read_b64_tr_b16 v[36:37], v10 offset:0
    ds_read_b64_tr_b16 v[38:39], v10 offset:4608
    v_mfma_f32_16x16x32_bf16 v[136:139], v[84:87], v[32:35], v[136:139]
    ds_read_b64_tr_b16 v[40:41], v10 offset:40
    ds_read_b64_tr_b16 v[42:43], v10 offset:4648
    v_mfma_f32_16x16x32_bf16 v[140:143], v[88:91], v[28:31], v[140:143]
    ds_read_b64_tr_b16 v[44:45], v10 offset:72
    ds_read_b64_tr_b16 v[46:47], v10 offset:4680
    v_mfma_f32_16x16x32_bf16 v[144:147], v[88:91], v[32:35], v[144:147]
    ds_read_b64_tr_b16 v[48:49], v10 offset:112
    ds_read_b64_tr_b16 v[50:51], v10 offset:4720
    v_mfma_f32_16x16x32_bf16 v[148:151], v[92:95], v[28:31], v[148:151]
    ds_read_b64_tr_b16 v[52:53], v10 offset:144
    ds_read_b64_tr_b16 v[54:55], v10 offset:4752
    v_mfma_f32_16x16x32_bf16 v[152:155], v[92:95], v[32:35], v[152:155]
    s_waitcnt lgkmcnt(14)
    v_mfma_f32_16x16x32_bf16 v[156:159], v[96:99], v[28:31], v[156:159]
    ds_read_b64_tr_b16 v[56:57], v10 offset:184
    ds_read_b64_tr_b16 v[58:59], v10 offset:4792
    v_mfma_f32_16x16x32_bf16 v[160:163], v[96:99], v[32:35], v[160:163]
    ds_read_b64_tr_b16 v[60:61], v10 offset:216
    ds_read_b64_tr_b16 v[62:63], v10 offset:4824
    v_mfma_f32_16x16x32_bf16 v[164:167], v[100:103], v[28:31], v[164:167]
    ds_read_b64_tr_b16 v[64:65], v10 offset:256
    ds_read_b64_tr_b16 v[66:67], v10 offset:4864
    v_mfma_f32_16x16x32_bf16 v[168:171], v[100:103], v[32:35], v[168:171]
    ds_read_b64_tr_b16 v[68:69], v11 offset:0
    v_mfma_f32_16x16x32_bf16 v[172:175], v[104:107], v[28:31], v[172:175]
    ds_read_b64_tr_b16 v[70:71], v11 offset:4608
    v_mfma_f32_16x16x32_bf16 v[176:179], v[104:107], v[32:35], v[176:179]
    s_waitcnt lgkmcnt(12)
    v_mfma_f32_16x16x32_bf16 v[108:111], v[36:39], v[20:23], v[108:111]
    ds_read_b64 v[28:29], v14 offset:0
    ds_read_b64 v[30:31], v15 offset:0
    v_mfma_f32_16x16x32_bf16 v[112:115], v[36:39], v[24:27], v[112:115]
    ds_read_b64 v[32:33], v14 offset:2048
    ds_read_b64 v[34:35], v15 offset:2048
    v_mfma_f32_16x16x32_bf16 v[116:119], v[40:43], v[20:23], v[116:119]
    ds_read_b64_tr_b16 v[72:73], v10 offset:9216
    ds_read_b64_tr_b16 v[74:75], v10 offset:13824
    v_mfma_f32_16x16x32_bf16 v[120:123], v[40:43], v[24:27], v[120:123]
    ds_read_b64_tr_b16 v[76:77], v10 offset:9256
    ds_read_b64_tr_b16 v[78:79], v10 offset:13864
    v_mfma_f32_16x16x32_bf16 v[124:127], v[44:47], v[20:23], v[124:127]
    ds_read_b64_tr_b16 v[80:81], v10 offset:9288
    ds_read_b64_tr_b16 v[82:83], v10 offset:13896
    v_mfma_f32_16x16x32_bf16 v[128:131], v[44:47], v[24:27], v[128:131]
    s_waitcnt lgkmcnt(15)
    v_mfma_f32_16x16x32_bf16 v[132:135], v[48:51], v[20:23], v[132:135]
    ds_read_b64_tr_b16 v[84:85], v10 offset:9328
    ds_read_b64_tr_b16 v[86:87], v10 offset:13936
    v_mfma_f32_16x16x32_bf16 v[136:139], v[48:51], v[24:27], v[136:139]
    ds_read_b64_tr_b16 v[88:89], v10 offset:9360
    ds_read_b64_tr_b16 v[90:91], v10 offset:13968
    v_mfma_f32_16x16x32_bf16 v[140:143], v[52:55], v[20:23], v[140:143]
    ds_read_b64_tr_b16 v[92:93], v10 offset:9400
    v_mfma_f32_16x16x32_bf16 v[144:147], v[52:55], v[24:27], v[144:147]
    ds_read_b64_tr_b16 v[94:95], v10 offset:14008
    v_mfma_f32_16x16x32_bf16 v[148:151], v[56:59], v[20:23], v[148:151]
    ds_read_b64_tr_b16 v[96:97], v10 offset:9432
    v_mfma_f32_16x16x32_bf16 v[152:155], v[56:59], v[24:27], v[152:155]
    s_waitcnt lgkmcnt(15)
    v_mfma_f32_16x16x32_bf16 v[156:159], v[60:63], v[20:23], v[156:159]
    ds_read_b64_tr_b16 v[98:99], v10 offset:14040
    v_mfma_f32_16x16x32_bf16 v[160:163], v[60:63], v[24:27], v[160:163]
    ds_read_b64_tr_b16 v[100:101], v10 offset:9472
    v_mfma_f32_16x16x32_bf16 v[164:167], v[64:67], v[20:23], v[164:167]
    ds_read_b64_tr_b16 v[102:103], v10 offset:14080
    v_mfma_f32_16x16x32_bf16 v[168:171], v[64:67], v[24:27], v[168:171]
    ds_read_b64_tr_b16 v[104:105], v11 offset:9216
    v_mfma_f32_16x16x32_bf16 v[172:175], v[68:71], v[20:23], v[172:175]
    ds_read_b64_tr_b16 v[106:107], v11 offset:13824
    v_mfma_f32_16x16x32_bf16 v[176:179], v[68:71], v[24:27], v[176:179]
    s_cmp_lg_u32 s36, 1
    s_cbranch_scc1 ZS_m_15
    buffer_load_dword v18, v16, s[56:59], 0 offen sc0 sc1
ZS_m_15:
    s_barrier
    s_waitcnt lgkmcnt(12)
    v_mfma_f32_16x16x32_bf16 v[108:111], v[72:75], v[28:31], v[108:111]
    v_subrev_u32 v12, 104448, v12
    v_subrev_u32 v13, 104448, v13
    v_mfma_f32_16x16x32_bf16 v[112:115], v[72:75], v[32:35], v[112:115]
    v_subrev_u32 v14, 104448, v14
    v_subrev_u32 v15, 104448, v15
    v_mfma_f32_16x16x32_bf16 v[116:119], v[76:79], v[28:31], v[116:119]
    v_subrev_u32 v10, 104448, v10
    v_subrev_u32 v11, 104448, v11
    v_mfma_f32_16x16x32_bf16 v[120:123], v[76:79], v[32:35], v[120:123]
    ds_read_b64 v[20:21], v12 offset:0
    ds_read_b64 v[22:23], v13 offset:0
    v_mfma_f32_16x16x32_bf16 v[124:127], v[80:83], v[28:31], v[124:127]
    ds_read_b64 v[24:25], v12 offset:2048
    ds_read_b64 v[26:27], v13 offset:2048
    v_mfma_f32_16x16x32_bf16 v[128:131], v[80:83], v[32:35], v[128:131]
    s_waitcnt lgkmcnt(10)
    v_mfma_f32_16x16x32_bf16 v[132:135], v[84:87], v[28:31], v[132:135]
    ds_read_b64_tr_b16 v[36:37], v10 offset:0
    ds_read_b64_tr_b16 v[38:39], v10 offset:4608
    v_mfma_f32_16x16x32_bf16 v[136:139], v[84:87], v[32:35], v[136:139]
    ds_read_b64_tr_b16 v[40:41], v10 offset:40
    ds_read_b64_tr_b16 v[42:43], v10 offset:4648
    v_mfma_f32_16x16x32_bf16 v[140:143], v[88:91], v[28:31], v[140:143]
    ds_read_b64_tr_b16 v[44:45], v10 offset:72
    ds_read_b64_tr_b16 v[46:47], v10 offset:4680
    v_mfma_f32_16x16x32_bf16 v[144:147], v[88:91], v[32:35], v[144:147]
    ds_read_b64_tr_b16 v[48:49], v10 offset:112
    ds_read_b64_tr_b16 v[50:51], v10 offset:4720
    v_mfma_f32_16x16x32_bf16 v[148:151], v[92:95], v[28:31], v[148:151]
    ds_read_b64_tr_b16 v[52:53], v10 offset:144
    ds_read_b64_tr_b16 v[54:55], v10 offset:4752
    v_mfma_f32_16x16x32_bf16 v[152:155], v[92:95], v[32:35], v[152:155]
    s_waitcnt lgkmcnt(14)
    v_mfma_f32_16x16x32_bf16 v[156:159], v[96:99], v[28:31], v[156:159]
    ds_read_b64_tr_b16 v[56:57], v10 offset:184
    ds_read_b64_tr_b16 v[58:59], v10 offset:4792
    v_mfma_f32_16x16x32_bf16 v[160:163], v[96:99], v[32:35], v[160:163]
    ds_read_b64_tr_b16 v[60:61], v10 offset:216
    ds_read_b64_tr_b16 v[62:63], v10 offset:4824
    v_mfma_f32_16x16x32_bf16 v[164:167], v[100:103], v[28:31], v[164:167]
    ds_read_b64_tr_b16 v[64:65], v10 offset:256
    ds_read_b64_tr_b16 v[66:67], v10 offset:4864
    v_mfma_f32_16x16x32_bf16 v[168:171], v[100:103], v[32:35], v[168:171]
    ds_read_b64_tr_b16 v[68:69], v11 offset:0
    v_mfma_f32_16x16x32_bf16 v[172:175], v[104:107], v[28:31], v[172:175]
    ds_read_b64_tr_b16 v[70:71], v11 offset:4608
    v_mfma_f32_16x16x32_bf16 v[176:179], v[104:107], v[32:35], v[176:179]
    s_sub_u32 s36, s36, 1
    s_cmp_lg_u32 s36, 0
    s_cbranch_scc1 CL_m_14
    s_waitcnt vmcnt(0)
    v_cmp_gt_u32 vcc, 64, v18
    s_mov_b32 s31, 0
    s_nop 3
    s_cbranch_vccz ZOK_m_16
    s_mov_b32 s37, 0x40000
POLL_m_17:
    buffer_load_dword v18, v16, s[56:59], s31 offen sc0 sc1
    s_waitcnt vmcnt(0)
    v_cmp_gt_u32 vcc, 64, v18
    s_sub_u32 s37, s37, 1
    s_cmp_eq_u32 s37, 0
    s_cbranch_scc1 GO_m_18
    s_cbranch_vccz GO_m_18
    s_sleep 1
    s_branch POLL_m_17
GO_m_18:
ZOK_m_16:
    v_lshlrev_b32 v16, 4, v3
    v_mul_u32_u24 v17, 144, v3
    v_lshlrev_b32 v18, 2, v4
    buffer_load_dword v216, v18, s[20:23], s49 offen offset:0 sc1
    buffer_load_dword v218, v18, s[20:23], s49 offen offset:64 sc1
    s_add_u32 s49, s49, 8192
    buffer_load_dword v217, v18, s[20:23], s49 offen offset:0 sc1
    buffer_load_dword v219, v18, s[20:23], s49 offen offset:64 sc1
    buffer_load_dwordx4 v[180:183], v16, s[20:23], s51 offen offset:0 sc1
    buffer_load_dwordx4 v[184:187], v16, s[20:23], s51 offen offset:80 sc1
    buffer_load_dwordx4 v[188:191], v16, s[20:23], s51 offen offset:144 sc1
    buffer_load_dwordx4 v[192:195], v16, s[20:23], s51 offen offset:224 sc1
    buffer_load_dwordx4 v[196:199], v16, s[20:23], s51 offen offset:288 sc1
    buffer_load_dwordx4 v[200:203], v16, s[20:23], s51 offen offset:368 sc1
    buffer_load_dwordx4 v[204:207], v16, s[20:23], s51 offen offset:432 sc1
    buffer_load_dwordx4 v[208:211], v16, s[20:23], s51 offen offset:512 sc1
    buffer_load_dwordx4 v[212:215], v17, s[20:23], s51 offen offset:64 sc1
    s_waitcnt lgkmcnt(12)
    v_mfma_f32_16x16x32_bf16 v[108:111], v[36:39], v[20:23], v[108:111]
    ds_read_b64 v[28:29], v14 offset:0
    ds_read_b64 v[30:31], v15 offset:0
    v_mfma_f32_16x16x32_bf16 v[112:115], v[36:39], v[24:27], v[112:115]
    ds_read_b64 v[32:33], v14 offset:2048
    ds_read_b64 v[34:35], v15 offset:2048
    v_mfma_f32_16x16x32_bf16 v[116:119], v[40:43], v[20:23], v[116:119]
    ds_read_b64_tr_b16 v[72:73], v10 offset:9216
    ds_read_b64_tr_b16 v[74:75], v10 offset:13824
    v_mfma_f32_16x16x32_bf16 v[120:123], v[40:43], v[24:27], v[120:123]
    ds_read_b64_tr_b16 v[76:77], v10 offset:9256
    ds_read_b64_tr_b16 v[78:79], v10 offset:13864
    v_mfma_f32_16x16x32_bf16 v[124:127], v[44:47], v[20:23], v[124:127]
    ds_read_b64_tr_b16 v[80:81], v10 offset:9288
    ds_read_b64_tr_b16 v[82:83], v10 offset:13896
    v_mfma_f32_16x16x32_bf16 v[128:131], v[44:47], v[24:27], v[128:131]
    s_waitcnt lgkmcnt(15)
    v_mfma_f32_16x16x32_bf16 v[132:135], v[48:51], v[20:23], v[132:135]
    ds_read_b64_tr_b16 v[84:85], v10 offset:9328
    ds_read_b64_tr_b16 v[86:87], v10 offset:13936
    v_mfma_f32_16x16x32_bf16 v[136:139], v[48:51], v[24:27], v[136:139]
    ds_read_b64_tr_b16 v[88:89], v10 offset:9360
    ds_read_b64_tr_b16 v[90:91], v10 offset:13968
    v_mfma_f32_16x16x32_bf16 v[140:143], v[52:55], v[20:23], v[140:143]
    ds_read_b64_tr_b16 v[92:93], v10 offset:9400
    v_mfma_f32_16x16x32_bf16 v[144:147], v[52:55], v[24:27], v[144:147]
    ds_read_b64_tr_b16 v[94:95], v10 offset:14008
    v_mfma_f32_16x16x32_bf16 v[148:151], v[56:59], v[20:23], v[148:151]
    ds_read_b64_tr_b16 v[96:97], v10 offset:9432
    v_mfma_f32_16x16x32_bf16 v[152:155], v[56:59], v[24:27], v[152:155]
    s_waitcnt lgkmcnt(15)
    v_mfma_f32_16x16x32_bf16 v[156:159], v[60:63], v[20:23], v[156:159]
    ds_read_b64_tr_b16 v[98:99], v10 offset:14040
    v_mfma_f32_16x16x32_bf16 v[160:163], v[60:63], v[24:27], v[160:163]
    ds_read_b64_tr_b16 v[100:101], v10 offset:9472
    v_mfma_f32_16x16x32_bf16 v[164:167], v[64:67], v[20:23], v[164:167]
    ds_read_b64_tr_b16 v[102:103], v10 offset:14080
    v_mfma_f32_16x16x32_bf16 v[168:171], v[64:67], v[24:27], v[168:171]
    ds_read_b64_tr_b16 v[104:105], v11 offset:9216
    v_mfma_f32_16x16x32_bf16 v[172:175], v[68:71], v[20:23], v[172:175]
    ds_read_b64_tr_b16 v[106:107], v11 offset:13824
    v_mfma_f32_16x16x32_bf16 v[176:179], v[68:71], v[24:27], v[176:179]
    s_waitcnt lgkmcnt(12)
    v_mfma_f32_16x16x32_bf16 v[108:111], v[72:75], v[28:31], v[108:111]
    v_mfma_f32_16x16x32_bf16 v[112:115], v[72:75], v[32:35], v[112:115]
    v_mfma_f32_16x16x32_bf16 v[116:119], v[76:79], v[28:31], v[116:119]
    v_mfma_f32_16x16x32_bf16 v[120:123], v[76:79], v[32:35], v[120:123]
    v_mfma_f32_16x16x32_bf16 v[124:127], v[80:83], v[28:31], v[124:127]
    v_mfma_f32_16x16x32_bf16 v[128:131], v[80:83], v[32:35], v[128:131]
    s_waitcnt lgkmcnt(6)
    v_mfma_f32_16x16x32_bf16 v[132:135], v[84:87], v[28:31], v[132:135]
    v_mfma_f32_16x16x32_bf16 v[136:139], v[84:87], v[32:35], v[136:139]
    v_mfma_f32_16x16x32_bf16 v[140:143], v[88:91], v[28:31], v[140:143]
    v_mfma_f32_16x16x32_bf16 v[144:147], v[88:91], v[32:35], v[144:147]
    v_mfma_f32_16x16x32_bf16 v[148:151], v[92:95], v[28:31], v[148:151]
    v_mfma_f32_16x16x32_bf16 v[152:155], v[92:95], v[32:35], v[152:155]
    s_waitcnt lgkmcnt(0)
    v_mfma_f32_16x16x32_bf16 v[156:159], v[96:99], v[28:31], v[156:159]
    v_mfma_f32_16x16x32_bf16 v[160:163], v[96:99], v[32:35], v[160:163]
    v_mfma_f32_16x16x32_bf16 v[164:167], v[100:103], v[28:31], v[164:167]
    v_mfma_f32_16x16x32_bf16 v[168:171], v[100:103], v[32:35], v[168:171]
    v_mfma_f32_16x16x32_bf16 v[172:175], v[104:107], v[28:31], v[172:175]
    v_mfma_f32_16x16x32_bf16 v[176:179], v[104:107], v[32:35], v[176:179]
    v_lshlrev_b32 v10, 4, v1
    s_waitcnt vmcnt(0)
    s_cmp_eq_u32 s26, 0
    s_cselect_b32 s31, 0x3eae1a93, 1.0
    v_mul_f32 v217, s31, v217
    v_mul_f32 v219, s31, v219
    v_pk_fma_f32 v[108:109], v[216:217], v[180:181], v[108:109] op_sel_hi:[0,1,1] neg_lo:[1,0,0] neg_hi:[1,0,0]
    v_pk_fma_f32 v[110:111], v[216:217], v[182:183], v[110:111] op_sel_hi:[0,1,1] neg_lo:[1,0,0] neg_hi:[1,0,0]
    v_pk_fma_f32 v[112:113], v[218:219], v[180:181], v[112:113] op_sel_hi:[0,1,1] neg_lo:[1,0,0] neg_hi:[1,0,0]
    v_pk_fma_f32 v[114:115], v[218:219], v[182:183], v[114:115] op_sel_hi:[0,1,1] neg_lo:[1,0,0] neg_hi:[1,0,0]
    v_pk_mul_f32 v[108:109], v[108:109], v[216:217] op_sel:[0,1] op_sel_hi:[1,1]
    v_pk_mul_f32 v[110:111], v[110:111], v[216:217] op_sel:[0,1] op_sel_hi:[1,1]
    v_pk_mul_f32 v[112:113], v[112:113], v[218:219] op_sel:[0,1] op_sel_hi:[1,1]
    v_pk_mul_f32 v[114:115], v[114:115], v[218:219] op_sel:[0,1] op_sel_hi:[1,1]
    v_cvt_pk_bf16_f32 v20, v108, v109
    v_cvt_pk_bf16_f32 v21, v110, v111
    v_cvt_pk_bf16_f32 v22, v112, v113
    v_cvt_pk_bf16_f32 v23, v114, v115
    v_pk_fma_f32 v[116:117], v[216:217], v[184:185], v[116:117] op_sel_hi:[0,1,1] neg_lo:[1,0,0] neg_hi:[1,0,0]
    v_pk_fma_f32 v[118:119], v[216:217], v[186:187], v[118:119] op_sel_hi:[0,1,1] neg_lo:[1,0,0] neg_hi:[1,0,0]
    v_pk_fma_f32 v[120:121], v[218:219], v[184:185], v[120:121] op_sel_hi:[0,1,1] neg_lo:[1,0,0] neg_hi:[1,0,0]
    v_pk_fma_f32 v[122:123], v[218:219], v[186:187], v[122:123] op_sel_hi:[0,1,1] neg_lo:[1,0,0] neg_hi:[1,0,0]
    v_pk_mul_f32 v[116:117], v[116:117], v[216:217] op_sel:[0,1] op_sel_hi:[1,1]
    v_pk_mul_f32 v[118:119], v[118:119], v[216:217] op_sel:[0,1] op_sel_hi:[1,1]
    v_pk_mul_f32 v[120:121], v[120:121], v[218:219] op_sel:[0,1] op_sel_hi:[1,1]
    v_pk_mul_f32 v[122:123], v[122:123], v[218:219] op_sel:[0,1] op_sel_hi:[1,1]
    v_cvt_pk_bf16_f32 v24, v116, v117
    v_cvt_pk_bf16_f32 v25, v118, v119
    v_cvt_pk_bf16_f32 v26, v120, v121
    v_cvt_pk_bf16_f32 v27, v122, v123
    v_permlane16_swap_b32 v20, v22
    v_permlane16_swap_b32 v21, v23
    buffer_store_dwordx4 v[20:23], v10, s[20:23], s50 offen sc0 sc1
    s_add_u32 s50, s50, 66560
    v_pk_fma_f32 v[124:125], v[216:217], v[188:189], v[124:125] op_sel_hi:[0,1,1] neg_lo:[1,0,0] neg_hi:[1,0,0]
    v_pk_fma_f32 v[126:127], v[216:217], v[190:191], v[126:127] op_sel_hi:[0,1,1] neg_lo:[1,0,0] neg_hi:[1,0,0]
    v_pk_fma_f32 v[128:129], v[218:219], v[188:189], v[128:129] op_sel_hi:[0,1,1] neg_lo:[1,0,0] neg_hi:[1,0,0]
    v_pk_fma_f32 v[130:131], v[218:219], v[190:191], v[130:131] op_sel_hi:[0,1,1] neg_lo:[1,0,0] neg_hi:[1,0,0]
    v_pk_mul_f32 v[124:125], v[124:125], v[216:217] op_sel:[0,1] op_sel_hi:[1,1]
    v_pk_mul_f32 v[126:127], v[126:127], v[216:217] op_sel:[0,1] op_sel_hi:[1,1]
    v_pk_mul_f32 v[128:129], v[128:129], v[218:219] op_sel:[0,1] op_sel_hi:[1,1]
    v_pk_mul_f32 v[130:131], v[130:131], v[218:219] op_sel:[0,1] op_sel_hi:[1,1]
    v_cvt_pk_bf16_f32 v28, v124, v125
    v_cvt_pk_bf16_f32 v29, v126, v127
    v_cvt_pk_bf16_f32 v30, v128, v129
    v_cvt_pk_bf16_f32 v31, v130, v131
    v_permlane16_swap_b32 v24, v26
    v_permlane16_swap_b32 v25, v27
    buffer_store_dwordx4 v[24:27], v10, s[20:23], s50 offen sc0 sc1
    s_add_u32 s50, s50, 66560
    v_pk_fma_f32 v[132:133], v[216:217], v[192:193], v[132:133] op_sel_hi:[0,1,1] neg_lo:[1,0,0] neg_hi:[1,0,0]
    v_pk_fma_f32 v[134:135], v[216:217], v[194:195], v[134:135] op_sel_hi:[0,1,1] neg_lo:[1,0,0] neg_hi:[1,0,0]
    v_pk_fma_f32 v[136:137], v[218:219], v[192:193], v[136:137] op_sel_hi:[0,1,1] neg_lo:[1,0,0] neg_hi:[1,0,0]
    v_pk_fma_f32 v[138:139], v[218:219], v[194:195], v[138:139] op_sel_hi:[0,1,1] neg_lo:[1,0,0] neg_hi:[1,0,0]
    v_pk_mul_f32 v[132:133], v[132:133], v[216:217] op_sel:[0,1] op_sel_hi:[1,1]
    v_pk_mul_f32 v[134:135], v[134:135], v[216:217] op_sel:[0,1] op_sel_hi:[1,1]
    v_pk_mul_f32 v[136:137], v[136:137], v[218:219] op_sel:[0,1] op_sel_hi:[1,1]
    v_pk_mul_f32 v[138:139], v[138:139], v[218:219] op_sel:[0,1] op_sel_hi:[1,1]
    v_cvt_pk_bf16_f32 v32, v132, v133
    v_cvt_pk_bf16_f32 v33, v134, v135
    v_cvt_pk_bf16_f32 v34, v136, v137
    v_cvt_pk_bf16_f32 v35, v138, v139
    v_permlane16_swap_b32 v28, v30
    v_permlane16_swap_b32 v29, v31
    buffer_store_dwordx4 v[28:31], v10, s[20:23], s50 offen sc0 sc1
    s_add_u32 s50, s50, 66560
    v_pk_fma_f32 v[140:141], v[216:217], v[196:197], v[140:141] op_sel_hi:[0,1,1] neg_lo:[1,0,0] neg_hi:[1,0,0]
    v_pk_fma_f32 v[142:143], v[216:217], v[198:199], v[142:143] op_sel_hi:[0,1,1] neg_lo:[1,0,0] neg_hi:[1,0,0]
    v_pk_fma_f32 v[144:145], v[218:219], v[196:197], v[144:145] op_sel_hi:[0,1,1] neg_lo:[1,0,0] neg_hi:[1,0,0]
    v_pk_fma_f32 v[146:147], v[218:219], v[198:199], v[146:147] op_sel_hi:[0,1,1] neg_lo:[1,0,0] neg_hi:[1,0,0]
    v_pk_mul_f32 v[140:141], v[140:141], v[216:217] op_sel:[0,1] op_sel_hi:[1,1]
    v_pk_mul_f32 v[142:143], v[142:143], v[216:217] op_sel:[0,1] op_sel_hi:[1,1]
    v_pk_mul_f32 v[144:145], v[144:145], v[218:219] op_sel:[0,1] op_sel_hi:[1,1]
    v_pk_mul_f32 v[146:147], v[146:147], v[218:219] op_sel:[0,1] op_sel_hi:[1,1]
    v_cvt_pk_bf16_f32 v20, v140, v141
    v_cvt_pk_bf16_f32 v21, v142, v143
    v_cvt_pk_bf16_f32 v22, v144, v145
    v_cvt_pk_bf16_f32 v23, v146, v147
    v_permlane16_swap_b32 v32, v34
    v_permlane16_swap_b32 v33, v35
    buffer_store_dwordx4 v[32:35], v10, s[20:23], s50 offen sc0 sc1
    s_add_u32 s50, s50, 66560
    v_pk_fma_f32 v[148:149], v[216:217], v[200:201], v[148:149] op_sel_hi:[0,1,1] neg_lo:[1,0,0] neg_hi:[1,0,0]
    v_pk_fma_f32 v[150:151], v[216:217], v[202:203], v[150:151] op_sel_hi:[0,1,1] neg_lo:[1,0,0] neg_hi:[1,0,0]
    v_pk_fma_f32 v[152:153], v[218:219], v[200:201], v[152:153] op_sel_hi:[0,1,1] neg_lo:[1,0,0] neg_hi:[1,0,0]
    v_pk_fma_f32 v[154:155], v[218:219], v[202:203], v[154:155] op_sel_hi:[0,1,1] neg_lo:[1,0,0] neg_hi:[1,0,0]
    v_pk_mul_f32 v[148:149], v[148:149], v[216:217] op_sel:[0,1] op_sel_hi:[1,1]
    v_pk_mul_f32 v[150:151], v[150:151], v[216:217] op_sel:[0,1] op_sel_hi:[1,1]
    v_pk_mul_f32 v[152:153], v[152:153], v[218:219] op_sel:[0,1] op_sel_hi:[1,1]
    v_pk_mul_f32 v[154:155], v[154:155], v[218:219] op_sel:[0,1] op_sel_hi:[1,1]
    v_cvt_pk_bf16_f32 v24, v148, v149
    v_cvt_pk_bf16_f32 v25, v150, v151
    v_cvt_pk_bf16_f32 v26, v152, v153
    v_cvt_pk_bf16_f32 v27, v154, v155
    v_permlane16_swap_b32 v20, v22
    v_permlane16_swap_b32 v21, v23
    buffer_store_dwordx4 v[20:23], v10, s[20:23], s50 offen sc0 sc1
    s_add_u32 s50, s50, 66560
    v_pk_fma_f32 v[156:157], v[216:217], v[204:205], v[156:157] op_sel_hi:[0,1,1] neg_lo:[1,0,0] neg_hi:[1,0,0]
    v_pk_fma_f32 v[158:159], v[216:217], v[206:207], v[158:159] op_sel_hi:[0,1,1] neg_lo:[1,0,0] neg_hi:[1,0,0]
    v_pk_fma_f32 v[160:161], v[218:219], v[204:205], v[160:161] op_sel_hi:[0,1,1] neg_lo:[1,0,0] neg_hi:[1,0,0]
    v_pk_fma_f32 v[162:163], v[218:219], v[206:207], v[162:163] op_sel_hi:[0,1,1] neg_lo:[1,0,0] neg_hi:[1,0,0]
    v_pk_mul_f32 v[156:157], v[156:157], v[216:217] op_sel:[0,1] op_sel_hi:[1,1]
    v_pk_mul_f32 v[158:159], v[158:159], v[216:217] op_sel:[0,1] op_sel_hi:[1,1]
    v_pk_mul_f32 v[160:161], v[160:161], v[218:219] op_sel:[0,1] op_sel_hi:[1,1]
    v_pk_mul_f32 v[162:163], v[162:163], v[218:219] op_sel:[0,1] op_sel_hi:[1,1]
    v_cvt_pk_bf16_f32 v28, v156, v157
    v_cvt_pk_bf16_f32 v29, v158, v159
    v_cvt_pk_bf16_f32 v30, v160, v161
    v_cvt_pk_bf16_f32 v31, v162, v163
    v_permlane16_swap_b32 v24, v26
    v_permlane16_swap_b32 v25, v27
    buffer_store_dwordx4 v[24:27], v10, s[20:23], s50 offen sc0 sc1
    s_add_u32 s50, s50, 66560
    v_pk_fma_f32 v[164:165], v[216:217], v[208:209], v[164:165] op_sel_hi:[0,1,1] neg_lo:[1,0,0] neg_hi:[1,0,0]
    v_pk_fma_f32 v[166:167], v[216:217], v[210:211], v[166:167] op_sel_hi:[0,1,1] neg_lo:[1,0,0] neg_hi:[1,0,0]
    v_pk_fma_f32 v[168:169], v[218:219], v[208:209], v[168:169] op_sel_hi:[0,1,1] neg_lo:[1,0,0] neg_hi:[1,0,0]
    v_pk_fma_f32 v[170:171], v[218:219], v[210:211], v[170:171] op_sel_hi:[0,1,1] neg_lo:[1,0,0] neg_hi:[1,0,0]
    v_pk_mul_f32 v[164:165], v[164:165], v[216:217] op_sel:[0,1] op_sel_hi:[1,1]
    v_pk_mul_f32 v[166:167], v[166:167], v[216:217] op_sel:[0,1] op_sel_hi:[1,1]
    v_pk_mul_f32 v[168:169], v[168:169], v[218:219] op_sel:[0,1] op_sel_hi:[1,1]
    v_pk_mul_f32 v[170:171], v[170:171], v[218:219] op_sel:[0,1] op_sel_hi:[1,1]
    v_cvt_pk_bf16_f32 v32, v164, v165
    v_cvt_pk_bf16_f32 v33, v166, v167
    v_cvt_pk_bf16_f32 v34, v168, v169
    v_cvt_pk_bf16_f32 v35, v170, v171
    v_permlane16_swap_b32 v28, v30
    v_permlane16_swap_b32 v29, v31
    buffer_store_dwordx4 v[28:31], v10, s[20:23], s50 offen sc0 sc1
    s_add_u32 s50, s50, 66560
    v_pk_fma_f32 v[172:173], v[216:217], v[212:213], v[172:173] op_sel_hi:[0,1,1] neg_lo:[1,0,0] neg_hi:[1,0,0]
    v_pk_fma_f32 v[174:175], v[216:217], v[214:215], v[174:175] op_sel_hi:[0,1,1] neg_lo:[1,0,0] neg_hi:[1,0,0]
    v_pk_fma_f32 v[176:177], v[218:219], v[212:213], v[176:177] op_sel_hi:[0,1,1] neg_lo:[1,0,0] neg_hi:[1,0,0]
    v_pk_fma_f32 v[178:179], v[218:219], v[214:215], v[178:179] op_sel_hi:[0,1,1] neg_lo:[1,0,0] neg_hi:[1,0,0]
    v_pk_mul_f32 v[172:173], v[172:173], v[216:217] op_sel:[0,1] op_sel_hi:[1,1]
    v_pk_mul_f32 v[174:175], v[174:175], v[216:217] op_sel:[0,1] op_sel_hi:[1,1]
    v_pk_mul_f32 v[176:177], v[176:177], v[218:219] op_sel:[0,1] op_sel_hi:[1,1]
    v_pk_mul_f32 v[178:179], v[178:179], v[218:219] op_sel:[0,1] op_sel_hi:[1,1]
    v_cvt_pk_bf16_f32 v20, v172, v173
    v_cvt_pk_bf16_f32 v21, v174, v175
    v_cvt_pk_bf16_f32 v22, v176, v177
    v_cvt_pk_bf16_f32 v23, v178, v179
    v_permlane16_swap_b32 v32, v34
    v_permlane16_swap_b32 v33, v35
    buffer_store_dwordx4 v[32:35], v10, s[20:23], s50 offen sc0 sc1
    s_add_u32 s50, s50, 66560
    v_permlane16_swap_b32 v20, v22
    v_permlane16_swap_b32 v21, v23
    buffer_store_dwordx4 v[20:23], v10, s[20:23], s50 offen sc0 sc1
    s_add_u32 s50, s50, 66560
    v_mov_b32 v5, 0
    v_mov_b32 v6, 1
    s_waitcnt vmcnt(0)
    v_mov_b32 v7, 160768
    s_mov_b64 exec, 1
    ds_add_rtn_u32 v7, v7, v6
    s_waitcnt lgkmcnt(0)
    v_readfirstlane_b32 s31, v7
    s_nop 0
    s_cmp_lg_u32 s31, 3
    s_cbranch_scc1 NL_m_19
    buffer_store_dword v6, v5, s[20:23], s48 offen sc0 sc1
    v_mov_b32 v7, 160768
    s_waitcnt vmcnt(0)
    ds_add_u32 v7, v6
NL_m_19:
    s_mov_b64 exec, -1
    s_branch P2A_m_4
VOR_m_13:
    s_barrier
    ds_read_b64 v[20:21], v12 offset:0
    ds_read_b64 v[22:23], v13 offset:0
    ds_read_b64 v[24:25], v12 offset:2048
    ds_read_b64 v[26:27], v13 offset:2048
    ds_read_b64_tr_b16 v[36:37], v10 offset:0
    ds_read_b64_tr_b16 v[38:39], v10 offset:4608
    ds_read_b64_tr_b16 v[40:41], v10 offset:40
    ds_read_b64_tr_b16 v[42:43], v10 offset:4648
    ds_read_b64_tr_b16 v[44:45], v10 offset:72
    ds_read_b64_tr_b16 v[46:47], v10 offset:4680
    ds_read_b64_tr_b16 v[48:49], v10 offset:112
    ds_read_b64_tr_b16 v[50:51], v10 offset:4720
    ds_read_b64_tr_b16 v[52:53], v10 offset:144
    ds_read_b64_tr_b16 v[54:55], v10 offset:4752
    ds_read_b64_tr_b16 v[56:57], v10 offset:184
    ds_read_b64_tr_b16 v[58:59], v10 offset:4792
    ds_read_b64_tr_b16 v[60:61], v10 offset:216
    ds_read_b64_tr_b16 v[62:63], v10 offset:4824
    ds_read_b64_tr_b16 v[64:65], v10 offset:256
    ds_read_b64_tr_b16 v[66:67], v10 offset:4864
    ds_read_b64_tr_b16 v[68:69], v11 offset:0
    ds_read_b64_tr_b16 v[70:71], v11 offset:4608
    s_mov_b32 s36, 2
CL_m_20:
    s_waitcnt lgkmcnt(12)
    v_mfma_f32_16x16x32_bf16 v[108:111], v[20:23], v[36:39], v[108:111]
    ds_read_b64 v[28:29], v14 offset:0
    ds_read_b64 v[30:31], v15 offset:0
    v_mfma_f32_16x16x32_bf16 v[112:115], v[24:27], v[36:39], v[112:115]
    ds_read_b64 v[32:33], v14 offset:2048
    ds_read_b64 v[34:35], v15 offset:2048
    v_mfma_f32_16x16x32_bf16 v[116:119], v[20:23], v[40:43], v[116:119]
    ds_read_b64_tr_b16 v[72:73], v10 offset:9216
    ds_read_b64_tr_b16 v[74:75], v10 offset:13824
    v_mfma_f32_16x16x32_bf16 v[120:123], v[24:27], v[40:43], v[120:123]
    ds_read_b64_tr_b16 v[76:77], v10 offset:9256
    ds_read_b64_tr_b16 v[78:79], v10 offset:13864
    v_mfma_f32_16x16x32_bf16 v[124:127], v[20:23], v[44:47], v[124:127]
    ds_read_b64_tr_b16 v[80:81], v10 offset:9288
    ds_read_b64_tr_b16 v[82:83], v10 offset:13896
    v_mfma_f32_16x16x32_bf16 v[128:131], v[24:27], v[44:47], v[128:131]
    s_waitcnt lgkmcnt(15)
    v_mfma_f32_16x16x32_bf16 v[132:135], v[20:23], v[48:51], v[132:135]
    ds_read_b64_tr_b16 v[84:85], v10 offset:9328
    ds_read_b64_tr_b16 v[86:87], v10 offset:13936
    v_mfma_f32_16x16x32_bf16 v[136:139], v[24:27], v[48:51], v[136:139]
    ds_read_b64_tr_b16 v[88:89], v10 offset:9360
    ds_read_b64_tr_b16 v[90:91], v10 offset:13968
    v_mfma_f32_16x16x32_bf16 v[140:143], v[20:23], v[52:55], v[140:143]
    ds_read_b64_tr_b16 v[92:93], v10 offset:9400
    v_mfma_f32_16x16x32_bf16 v[144:147], v[24:27], v[52:55], v[144:147]
    ds_read_b64_tr_b16 v[94:95], v10 offset:14008
    v_mfma_f32_16x16x32_bf16 v[148:151], v[20:23], v[56:59], v[148:151]
    ds_read_b64_tr_b16 v[96:97], v10 offset:9432
    v_mfma_f32_16x16x32_bf16 v[152:155], v[24:27], v[56:59], v[152:155]
    s_waitcnt lgkmcnt(15)
    v_mfma_f32_16x16x32_bf16 v[156:159], v[20:23], v[60:63], v[156:159]
    ds_read_b64_tr_b16 v[98:99], v10 offset:14040
    v_mfma_f32_16x16x32_bf16 v[160:163], v[24:27], v[60:63], v[160:163]
    ds_read_b64_tr_b16 v[100:101], v10 offset:9472
    v_mfma_f32_16x16x32_bf16 v[164:167], v[20:23], v[64:67], v[164:167]
    ds_read_b64_tr_b16 v[102:103], v10 offset:14080
    v_mfma_f32_16x16x32_bf16 v[168:171], v[24:27], v[64:67], v[168:171]
    ds_read_b64_tr_b16 v[104:105], v11 offset:9216
    v_mfma_f32_16x16x32_bf16 v[172:175], v[20:23], v[68:71], v[172:175]
    ds_read_b64_tr_b16 v[106:107], v11 offset:13824
    v_mfma_f32_16x16x32_bf16 v[176:179], v[24:27], v[68:71], v[176:179]
    s_barrier
    s_waitcnt lgkmcnt(12)
    v_mfma_f32_16x16x32_bf16 v[108:111], v[28:31], v[72:75], v[108:111]
    v_add_u32 v12, 34816, v12
    v_add_u32 v13, 34816, v13
    v_mfma_f32_16x16x32_bf16 v[112:115], v[32:35], v[72:75], v[112:115]
    v_add_u32 v14, 34816, v14
    v_add_u32 v15, 34816, v15
    v_mfma_f32_16x16x32_bf16 v[116:119], v[28:31], v[76:79], v[116:119]
    v_add_u32 v10, 34816, v10
    v_add_u32 v11, 34816, v11
    v_mfma_f32_16x16x32_bf16 v[120:123], v[32:35], v[76:79], v[120:123]
    ds_read_b64 v[20:21], v12 offset:0
    ds_read_b64 v[22:23], v13 offset:0
    v_mfma_f32_16x16x32_bf16 v[124:127], v[28:31], v[80:83], v[124:127]
    ds_read_b64 v[24:25], v12 offset:2048
    ds_read_b64 v[26:27], v13 offset:2048
    v_mfma_f32_16x16x32_bf16 v[128:131], v[32:35], v[80:83], v[128:131]
    s_waitcnt lgkmcnt(10)
    v_mfma_f32_16x16x32_bf16 v[132:135], v[28:31], v[84:87], v[132:135]
    ds_read_b64_tr_b16 v[36:37], v10 offset:0
    ds_read_b64_tr_b16 v[38:39], v10 offset:4608
    v_mfma_f32_16x16x32_bf16 v[136:139], v[32:35], v[84:87], v[136:139]
    ds_read_b64_tr_b16 v[40:41], v10 offset:40
    ds_read_b64_tr_b16 v[42:43], v10 offset:4648
    v_mfma_f32_16x16x32_bf16 v[140:143], v[28:31], v[88:91], v[140:143]
    ds_read_b64_tr_b16 v[44:45], v10 offset:72
    ds_read_b64_tr_b16 v[46:47], v10 offset:4680
    v_mfma_f32_16x16x32_bf16 v[144:147], v[32:35], v[88:91], v[144:147]
    ds_read_b64_tr_b16 v[48:49], v10 offset:112
    ds_read_b64_tr_b16 v[50:51], v10 offset:4720
    v_mfma_f32_16x16x32_bf16 v[148:151], v[28:31], v[92:95], v[148:151]
    ds_read_b64_tr_b16 v[52:53], v10 offset:144
    ds_read_b64_tr_b16 v[54:55], v10 offset:4752
    v_mfma_f32_16x16x32_bf16 v[152:155], v[32:35], v[92:95], v[152:155]
    s_waitcnt lgkmcnt(14)
    v_mfma_f32_16x16x32_bf16 v[156:159], v[28:31], v[96:99], v[156:159]
    ds_read_b64_tr_b16 v[56:57], v10 offset:184
    ds_read_b64_tr_b16 v[58:59], v10 offset:4792
    v_mfma_f32_16x16x32_bf16 v[160:163], v[32:35], v[96:99], v[160:163]
    ds_read_b64_tr_b16 v[60:61], v10 offset:216
    ds_read_b64_tr_b16 v[62:63], v10 offset:4824
    v_mfma_f32_16x16x32_bf16 v[164:167], v[28:31], v[100:103], v[164:167]
    ds_read_b64_tr_b16 v[64:65], v10 offset:256
    ds_read_b64_tr_b16 v[66:67], v10 offset:4864
    v_mfma_f32_16x16x32_bf16 v[168:171], v[32:35], v[100:103], v[168:171]
    ds_read_b64_tr_b16 v[68:69], v11 offset:0
    v_mfma_f32_16x16x32_bf16 v[172:175], v[28:31], v[104:107], v[172:175]
    ds_read_b64_tr_b16 v[70:71], v11 offset:4608
    v_mfma_f32_16x16x32_bf16 v[176:179], v[32:35], v[104:107], v[176:179]
    s_waitcnt lgkmcnt(12)
    v_mfma_f32_16x16x32_bf16 v[108:111], v[20:23], v[36:39], v[108:111]
    ds_read_b64 v[28:29], v14 offset:0
    ds_read_b64 v[30:31], v15 offset:0
    v_mfma_f32_16x16x32_bf16 v[112:115], v[24:27], v[36:39], v[112:115]
    ds_read_b64 v[32:33], v14 offset:2048
    ds_read_b64 v[34:35], v15 offset:2048
    v_mfma_f32_16x16x32_bf16 v[116:119], v[20:23], v[40:43], v[116:119]
    ds_read_b64_tr_b16 v[72:73], v10 offset:9216
    ds_read_b64_tr_b16 v[74:75], v10 offset:13824
    v_mfma_f32_16x16x32_bf16 v[120:123], v[24:27], v[40:43], v[120:123]
    ds_read_b64_tr_b16 v[76:77], v10 offset:9256
    ds_read_b64_tr_b16 v[78:79], v10 offset:13864
    v_mfma_f32_16x16x32_bf16 v[124:127], v[20:23], v[44:47], v[124:127]
    ds_read_b64_tr_b16 v[80:81], v10 offset:9288
    ds_read_b64_tr_b16 v[82:83], v10 offset:13896
    v_mfma_f32_16x16x32_bf16 v[128:131], v[24:27], v[44:47], v[128:131]
    s_waitcnt lgkmcnt(15)
    v_mfma_f32_16x16x32_bf16 v[132:135], v[20:23], v[48:51], v[132:135]
    ds_read_b64_tr_b16 v[84:85], v10 offset:9328
    ds_read_b64_tr_b16 v[86:87], v10 offset:13936
    v_mfma_f32_16x16x32_bf16 v[136:139], v[24:27], v[48:51], v[136:139]
    ds_read_b64_tr_b16 v[88:89], v10 offset:9360
    ds_read_b64_tr_b16 v[90:91], v10 offset:13968
    v_mfma_f32_16x16x32_bf16 v[140:143], v[20:23], v[52:55], v[140:143]
    ds_read_b64_tr_b16 v[92:93], v10 offset:9400
    v_mfma_f32_16x16x32_bf16 v[144:147], v[24:27], v[52:55], v[144:147]
    ds_read_b64_tr_b16 v[94:95], v10 offset:14008
    v_mfma_f32_16x16x32_bf16 v[148:151], v[20:23], v[56:59], v[148:151]
    ds_read_b64_tr_b16 v[96:97], v10 offset:9432
    v_mfma_f32_16x16x32_bf16 v[152:155], v[24:27], v[56:59], v[152:155]
    s_waitcnt lgkmcnt(15)
    v_mfma_f32_16x16x32_bf16 v[156:159], v[20:23], v[60:63], v[156:159]
    ds_read_b64_tr_b16 v[98:99], v10 offset:14040
    v_mfma_f32_16x16x32_bf16 v[160:163], v[24:27], v[60:63], v[160:163]
    ds_read_b64_tr_b16 v[100:101], v10 offset:9472
    v_mfma_f32_16x16x32_bf16 v[164:167], v[20:23], v[64:67], v[164:167]
    ds_read_b64_tr_b16 v[102:103], v10 offset:14080
    v_mfma_f32_16x16x32_bf16 v[168:171], v[24:27], v[64:67], v[168:171]
    ds_read_b64_tr_b16 v[104:105], v11 offset:9216
    v_mfma_f32_16x16x32_bf16 v[172:175], v[20:23], v[68:71], v[172:175]
    ds_read_b64_tr_b16 v[106:107], v11 offset:13824
    v_mfma_f32_16x16x32_bf16 v[176:179], v[24:27], v[68:71], v[176:179]
    s_barrier
    s_waitcnt lgkmcnt(12)
    v_mfma_f32_16x16x32_bf16 v[108:111], v[28:31], v[72:75], v[108:111]
    v_add_u32 v12, 34816, v12
    v_add_u32 v13, 34816, v13
    v_mfma_f32_16x16x32_bf16 v[112:115], v[32:35], v[72:75], v[112:115]
    v_add_u32 v14, 34816, v14
    v_add_u32 v15, 34816, v15
    v_mfma_f32_16x16x32_bf16 v[116:119], v[28:31], v[76:79], v[116:119]
    v_add_u32 v10, 34816, v10
    v_add_u32 v11, 34816, v11
    v_mfma_f32_16x16x32_bf16 v[120:123], v[32:35], v[76:79], v[120:123]
    ds_read_b64 v[20:21], v12 offset:0
    ds_read_b64 v[22:23], v13 offset:0
    v_mfma_f32_16x16x32_bf16 v[124:127], v[28:31], v[80:83], v[124:127]
    ds_read_b64 v[24:25], v12 offset:2048
    ds_read_b64 v[26:27], v13 offset:2048
    v_mfma_f32_16x16x32_bf16 v[128:131], v[32:35], v[80:83], v[128:131]
    s_waitcnt lgkmcnt(10)
    v_mfma_f32_16x16x32_bf16 v[132:135], v[28:31], v[84:87], v[132:135]
    ds_read_b64_tr_b16 v[36:37], v10 offset:0
    ds_read_b64_tr_b16 v[38:39], v10 offset:4608
    v_mfma_f32_16x16x32_bf16 v[136:139], v[32:35], v[84:87], v[136:139]
    ds_read_b64_tr_b16 v[40:41], v10 offset:40
    ds_read_b64_tr_b16 v[42:43], v10 offset:4648
    v_mfma_f32_16x16x32_bf16 v[140:143], v[28:31], v[88:91], v[140:143]
    ds_read_b64_tr_b16 v[44:45], v10 offset:72
    ds_read_b64_tr_b16 v[46:47], v10 offset:4680
    v_mfma_f32_16x16x32_bf16 v[144:147], v[32:35], v[88:91], v[144:147]
    ds_read_b64_tr_b16 v[48:49], v10 offset:112
    ds_read_b64_tr_b16 v[50:51], v10 offset:4720
    v_mfma_f32_16x16x32_bf16 v[148:151], v[28:31], v[92:95], v[148:151]
    ds_read_b64_tr_b16 v[52:53], v10 offset:144
    ds_read_b64_tr_b16 v[54:55], v10 offset:4752
    v_mfma_f32_16x16x32_bf16 v[152:155], v[32:35], v[92:95], v[152:155]
    s_waitcnt lgkmcnt(14)
    v_mfma_f32_16x16x32_bf16 v[156:159], v[28:31], v[96:99], v[156:159]
    ds_read_b64_tr_b16 v[56:57], v10 offset:184
    ds_read_b64_tr_b16 v[58:59], v10 offset:4792
    v_mfma_f32_16x16x32_bf16 v[160:163], v[32:35], v[96:99], v[160:163]
    ds_read_b64_tr_b16 v[60:61], v10 offset:216
    ds_read_b64_tr_b16 v[62:63], v10 offset:4824
    v_mfma_f32_16x16x32_bf16 v[164:167], v[28:31], v[100:103], v[164:167]
    ds_read_b64_tr_b16 v[64:65], v10 offset:256
    ds_read_b64_tr_b16 v[66:67], v10 offset:4864
    v_mfma_f32_16x16x32_bf16 v[168:171], v[32:35], v[100:103], v[168:171]
    ds_read_b64_tr_b16 v[68:69], v11 offset:0
    v_mfma_f32_16x16x32_bf16 v[172:175], v[28:31], v[104:107], v[172:175]
    ds_read_b64_tr_b16 v[70:71], v11 offset:4608
    v_mfma_f32_16x16x32_bf16 v[176:179], v[32:35], v[104:107], v[176:179]
    s_waitcnt lgkmcnt(12)
    v_mfma_f32_16x16x32_bf16 v[108:111], v[20:23], v[36:39], v[108:111]
    ds_read_b64 v[28:29], v14 offset:0
    ds_read_b64 v[30:31], v15 offset:0
    v_mfma_f32_16x16x32_bf16 v[112:115], v[24:27], v[36:39], v[112:115]
    ds_read_b64 v[32:33], v14 offset:2048
    ds_read_b64 v[34:35], v15 offset:2048
    v_mfma_f32_16x16x32_bf16 v[116:119], v[20:23], v[40:43], v[116:119]
    ds_read_b64_tr_b16 v[72:73], v10 offset:9216
    ds_read_b64_tr_b16 v[74:75], v10 offset:13824
    v_mfma_f32_16x16x32_bf16 v[120:123], v[24:27], v[40:43], v[120:123]
    ds_read_b64_tr_b16 v[76:77], v10 offset:9256
    ds_read_b64_tr_b16 v[78:79], v10 offset:13864
    v_mfma_f32_16x16x32_bf16 v[124:127], v[20:23], v[44:47], v[124:127]
    ds_read_b64_tr_b16 v[80:81], v10 offset:9288
    ds_read_b64_tr_b16 v[82:83], v10 offset:13896
    v_mfma_f32_16x16x32_bf16 v[128:131], v[24:27], v[44:47], v[128:131]
    s_waitcnt lgkmcnt(15)
    v_mfma_f32_16x16x32_bf16 v[132:135], v[20:23], v[48:51], v[132:135]
    ds_read_b64_tr_b16 v[84:85], v10 offset:9328
    ds_read_b64_tr_b16 v[86:87], v10 offset:13936
    v_mfma_f32_16x16x32_bf16 v[136:139], v[24:27], v[48:51], v[136:139]
    ds_read_b64_tr_b16 v[88:89], v10 offset:9360
    ds_read_b64_tr_b16 v[90:91], v10 offset:13968
    v_mfma_f32_16x16x32_bf16 v[140:143], v[20:23], v[52:55], v[140:143]
    ds_read_b64_tr_b16 v[92:93], v10 offset:9400
    v_mfma_f32_16x16x32_bf16 v[144:147], v[24:27], v[52:55], v[144:147]
    ds_read_b64_tr_b16 v[94:95], v10 offset:14008
    v_mfma_f32_16x16x32_bf16 v[148:151], v[20:23], v[56:59], v[148:151]
    ds_read_b64_tr_b16 v[96:97], v10 offset:9432
    v_mfma_f32_16x16x32_bf16 v[152:155], v[24:27], v[56:59], v[152:155]
    s_waitcnt lgkmcnt(15)
    v_mfma_f32_16x16x32_bf16 v[156:159], v[20:23], v[60:63], v[156:159]
    ds_read_b64_tr_b16 v[98:99], v10 offset:14040
    v_mfma_f32_16x16x32_bf16 v[160:163], v[24:27], v[60:63], v[160:163]
    ds_read_b64_tr_b16 v[100:101], v10 offset:9472
    v_mfma_f32_16x16x32_bf16 v[164:167], v[20:23], v[64:67], v[164:167]
    ds_read_b64_tr_b16 v[102:103], v10 offset:14080
    v_mfma_f32_16x16x32_bf16 v[168:171], v[24:27], v[64:67], v[168:171]
    ds_read_b64_tr_b16 v[104:105], v11 offset:9216
    v_mfma_f32_16x16x32_bf16 v[172:175], v[20:23], v[68:71], v[172:175]
    ds_read_b64_tr_b16 v[106:107], v11 offset:13824
    v_mfma_f32_16x16x32_bf16 v[176:179], v[24:27], v[68:71], v[176:179]
    s_barrier
    s_waitcnt lgkmcnt(12)
    v_mfma_f32_16x16x32_bf16 v[108:111], v[28:31], v[72:75], v[108:111]
    v_add_u32 v12, 34816, v12
    v_add_u32 v13, 34816, v13
    v_mfma_f32_16x16x32_bf16 v[112:115], v[32:35], v[72:75], v[112:115]
    v_add_u32 v14, 34816, v14
    v_add_u32 v15, 34816, v15
    v_mfma_f32_16x16x32_bf16 v[116:119], v[28:31], v[76:79], v[116:119]
    v_add_u32 v10, 34816, v10
    v_add_u32 v11, 34816, v11
    v_mfma_f32_16x16x32_bf16 v[120:123], v[32:35], v[76:79], v[120:123]
    ds_read_b64 v[20:21], v12 offset:0
    ds_read_b64 v[22:23], v13 offset:0
    v_mfma_f32_16x16x32_bf16 v[124:127], v[28:31], v[80:83], v[124:127]
    ds_read_b64 v[24:25], v12 offset:2048
    ds_read_b64 v[26:27], v13 offset:2048
    v_mfma_f32_16x16x32_bf16 v[128:131], v[32:35], v[80:83], v[128:131]
    s_waitcnt lgkmcnt(10)
    v_mfma_f32_16x16x32_bf16 v[132:135], v[28:31], v[84:87], v[132:135]
    ds_read_b64_tr_b16 v[36:37], v10 offset:0
    ds_read_b64_tr_b16 v[38:39], v10 offset:4608
    v_mfma_f32_16x16x32_bf16 v[136:139], v[32:35], v[84:87], v[136:139]
    ds_read_b64_tr_b16 v[40:41], v10 offset:40
    ds_read_b64_tr_b16 v[42:43], v10 offset:4648
    v_mfma_f32_16x16x32_bf16 v[140:143], v[28:31], v[88:91], v[140:143]
    ds_read_b64_tr_b16 v[44:45], v10 offset:72
    ds_read_b64_tr_b16 v[46:47], v10 offset:4680
    v_mfma_f32_16x16x32_bf16 v[144:147], v[32:35], v[88:91], v[144:147]
    ds_read_b64_tr_b16 v[48:49], v10 offset:112
    ds_read_b64_tr_b16 v[50:51], v10 offset:4720
    v_mfma_f32_16x16x32_bf16 v[148:151], v[28:31], v[92:95], v[148:151]
    ds_read_b64_tr_b16 v[52:53], v10 offset:144
    ds_read_b64_tr_b16 v[54:55], v10 offset:4752
    v_mfma_f32_16x16x32_bf16 v[152:155], v[32:35], v[92:95], v[152:155]
    s_waitcnt lgkmcnt(14)
    v_mfma_f32_16x16x32_bf16 v[156:159], v[28:31], v[96:99], v[156:159]
    ds_read_b64_tr_b16 v[56:57], v10 offset:184
    ds_read_b64_tr_b16 v[58:59], v10 offset:4792
    v_mfma_f32_16x16x32_bf16 v[160:163], v[32:35], v[96:99], v[160:163]
    ds_read_b64_tr_b16 v[60:61], v10 offset:216
    ds_read_b64_tr_b16 v[62:63], v10 offset:4824
    v_mfma_f32_16x16x32_bf16 v[164:167], v[28:31], v[100:103], v[164:167]
    ds_read_b64_tr_b16 v[64:65], v10 offset:256
    ds_read_b64_tr_b16 v[66:67], v10 offset:4864
    v_mfma_f32_16x16x32_bf16 v[168:171], v[32:35], v[100:103], v[168:171]
    ds_read_b64_tr_b16 v[68:69], v11 offset:0
    v_mfma_f32_16x16x32_bf16 v[172:175], v[28:31], v[104:107], v[172:175]
    ds_read_b64_tr_b16 v[70:71], v11 offset:4608
    v_mfma_f32_16x16x32_bf16 v[176:179], v[32:35], v[104:107], v[176:179]
    s_waitcnt lgkmcnt(12)
    v_mfma_f32_16x16x32_bf16 v[108:111], v[20:23], v[36:39], v[108:111]
    ds_read_b64 v[28:29], v14 offset:0
    ds_read_b64 v[30:31], v15 offset:0
    v_mfma_f32_16x16x32_bf16 v[112:115], v[24:27], v[36:39], v[112:115]
    ds_read_b64 v[32:33], v14 offset:2048
    ds_read_b64 v[34:35], v15 offset:2048
    v_mfma_f32_16x16x32_bf16 v[116:119], v[20:23], v[40:43], v[116:119]
    ds_read_b64_tr_b16 v[72:73], v10 offset:9216
    ds_read_b64_tr_b16 v[74:75], v10 offset:13824
    v_mfma_f32_16x16x32_bf16 v[120:123], v[24:27], v[40:43], v[120:123]
    ds_read_b64_tr_b16 v[76:77], v10 offset:9256
    ds_read_b64_tr_b16 v[78:79], v10 offset:13864
    v_mfma_f32_16x16x32_bf16 v[124:127], v[20:23], v[44:47], v[124:127]
    ds_read_b64_tr_b16 v[80:81], v10 offset:9288
    ds_read_b64_tr_b16 v[82:83], v10 offset:13896
    v_mfma_f32_16x16x32_bf16 v[128:131], v[24:27], v[44:47], v[128:131]
    s_waitcnt lgkmcnt(15)
    v_mfma_f32_16x16x32_bf16 v[132:135], v[20:23], v[48:51], v[132:135]
    ds_read_b64_tr_b16 v[84:85], v10 offset:9328
    ds_read_b64_tr_b16 v[86:87], v10 offset:13936
    v_mfma_f32_16x16x32_bf16 v[136:139], v[24:27], v[48:51], v[136:139]
    ds_read_b64_tr_b16 v[88:89], v10 offset:9360
    ds_read_b64_tr_b16 v[90:91], v10 offset:13968
    v_mfma_f32_16x16x32_bf16 v[140:143], v[20:23], v[52:55], v[140:143]
    ds_read_b64_tr_b16 v[92:93], v10 offset:9400
    v_mfma_f32_16x16x32_bf16 v[144:147], v[24:27], v[52:55], v[144:147]
    ds_read_b64_tr_b16 v[94:95], v10 offset:14008
    v_mfma_f32_16x16x32_bf16 v[148:151], v[20:23], v[56:59], v[148:151]
    ds_read_b64_tr_b16 v[96:97], v10 offset:9432
    v_mfma_f32_16x16x32_bf16 v[152:155], v[24:27], v[56:59], v[152:155]
    s_waitcnt lgkmcnt(15)
    v_mfma_f32_16x16x32_bf16 v[156:159], v[20:23], v[60:63], v[156:159]
    ds_read_b64_tr_b16 v[98:99], v10 offset:14040
    v_mfma_f32_16x16x32_bf16 v[160:163], v[24:27], v[60:63], v[160:163]
    ds_read_b64_tr_b16 v[100:101], v10 offset:9472
    v_mfma_f32_16x16x32_bf16 v[164:167], v[20:23], v[64:67], v[164:167]
    ds_read_b64_tr_b16 v[102:103], v10 offset:14080
    v_mfma_f32_16x16x32_bf16 v[168:171], v[24:27], v[64:67], v[168:171]
    ds_read_b64_tr_b16 v[104:105], v11 offset:9216
    v_mfma_f32_16x16x32_bf16 v[172:175], v[20:23], v[68:71], v[172:175]
    ds_read_b64_tr_b16 v[106:107], v11 offset:13824
    v_mfma_f32_16x16x32_bf16 v[176:179], v[24:27], v[68:71], v[176:179]
    s_cmp_lg_u32 s36, 1
    s_cbranch_scc1 ZS_m_21
    buffer_load_dword v18, v16, s[56:59], 0 offen sc0 sc1
ZS_m_21:
    s_barrier
    s_waitcnt lgkmcnt(12)
    v_mfma_f32_16x16x32_bf16 v[108:111], v[28:31], v[72:75], v[108:111]
    v_subrev_u32 v12, 104448, v12
    v_subrev_u32 v13, 104448, v13
    v_mfma_f32_16x16x32_bf16 v[112:115], v[32:35], v[72:75], v[112:115]
    v_subrev_u32 v14, 104448, v14
    v_subrev_u32 v15, 104448, v15
    v_mfma_f32_16x16x32_bf16 v[116:119], v[28:31], v[76:79], v[116:119]
    v_subrev_u32 v10, 104448, v10
    v_subrev_u32 v11, 104448, v11
    v_mfma_f32_16x16x32_bf16 v[120:123], v[32:35], v[76:79], v[120:123]
    ds_read_b64 v[20:21], v12 offset:0
    ds_read_b64 v[22:23], v13 offset:0
    v_mfma_f32_16x16x32_bf16 v[124:127], v[28:31], v[80:83], v[124:127]
    ds_read_b64 v[24:25], v12 offset:2048
    ds_read_b64 v[26:27], v13 offset:2048
    v_mfma_f32_16x16x32_bf16 v[128:131], v[32:35], v[80:83], v[128:131]
    s_waitcnt lgkmcnt(10)
    v_mfma_f32_16x16x32_bf16 v[132:135], v[28:31], v[84:87], v[132:135]
    ds_read_b64_tr_b16 v[36:37], v10 offset:0
    ds_read_b64_tr_b16 v[38:39], v10 offset:4608
    v_mfma_f32_16x16x32_bf16 v[136:139], v[32:35], v[84:87], v[136:139]
    ds_read_b64_tr_b16 v[40:41], v10 offset:40
    ds_read_b64_tr_b16 v[42:43], v10 offset:4648
    v_mfma_f32_16x16x32_bf16 v[140:143], v[28:31], v[88:91], v[140:143]
    ds_read_b64_tr_b16 v[44:45], v10 offset:72
    ds_read_b64_tr_b16 v[46:47], v10 offset:4680
    v_mfma_f32_16x16x32_bf16 v[144:147], v[32:35], v[88:91], v[144:147]
    ds_read_b64_tr_b16 v[48:49], v10 offset:112
    ds_read_b64_tr_b16 v[50:51], v10 offset:4720
    v_mfma_f32_16x16x32_bf16 v[148:151], v[28:31], v[92:95], v[148:151]
    ds_read_b64_tr_b16 v[52:53], v10 offset:144
    ds_read_b64_tr_b16 v[54:55], v10 offset:4752
    v_mfma_f32_16x16x32_bf16 v[152:155], v[32:35], v[92:95], v[152:155]
    s_waitcnt lgkmcnt(14)
    v_mfma_f32_16x16x32_bf16 v[156:159], v[28:31], v[96:99], v[156:159]
    ds_read_b64_tr_b16 v[56:57], v10 offset:184
    ds_read_b64_tr_b16 v[58:59], v10 offset:4792
    v_mfma_f32_16x16x32_bf16 v[160:163], v[32:35], v[96:99], v[160:163]
    ds_read_b64_tr_b16 v[60:61], v10 offset:216
    ds_read_b64_tr_b16 v[62:63], v10 offset:4824
    v_mfma_f32_16x16x32_bf16 v[164:167], v[28:31], v[100:103], v[164:167]
    ds_read_b64_tr_b16 v[64:65], v10 offset:256
    ds_read_b64_tr_b16 v[66:67], v10 offset:4864
    v_mfma_f32_16x16x32_bf16 v[168:171], v[32:35], v[100:103], v[168:171]
    ds_read_b64_tr_b16 v[68:69], v11 offset:0
    v_mfma_f32_16x16x32_bf16 v[172:175], v[28:31], v[104:107], v[172:175]
    ds_read_b64_tr_b16 v[70:71], v11 offset:4608
    v_mfma_f32_16x16x32_bf16 v[176:179], v[32:35], v[104:107], v[176:179]
    s_sub_u32 s36, s36, 1
    s_cmp_lg_u32 s36, 0
    s_cbranch_scc1 CL_m_20
    s_waitcnt vmcnt(0)
    v_cmp_gt_u32 vcc, 64, v18
    s_mov_b32 s31, 0
    s_nop 3
    s_cbranch_vccz ZOK_m_22
    s_mov_b32 s37, 0x40000
POLL_m_23:
    buffer_load_dword v18, v16, s[56:59], s31 offen sc0 sc1
    s_waitcnt vmcnt(0)
    v_cmp_gt_u32 vcc, 64, v18
    s_sub_u32 s37, s37, 1
    s_cmp_eq_u32 s37, 0
    s_cbranch_scc1 GO_m_24
    s_cbranch_vccz GO_m_24
    s_sleep 1
    s_branch POLL_m_23
GO_m_24:
ZOK_m_22:
    v_lshlrev_b32 v16, 2, v4
    v_lshrrev_b32 v17, 2, v4
    v_mul_u32_u24 v17, 128, v17
    v_add_u32 v17, v17, v16
    v_lshlrev_b32 v18, 4, v3
    buffer_load_dwordx4 v[216:219], v18, s[20:23], s49 offen offset:0 sc1
    buffer_load_dwordx4 v[224:227], v18, s[20:23], s49 offen offset:64 sc1
    s_add_u32 s49, s49, 8192
    buffer_load_dwordx4 v[220:223], v18, s[20:23], s49 offen offset:0 sc1
    buffer_load_dwordx4 v[228:231], v18, s[20:23], s49 offen offset:64 sc1
    buffer_load_dword v180, v16, s[20:23], s51 offen offset:0 sc1
    buffer_load_dword v181, v16, s[20:23], s51 offen offset:80 sc1
    buffer_load_dword v182, v16, s[20:23], s51 offen offset:144 sc1
    buffer_load_dword v183, v16, s[20:23], s51 offen offset:224 sc1
    buffer_load_dword v184, v16, s[20:23], s51 offen offset:288 sc1
    buffer_load_dword v185, v16, s[20:23], s51 offen offset:368 sc1
    buffer_load_dword v186, v16, s[20:23], s51 offen offset:432 sc1
    buffer_load_dword v187, v16, s[20:23], s51 offen offset:512 sc1
    buffer_load_dword v188, v17, s[20:23], s51 offen offset:64 sc1
    s_waitcnt lgkmcnt(12)
    v_mfma_f32_16x16x32_bf16 v[108:111], v[20:23], v[36:39], v[108:111]
    ds_read_b64 v[28:29], v14 offset:0
    ds_read_b64 v[30:31], v15 offset:0
    v_mfma_f32_16x16x32_bf16 v[112:115], v[24:27], v[36:39], v[112:115]
    ds_read_b64 v[32:33], v14 offset:2048
    ds_read_b64 v[34:35], v15 offset:2048
    v_mfma_f32_16x16x32_bf16 v[116:119], v[20:23], v[40:43], v[116:119]
    ds_read_b64_tr_b16 v[72:73], v10 offset:9216
    ds_read_b64_tr_b16 v[74:75], v10 offset:13824
    v_mfma_f32_16x16x32_bf16 v[120:123], v[24:27], v[40:43], v[120:123]
    ds_read_b64_tr_b16 v[76:77], v10 offset:9256
    ds_read_b64_tr_b16 v[78:79], v10 offset:13864
    v_mfma_f32_16x16x32_bf16 v[124:127], v[20:23], v[44:47], v[124:127]
    ds_read_b64_tr_b16 v[80:81], v10 offset:9288
    ds_read_b64_tr_b16 v[82:83], v10 offset:13896
    v_mfma_f32_16x16x32_bf16 v[128:131], v[24:27], v[44:47], v[128:131]
    s_waitcnt lgkmcnt(15)
    v_mfma_f32_16x16x32_bf16 v[132:135], v[20:23], v[48:51], v[132:135]
    ds_read_b64_tr_b16 v[84:85], v10 offset:9328
    ds_read_b64_tr_b16 v[86:87], v10 offset:13936
    v_mfma_f32_16x16x32_bf16 v[136:139], v[24:27], v[48:51], v[136:139]
    ds_read_b64_tr_b16 v[88:89], v10 offset:9360
    ds_read_b64_tr_b16 v[90:91], v10 offset:13968
    v_mfma_f32_16x16x32_bf16 v[140:143], v[20:23], v[52:55], v[140:143]
    ds_read_b64_tr_b16 v[92:93], v10 offset:9400
    v_mfma_f32_16x16x32_bf16 v[144:147], v[24:27], v[52:55], v[144:147]
    ds_read_b64_tr_b16 v[94:95], v10 offset:14008
    v_mfma_f32_16x16x32_bf16 v[148:151], v[20:23], v[56:59], v[148:151]
    ds_read_b64_tr_b16 v[96:97], v10 offset:9432
    v_mfma_f32_16x16x32_bf16 v[152:155], v[24:27], v[56:59], v[152:155]
    s_waitcnt lgkmcnt(15)
    v_mfma_f32_16x16x32_bf16 v[156:159], v[20:23], v[60:63], v[156:159]
    ds_read_b64_tr_b16 v[98:99], v10 offset:14040
    v_mfma_f32_16x16x32_bf16 v[160:163], v[24:27], v[60:63], v[160:163]
    ds_read_b64_tr_b16 v[100:101], v10 offset:9472
    v_mfma_f32_16x16x32_bf16 v[164:167], v[20:23], v[64:67], v[164:167]
    ds_read_b64_tr_b16 v[102:103], v10 offset:14080
    v_mfma_f32_16x16x32_bf16 v[168:171], v[24:27], v[64:67], v[168:171]
    ds_read_b64_tr_b16 v[104:105], v11 offset:9216
    v_mfma_f32_16x16x32_bf16 v[172:175], v[20:23], v[68:71], v[172:175]
    ds_read_b64_tr_b16 v[106:107], v11 offset:13824
    v_mfma_f32_16x16x32_bf16 v[176:179], v[24:27], v[68:71], v[176:179]
    s_waitcnt lgkmcnt(12)
    v_mfma_f32_16x16x32_bf16 v[108:111], v[28:31], v[72:75], v[108:111]
    v_mfma_f32_16x16x32_bf16 v[112:115], v[32:35], v[72:75], v[112:115]
    v_mfma_f32_16x16x32_bf16 v[116:119], v[28:31], v[76:79], v[116:119]
    v_mfma_f32_16x16x32_bf16 v[120:123], v[32:35], v[76:79], v[120:123]
    v_mfma_f32_16x16x32_bf16 v[124:127], v[28:31], v[80:83], v[124:127]
    v_mfma_f32_16x16x32_bf16 v[128:131], v[32:35], v[80:83], v[128:131]
    s_waitcnt lgkmcnt(6)
    v_mfma_f32_16x16x32_bf16 v[132:135], v[28:31], v[84:87], v[132:135]
    v_mfma_f32_16x16x32_bf16 v[136:139], v[32:35], v[84:87], v[136:139]
    v_mfma_f32_16x16x32_bf16 v[140:143], v[28:31], v[88:91], v[140:143]
    v_mfma_f32_16x16x32_bf16 v[144:147], v[32:35], v[88:91], v[144:147]
    v_mfma_f32_16x16x32_bf16 v[148:151], v[28:31], v[92:95], v[148:151]
    v_mfma_f32_16x16x32_bf16 v[152:155], v[32:35], v[92:95], v[152:155]
    s_waitcnt lgkmcnt(0)
    v_mfma_f32_16x16x32_bf16 v[156:159], v[28:31], v[96:99], v[156:159]
    v_mfma_f32_16x16x32_bf16 v[160:163], v[32:35], v[96:99], v[160:163]
    v_mfma_f32_16x16x32_bf16 v[164:167], v[28:31], v[100:103], v[164:167]
    v_mfma_f32_16x16x32_bf16 v[168:171], v[32:35], v[100:103], v[168:171]
    v_mfma_f32_16x16x32_bf16 v[172:175], v[28:31], v[104:107], v[172:175]
    v_mfma_f32_16x16x32_bf16 v[176:179], v[32:35], v[104:107], v[176:179]
    v_lshlrev_b32 v10, 4, v1
    s_waitcnt vmcnt(0)
    v_pk_fma_f32 v[108:109], v[216:217], v[180:181], v[108:109] op_sel:[0,0,0] op_sel_hi:[1,0,1] neg_lo:[1,0,0] neg_hi:[1,0,0]
    v_pk_fma_f32 v[110:111], v[218:219], v[180:181], v[110:111] op_sel:[0,0,0] op_sel_hi:[1,0,1] neg_lo:[1,0,0] neg_hi:[1,0,0]
    v_pk_fma_f32 v[112:113], v[224:225], v[180:181], v[112:113] op_sel:[0,0,0] op_sel_hi:[1,0,1] neg_lo:[1,0,0] neg_hi:[1,0,0]
    v_pk_fma_f32 v[114:115], v[226:227], v[180:181], v[114:115] op_sel:[0,0,0] op_sel_hi:[1,0,1] neg_lo:[1,0,0] neg_hi:[1,0,0]
    v_pk_mul_f32 v[108:109], v[108:109], v[220:221]
    v_pk_mul_f32 v[110:111], v[110:111], v[222:223]
    v_pk_mul_f32 v[112:113], v[112:113], v[228:229]
    v_pk_mul_f32 v[114:115], v[114:115], v[230:231]
    v_cvt_pk_bf16_f32 v20, v108, v109
    v_cvt_pk_bf16_f32 v21, v110, v111
    v_cvt_pk_bf16_f32 v22, v112, v113
    v_cvt_pk_bf16_f32 v23, v114, v115
    v_pk_fma_f32 v[116:117], v[216:217], v[180:181], v[116:117] op_sel:[0,1,0] op_sel_hi:[1,1,1] neg_lo:[1,0,0] neg_hi:[1,0,0]
    v_pk_fma_f32 v[118:119], v[218:219], v[180:181], v[118:119] op_sel:[0,1,0] op_sel_hi:[1,1,1] neg_lo:[1,0,0] neg_hi:[1,0,0]
    v_pk_fma_f32 v[120:121], v[224:225], v[180:181], v[120:121] op_sel:[0,1,0] op_sel_hi:[1,1,1] neg_lo:[1,0,0] neg_hi:[1,0,0]
    v_pk_fma_f32 v[122:123], v[226:227], v[180:181], v[122:123] op_sel:[0,1,0] op_sel_hi:[1,1,1] neg_lo:[1,0,0] neg_hi:[1,0,0]
    v_pk_mul_f32 v[116:117], v[116:117], v[220:221]
    v_pk_mul_f32 v[118:119], v[118:119], v[222:223]
    v_pk_mul_f32 v[120:121], v[120:121], v[228:229]
    v_pk_mul_f32 v[122:123], v[122:123], v[230:231]
    v_cvt_pk_bf16_f32 v24, v116, v117
    v_cvt_pk_bf16_f32 v25, v118, v119
    v_cvt_pk_bf16_f32 v26, v120, v121
    v_cvt_pk_bf16_f32 v27, v122, v123
    v_permlane32_swap_b32 v20, v22
    v_permlane32_swap_b32 v21, v23
    buffer_store_dwordx4 v[20:23], v10, s[20:23], s50 offen sc0 sc1
    s_add_u32 s50, s50, 66560
    v_pk_fma_f32 v[124:125], v[216:217], v[182:183], v[124:125] op_sel:[0,0,0] op_sel_hi:[1,0,1] neg_lo:[1,0,0] neg_hi:[1,0,0]
    v_pk_fma_f32 v[126:127], v[218:219], v[182:183], v[126:127] op_sel:[0,0,0] op_sel_hi:[1,0,1] neg_lo:[1,0,0] neg_hi:[1,0,0]
    v_pk_fma_f32 v[128:129], v[224:225], v[182:183], v[128:129] op_sel:[0,0,0] op_sel_hi:[1,0,1] neg_lo:[1,0,0] neg_hi:[1,0,0]
    v_pk_fma_f32 v[130:131], v[226:227], v[182:183], v[130:131] op_sel:[0,0,0] op_sel_hi:[1,0,1] neg_lo:[1,0,0] neg_hi:[1,0,0]
    v_pk_mul_f32 v[124:125], v[124:125], v[220:221]
    v_pk_mul_f32 v[126:127], v[126:127], v[222:223]
    v_pk_mul_f32 v[128:129], v[128:129], v[228:229]
    v_pk_mul_f32 v[130:131], v[130:131], v[230:231]
    v_cvt_pk_bf16_f32 v28, v124, v125
    v_cvt_pk_bf16_f32 v29, v126, v127
    v_cvt_pk_bf16_f32 v30, v128, v129
    v_cvt_pk_bf16_f32 v31, v130, v131
    v_permlane32_swap_b32 v24, v26
    v_permlane32_swap_b32 v25, v27
    buffer_store_dwordx4 v[24:27], v10, s[20:23], s50 offen sc0 sc1
    s_add_u32 s50, s50, 66560
    v_pk_fma_f32 v[132:133], v[216:217], v[182:183], v[132:133] op_sel:[0,1,0] op_sel_hi:[1,1,1] neg_lo:[1,0,0] neg_hi:[1,0,0]
    v_pk_fma_f32 v[134:135], v[218:219], v[182:183], v[134:135] op_sel:[0,1,0] op_sel_hi:[1,1,1] neg_lo:[1,0,0] neg_hi:[1,0,0]
    v_pk_fma_f32 v[136:137], v[224:225], v[182:183], v[136:137] op_sel:[0,1,0] op_sel_hi:[1,1,1] neg_lo:[1,0,0] neg_hi:[1,0,0]
    v_pk_fma_f32 v[138:139], v[226:227], v[182:183], v[138:139] op_sel:[0,1,0] op_sel_hi:[1,1,1] neg_lo:[1,0,0] neg_hi:[1,0,0]
    v_pk_mul_f32 v[132:133], v[132:133], v[220:221]
    v_pk_mul_f32 v[134:135], v[134:135], v[222:223]
    v_pk_mul_f32 v[136:137], v[136:137], v[228:229]
    v_pk_mul_f32 v[138:139], v[138:139], v[230:231]
    v_cvt_pk_bf16_f32 v32, v132, v133
    v_cvt_pk_bf16_f32 v33, v134, v135
    v_cvt_pk_bf16_f32 v34, v136, v137
    v_cvt_pk_bf16_f32 v35, v138, v139
    v_permlane32_swap_b32 v28, v30
    v_permlane32_swap_b32 v29, v31
    buffer_store_dwordx4 v[28:31], v10, s[20:23], s50 offen sc0 sc1
    s_add_u32 s50, s50, 66560
    v_pk_fma_f32 v[140:141], v[216:217], v[184:185], v[140:141] op_sel:[0,0,0] op_sel_hi:[1,0,1] neg_lo:[1,0,0] neg_hi:[1,0,0]
    v_pk_fma_f32 v[142:143], v[218:219], v[184:185], v[142:143] op_sel:[0,0,0] op_sel_hi:[1,0,1] neg_lo:[1,0,0] neg_hi:[1,0,0]
    v_pk_fma_f32 v[144:145], v[224:225], v[184:185], v[144:145] op_sel:[0,0,0] op_sel_hi:[1,0,1] neg_lo:[1,0,0] neg_hi:[1,0,0]
    v_pk_fma_f32 v[146:147], v[226:227], v[184:185], v[146:147] op_sel:[0,0,0] op_sel_hi:[1,0,1] neg_lo:[1,0,0] neg_hi:[1,0,0]
    v_pk_mul_f32 v[140:141], v[140:141], v[220:221]
    v_pk_mul_f32 v[142:143], v[142:143], v[222:223]
    v_pk_mul_f32 v[144:145], v[144:145], v[228:229]
    v_pk_mul_f32 v[146:147], v[146:147], v[230:231]
    v_cvt_pk_bf16_f32 v20, v140, v141
    v_cvt_pk_bf16_f32 v21, v142, v143
    v_cvt_pk_bf16_f32 v22, v144, v145
    v_cvt_pk_bf16_f32 v23, v146, v147
    v_permlane32_swap_b32 v32, v34
    v_permlane32_swap_b32 v33, v35
    buffer_store_dwordx4 v[32:35], v10, s[20:23], s50 offen sc0 sc1
    s_add_u32 s50, s50, 66560
    v_pk_fma_f32 v[148:149], v[216:217], v[184:185], v[148:149] op_sel:[0,1,0] op_sel_hi:[1,1,1] neg_lo:[1,0,0] neg_hi:[1,0,0]
    v_pk_fma_f32 v[150:151], v[218:219], v[184:185], v[150:151] op_sel:[0,1,0] op_sel_hi:[1,1,1] neg_lo:[1,0,0] neg_hi:[1,0,0]
    v_pk_fma_f32 v[152:153], v[224:225], v[184:185], v[152:153] op_sel:[0,1,0] op_sel_hi:[1,1,1] neg_lo:[1,0,0] neg_hi:[1,0,0]
    v_pk_fma_f32 v[154:155], v[226:227], v[184:185], v[154:155] op_sel:[0,1,0] op_sel_hi:[1,1,1] neg_lo:[1,0,0] neg_hi:[1,0,0]
    v_pk_mul_f32 v[148:149], v[148:149], v[220:221]
    v_pk_mul_f32 v[150:151], v[150:151], v[222:223]
    v_pk_mul_f32 v[152:153], v[152:153], v[228:229]
    v_pk_mul_f32 v[154:155], v[154:155], v[230:231]
    v_cvt_pk_bf16_f32 v24, v148, v149
    v_cvt_pk_bf16_f32 v25, v150, v151
    v_cvt_pk_bf16_f32 v26, v152, v153
    v_cvt_pk_bf16_f32 v27, v154, v155
    v_permlane32_swap_b32 v20, v22
    v_permlane32_swap_b32 v21, v23
    buffer_store_dwordx4 v[20:23], v10, s[20:23], s50 offen sc0 sc1
    s_add_u32 s50, s50, 66560
    v_pk_fma_f32 v[156:157], v[216:217], v[186:187], v[156:157] op_sel:[0,0,0] op_sel_hi:[1,0,1] neg_lo:[1,0,0] neg_hi:[1,0,0]
    v_pk_fma_f32 v[158:159], v[218:219], v[186:187], v[158:159] op_sel:[0,0,0] op_sel_hi:[1,0,1] neg_lo:[1,0,0] neg_hi:[1,0,0]
    v_pk_fma_f32 v[160:161], v[224:225], v[186:187], v[160:161] op_sel:[0,0,0] op_sel_hi:[1,0,1] neg_lo:[1,0,0] neg_hi:[1,0,0]
    v_pk_fma_f32 v[162:163], v[226:227], v[186:187], v[162:163] op_sel:[0,0,0] op_sel_hi:[1,0,1] neg_lo:[1,0,0] neg_hi:[1,0,0]
    v_pk_mul_f32 v[156:157], v[156:157], v[220:221]
    v_pk_mul_f32 v[158:159], v[158:159], v[222:223]
    v_pk_mul_f32 v[160:161], v[160:161], v[228:229]
    v_pk_mul_f32 v[162:163], v[162:163], v[230:231]
    v_cvt_pk_bf16_f32 v28, v156, v157
    v_cvt_pk_bf16_f32 v29, v158, v159
    v_cvt_pk_bf16_f32 v30, v160, v161
    v_cvt_pk_bf16_f32 v31, v162, v163
    v_permlane32_swap_b32 v24, v26
    v_permlane32_swap_b32 v25, v27
    buffer_store_dwordx4 v[24:27], v10, s[20:23], s50 offen sc0 sc1
    s_add_u32 s50, s50, 66560
    v_pk_fma_f32 v[164:165], v[216:217], v[186:187], v[164:165] op_sel:[0,1,0] op_sel_hi:[1,1,1] neg_lo:[1,0,0] neg_hi:[1,0,0]
    v_pk_fma_f32 v[166:167], v[218:219], v[186:187], v[166:167] op_sel:[0,1,0] op_sel_hi:[1,1,1] neg_lo:[1,0,0] neg_hi:[1,0,0]
    v_pk_fma_f32 v[168:169], v[224:225], v[186:187], v[168:169] op_sel:[0,1,0] op_sel_hi:[1,1,1] neg_lo:[1,0,0] neg_hi:[1,0,0]
    v_pk_fma_f32 v[170:171], v[226:227], v[186:187], v[170:171] op_sel:[0,1,0] op_sel_hi:[1,1,1] neg_lo:[1,0,0] neg_hi:[1,0,0]
    v_pk_mul_f32 v[164:165], v[164:165], v[220:221]
    v_pk_mul_f32 v[166:167], v[166:167], v[222:223]
    v_pk_mul_f32 v[168:169], v[168:169], v[228:229]
    v_pk_mul_f32 v[170:171], v[170:171], v[230:231]
    v_cvt_pk_bf16_f32 v32, v164, v165
    v_cvt_pk_bf16_f32 v33, v166, v167
    v_cvt_pk_bf16_f32 v34, v168, v169
    v_cvt_pk_bf16_f32 v35, v170, v171
    v_permlane32_swap_b32 v28, v30
    v_permlane32_swap_b32 v29, v31
    buffer_store_dwordx4 v[28:31], v10, s[20:23], s50 offen sc0 sc1
    s_add_u32 s50, s50, 66560
    v_pk_fma_f32 v[172:173], v[216:217], v[188:189], v[172:173] op_sel:[0,0,0] op_sel_hi:[1,0,1] neg_lo:[1,0,0] neg_hi:[1,0,0]
    v_pk_fma_f32 v[174:175], v[218:219], v[188:189], v[174:175] op_sel:[0,0,0] op_sel_hi:[1,0,1] neg_lo:[1,0,0] neg_hi:[1,0,0]
    v_pk_fma_f32 v[176:177], v[224:225], v[188:189], v[176:177] op_sel:[0,0,0] op_sel_hi:[1,0,1] neg_lo:[1,0,0] neg_hi:[1,0,0]
    v_pk_fma_f32 v[178:179], v[226:227], v[188:189], v[178:179] op_sel:[0,0,0] op_sel_hi:[1,0,1] neg_lo:[1,0,0] neg_hi:[1,0,0]
    v_pk_mul_f32 v[172:173], v[172:173], v[220:221]
    v_pk_mul_f32 v[174:175], v[174:175], v[222:223]
    v_pk_mul_f32 v[176:177], v[176:177], v[228:229]
    v_pk_mul_f32 v[178:179], v[178:179], v[230:231]
    v_cvt_pk_bf16_f32 v20, v172, v173
    v_cvt_pk_bf16_f32 v21, v174, v175
    v_cvt_pk_bf16_f32 v22, v176, v177
    v_cvt_pk_bf16_f32 v23, v178, v179
    v_permlane32_swap_b32 v32, v34
    v_permlane32_swap_b32 v33, v35
    buffer_store_dwordx4 v[32:35], v10, s[20:23], s50 offen sc0 sc1
    s_add_u32 s50, s50, 66560
    v_permlane32_swap_b32 v20, v22
    v_permlane32_swap_b32 v21, v23
    buffer_store_dwordx4 v[20:23], v10, s[20:23], s50 offen sc0 sc1
    s_add_u32 s50, s50, 66560
    v_mov_b32 v5, 0
    v_mov_b32 v6, 1
    s_waitcnt vmcnt(0)
    v_mov_b32 v7, 160768
    s_mov_b64 exec, 1
    ds_add_rtn_u32 v7, v7, v6
    s_waitcnt lgkmcnt(0)
    v_readfirstlane_b32 s31, v7
    s_nop 0
    s_cmp_lg_u32 s31, 3
    s_cbranch_scc1 NL_m_25
    buffer_store_dword v6, v5, s[20:23], s48 offen sc0 sc1
    v_mov_b32 v7, 160768
    s_waitcnt vmcnt(0)
    ds_add_u32 v7, v6
NL_m_25:
    s_mov_b64 exec, -1
    s_branch P2A_m_4
P1PF_m_10:
    s_sub_u32 s29, s2, 192
    v_lshlrev_b32 v5, 2, v1
    v_add_u32 v5, 160768, v5
    v_mov_b32 v6, 0
    s_mov_b64 exec, 0xffff
    ds_write_b32 v5, v6
    s_mov_b64 exec, -1
    v_lshrrev_b32 v6, 3, v0
    v_and_b32 v7, 7, v0
    v_lshlrev_b32 v7, 4, v7
    s_cmp_ge_u32 s29, 32
    s_cselect_b32 s30, 3456, 0
    s_cselect_b32 s31, 0, 1152
    s_add_u32 s30, s30, s31
    v_mad_u32_u24 v5, v6, s30, v7
    s_lshl_b32 s32, s29, 13
    s_add_u32 s32, s32, 20971520
    v_lshlrev_b32 v8, 4, v0
    v_mov_b32 v60, 0
    v_mov_b32 v61, 0
    v_mov_b32 v62, 0
    v_mov_b32 v63, 0
    v_mov_b32 v48, 0
    v_mov_b32 v49, 0
    v_mov_b32 v50, 0x3f803f80
    s_mul_i32 s30, s29, 73728
    s_sub_u32 s33, s29, 32
    s_lshl_b32 s31, s33, 7
    s_cmp_ge_u32 s33, 27
    s_cselect_b32 s31, 0x7000000, s31
    s_waitcnt lgkmcnt(0)
    s_mov_b32 s20, s84
    s_and_b32 s21, s85, 0xffff
    s_mov_b32 s22, 54525952
    s_mov_b32 s23, 0x20000
    s_mov_b32 s56, s82
    s_and_b32 s57, s83, 0xffff
    s_mov_b32 s58, 256
    s_mov_b32 s59, 0x20000
    s_cmp_ge_u32 s29, 32
    s_cbranch_scc1 CSW_m_26
    s_mov_b32 s12, s64
    s_and_b32 s13, s65, 0xffff
    s_mov_b32 s14, 2359296
    s_mov_b32 s15, 0x20000
    buffer_load_dwordx4 v[12:15], v5, s[12:15], s30 offen offset:0
    buffer_load_dwordx4 v[16:19], v5, s[12:15], s30 offen offset:128
    buffer_load_dwordx4 v[20:23], v5, s[12:15], s30 offen offset:256
    buffer_load_dwordx4 v[24:27], v5, s[12:15], s30 offen offset:384
    buffer_load_dwordx4 v[28:31], v5, s[12:15], s30 offen offset:512
    buffer_load_dwordx4 v[32:35], v5, s[12:15], s30 offen offset:640
    buffer_load_dwordx4 v[36:39], v5, s[12:15], s30 offen offset:768
    buffer_load_dwordx4 v[40:43], v5, s[12:15], s30 offen offset:896
    buffer_load_dwordx4 v[44:47], v5, s[12:15], s30 offen offset:1024
    buffer_store_dwordx4 v[60:63], v8, s[20:23], s32 offen sc0 sc1
    s_waitcnt vmcnt(9)
    v_dot2c_f32_bf16 v48, v12, v50
    v_dot2c_f32_bf16 v49, v12, v12
    v_dot2c_f32_bf16 v48, v13, v50
    v_dot2c_f32_bf16 v49, v13, v13
    v_dot2c_f32_bf16 v48, v14, v50
    v_dot2c_f32_bf16 v49, v14, v14
    v_dot2c_f32_bf16 v48, v15, v50
    v_dot2c_f32_bf16 v49, v15, v15
    s_waitcnt vmcnt(8)
    v_dot2c_f32_bf16 v48, v16, v50
    v_dot2c_f32_bf16 v49, v16, v16
    v_dot2c_f32_bf16 v48, v17, v50
    v_dot2c_f32_bf16 v49, v17, v17
    v_dot2c_f32_bf16 v48, v18, v50
    v_dot2c_f32_bf16 v49, v18, v18
    v_dot2c_f32_bf16 v48, v19, v50
    v_dot2c_f32_bf16 v49, v19, v19
    s_waitcnt vmcnt(7)
    v_dot2c_f32_bf16 v48, v20, v50
    v_dot2c_f32_bf16 v49, v20, v20
    v_dot2c_f32_bf16 v48, v21, v50
    v_dot2c_f32_bf16 v49, v21, v21
    v_dot2c_f32_bf16 v48, v22, v50
    v_dot2c_f32_bf16 v49, v22, v22
    v_dot2c_f32_bf16 v48, v23, v50
    v_dot2c_f32_bf16 v49, v23, v23
    s_waitcnt vmcnt(6)
    v_dot2c_f32_bf16 v48, v24, v50
    v_dot2c_f32_bf16 v49, v24, v24
    v_dot2c_f32_bf16 v48, v25, v50
    v_dot2c_f32_bf16 v49, v25, v25
    v_dot2c_f32_bf16 v48, v26, v50
    v_dot2c_f32_bf16 v49, v26, v26
    v_dot2c_f32_bf16 v48, v27, v50
    v_dot2c_f32_bf16 v49, v27, v27
    s_waitcnt vmcnt(5)
    v_dot2c_f32_bf16 v48, v28, v50
    v_dot2c_f32_bf16 v49, v28, v28
    v_dot2c_f32_bf16 v48, v29, v50
    v_dot2c_f32_bf16 v49, v29, v29
    v_dot2c_f32_bf16 v48, v30, v50
    v_dot2c_f32_bf16 v49, v30, v30
    v_dot2c_f32_bf16 v48, v31, v50
    v_dot2c_f32_bf16 v49, v31, v31
    s_waitcnt vmcnt(4)
    v_dot2c_f32_bf16 v48, v32, v50
    v_dot2c_f32_bf16 v49, v32, v32
    v_dot2c_f32_bf16 v48, v33, v50
    v_dot2c_f32_bf16 v49, v33, v33
    v_dot2c_f32_bf16 v48, v34, v50
    v_dot2c_f32_bf16 v49, v34, v34
    v_dot2c_f32_bf16 v48, v35, v50
    v_dot2c_f32_bf16 v49, v35, v35
    s_waitcnt vmcnt(3)
    v_dot2c_f32_bf16 v48, v36, v50
    v_dot2c_f32_bf16 v49, v36, v36
    v_dot2c_f32_bf16 v48, v37, v50
    v_dot2c_f32_bf16 v49, v37, v37
    v_dot2c_f32_bf16 v48, v38, v50
    v_dot2c_f32_bf16 v49, v38, v38
    v_dot2c_f32_bf16 v48, v39, v50
    v_dot2c_f32_bf16 v49, v39, v39
    s_waitcnt vmcnt(2)
    v_dot2c_f32_bf16 v48, v40, v50
    v_dot2c_f32_bf16 v49, v40, v40
    v_dot2c_f32_bf16 v48, v41, v50
    v_dot2c_f32_bf16 v49, v41, v41
    v_dot2c_f32_bf16 v48, v42, v50
    v_dot2c_f32_bf16 v49, v42, v42
    v_dot2c_f32_bf16 v48, v43, v50
    v_dot2c_f32_bf16 v49, v43, v43
    s_waitcnt vmcnt(1)
    v_dot2c_f32_bf16 v48, v44, v50
    v_dot2c_f32_bf16 v49, v44, v44
    v_dot2c_f32_bf16 v48, v45, v50
    v_dot2c_f32_bf16 v49, v45, v45
    v_dot2c_f32_bf16 v48, v46, v50
    v_dot2c_f32_bf16 v49, v46, v46
    v_dot2c_f32_bf16 v48, v47, v50
    v_dot2c_f32_bf16 v49, v47, v47
    s_nop 2
    v_add_f32_dpp v48, v48, v48 quad_perm:[1,0,3,2] row_mask:0xf bank_mask:0xf
    v_add_f32_dpp v49, v49, v49 quad_perm:[1,0,3,2] row_mask:0xf bank_mask:0xf
    s_nop 0
    v_add_f32_dpp v48, v48, v48 quad_perm:[2,3,0,1] row_mask:0xf bank_mask:0xf
    v_add_f32_dpp v49, v49, v49 quad_perm:[2,3,0,1] row_mask:0xf bank_mask:0xf
    s_nop 0
    v_add_f32_dpp v48, v48, v48 row_half_mirror row_mask:0xf bank_mask:0xf
    v_add_f32_dpp v49, v49, v49 row_half_mirror row_mask:0xf bank_mask:0xf
    s_mov_b32 s30, 0x3ae38e39
    v_mul_f32 v48, s30, v48
    v_mul_f32 v49, s30, v49
    v_fma_f32 v49, -v48, v48, v49
    v_max_f32 v49, 0, v49
    v_cvt_pk_bf16_f32 v48, v48, v48
    v_and_b32 v48, 0xffff0000, v48
    v_cvt_pk_bf16_f32 v49, v49, v49
    v_and_b32 v49, 0xffff0000, v49
    v_add_f32 v49, 0x3727c5ac, v49
    v_cvt_pk_bf16_f32 v49, v49, v49
    v_and_b32 v49, 0xffff0000, v49
    v_sqrt_f32 v49, v49
    s_nop 0
    v_cvt_pk_bf16_f32 v49, v49, v49
    v_and_b32 v49, 0xffff0000, v49
    v_rcp_f32 v49, v49
    s_lshl_b32 s30, s29, 8
    s_add_u32 s30, s30, 23068672
    s_add_u32 s31, s30, 8192
    v_lshlrev_b32 v5, 2, v6
    v_and_b32 v8, 7, v0
    v_cmp_eq_u32 vcc, 0, v8
    s_nop 0
    s_and_saveexec_b64 s[62:63], vcc
    buffer_store_dword v48, v5, s[20:23], s30 offen sc0 sc1
    buffer_store_dword v49, v5, s[20:23], s31 offen sc0 sc1
    s_mov_b64 exec, -1
    s_branch DN_m_29
CSW_m_26:
    s_mov_b32 s16, s66
    s_and_b32 s17, s67, 0xffff
    s_mov_b32 s18, 1990656
    s_mov_b32 s19, 0x20000
    buffer_load_dwordx4 v[12:15], v5, s[16:19], s31 offen
    s_add_u32 s31, s31, 221184
    buffer_load_dwordx4 v[16:19], v5, s[16:19], s31 offen
    s_add_u32 s31, s31, 221184
    buffer_load_dwordx4 v[20:23], v5, s[16:19], s31 offen
    s_add_u32 s31, s31, 221184
    buffer_load_dwordx4 v[24:27], v5, s[16:19], s31 offen
    s_add_u32 s31, s31, 221184
    buffer_load_dwordx4 v[28:31], v5, s[16:19], s31 offen
    s_add_u32 s31, s31, 221184
    buffer_load_dwordx4 v[32:35], v5, s[16:19], s31 offen
    s_add_u32 s31, s31, 221184
    buffer_load_dwordx4 v[36:39], v5, s[16:19], s31 offen
    s_add_u32 s31, s31, 221184
    buffer_load_dwordx4 v[40:43], v5, s[16:19], s31 offen
    s_add_u32 s31, s31, 221184
    buffer_load_dwordx4 v[44:47], v5, s[16:19], s31 offen
    s_add_u32 s31, s31, 221184
    buffer_store_dwordx4 v[60:63], v8, s[20:23], s32 offen sc0 sc1
    s_waitcnt vmcnt(9)
    v_lshlrev_b32 v52, 16, v12
    v_and_b32 v53, 0xffff0000, v12
    v_lshlrev_b32 v54, 16, v13
    v_and_b32 v55, 0xffff0000, v13
    v_lshlrev_b32 v56, 16, v14
    v_and_b32 v57, 0xffff0000, v14
    v_lshlrev_b32 v58, 16, v15
    v_and_b32 v59, 0xffff0000, v15
    s_waitcnt vmcnt(8)
    v_lshlrev_b32 v48, 16, v16
    v_and_b32 v49, 0xffff0000, v16
    v_pk_add_f32 v[52:53], v[52:53], v[48:49]
    v_lshlrev_b32 v48, 16, v17
    v_and_b32 v49, 0xffff0000, v17
    v_pk_add_f32 v[54:55], v[54:55], v[48:49]
    v_lshlrev_b32 v48, 16, v18
    v_and_b32 v49, 0xffff0000, v18
    v_pk_add_f32 v[56:57], v[56:57], v[48:49]
    v_lshlrev_b32 v48, 16, v19
    v_and_b32 v49, 0xffff0000, v19
    v_pk_add_f32 v[58:59], v[58:59], v[48:49]
    s_waitcnt vmcnt(7)
    v_lshlrev_b32 v48, 16, v20
    v_and_b32 v49, 0xffff0000, v20
    v_pk_add_f32 v[52:53], v[52:53], v[48:49]
    v_lshlrev_b32 v48, 16, v21
    v_and_b32 v49, 0xffff0000, v21
    v_pk_add_f32 v[54:55], v[54:55], v[48:49]
    v_lshlrev_b32 v48, 16, v22
    v_and_b32 v49, 0xffff0000, v22
    v_pk_add_f32 v[56:57], v[56:57], v[48:49]
    v_lshlrev_b32 v48, 16, v23
    v_and_b32 v49, 0xffff0000, v23
    v_pk_add_f32 v[58:59], v[58:59], v[48:49]
    s_waitcnt vmcnt(6)
    v_lshlrev_b32 v48, 16, v24
    v_and_b32 v49, 0xffff0000, v24
    v_pk_add_f32 v[52:53], v[52:53], v[48:49]
    v_lshlrev_b32 v48, 16, v25
    v_and_b32 v49, 0xffff0000, v25
    v_pk_add_f32 v[54:55], v[54:55], v[48:49]
    v_lshlrev_b32 v48, 16, v26
    v_and_b32 v49, 0xffff0000, v26
    v_pk_add_f32 v[56:57], v[56:57], v[48:49]
    v_lshlrev_b32 v48, 16, v27
    v_and_b32 v49, 0xffff0000, v27
    v_pk_add_f32 v[58:59], v[58:59], v[48:49]
    s_waitcnt vmcnt(5)
    v_lshlrev_b32 v48, 16, v28
    v_and_b32 v49, 0xffff0000, v28
    v_pk_add_f32 v[52:53], v[52:53], v[48:49]
    v_lshlrev_b32 v48, 16, v29
    v_and_b32 v49, 0xffff0000, v29
    v_pk_add_f32 v[54:55], v[54:55], v[48:49]
    v_lshlrev_b32 v48, 16, v30
    v_and_b32 v49, 0xffff0000, v30
    v_pk_add_f32 v[56:57], v[56:57], v[48:49]
    v_lshlrev_b32 v48, 16, v31
    v_and_b32 v49, 0xffff0000, v31
    v_pk_add_f32 v[58:59], v[58:59], v[48:49]
    s_waitcnt vmcnt(4)
    v_lshlrev_b32 v48, 16, v32
    v_and_b32 v49, 0xffff0000, v32
    v_pk_add_f32 v[52:53], v[52:53], v[48:49]
    v_lshlrev_b32 v48, 16, v33
    v_and_b32 v49, 0xffff0000, v33
    v_pk_add_f32 v[54:55], v[54:55], v[48:49]
    v_lshlrev_b32 v48, 16, v34
    v_and_b32 v49, 0xffff0000, v34
    v_pk_add_f32 v[56:57], v[56:57], v[48:49]
    v_lshlrev_b32 v48, 16, v35
    v_and_b32 v49, 0xffff0000, v35
    v_pk_add_f32 v[58:59], v[58:59], v[48:49]
    s_waitcnt vmcnt(3)
    v_lshlrev_b32 v48, 16, v36
    v_and_b32 v49, 0xffff0000, v36
    v_pk_add_f32 v[52:53], v[52:53], v[48:49]
    v_lshlrev_b32 v48, 16, v37
    v_and_b32 v49, 0xffff0000, v37
    v_pk_add_f32 v[54:55], v[54:55], v[48:49]
    v_lshlrev_b32 v48, 16, v38
    v_and_b32 v49, 0xffff0000, v38
    v_pk_add_f32 v[56:57], v[56:57], v[48:49]
    v_lshlrev_b32 v48, 16, v39
    v_and_b32 v49, 0xffff0000, v39
    v_pk_add_f32 v[58:59], v[58:59], v[48:49]
    s_waitcnt vmcnt(2)
    v_lshlrev_b32 v48, 16, v40
    v_and_b32 v49, 0xffff0000, v40
    v_pk_add_f32 v[52:53], v[52:53], v[48:49]
    v_lshlrev_b32 v48, 16, v41
    v_and_b32 v49, 0xffff0000, v41
    v_pk_add_f32 v[54:55], v[54:55], v[48:49]
    v_lshlrev_b32 v48, 16, v42
    v_and_b32 v49, 0xffff0000, v42
    v_pk_add_f32 v[56:57], v[56:57], v[48:49]
    v_lshlrev_b32 v48, 16, v43
    v_and_b32 v49, 0xffff0000, v43
    v_pk_add_f32 v[58:59], v[58:59], v[48:49]
    s_waitcnt vmcnt(1)
    v_lshlrev_b32 v48, 16, v44
    v_and_b32 v49, 0xffff0000, v44
    v_pk_add_f32 v[52:53], v[52:53], v[48:49]
    v_lshlrev_b32 v48, 16, v45
    v_and_b32 v49, 0xffff0000, v45
    v_pk_add_f32 v[54:55], v[54:55], v[48:49]
    v_lshlrev_b32 v48, 16, v46
    v_and_b32 v49, 0xffff0000, v46
    v_pk_add_f32 v[56:57], v[56:57], v[48:49]
    v_lshlrev_b32 v48, 16, v47
    v_and_b32 v49, 0xffff0000, v47
    v_pk_add_f32 v[58:59], v[58:59], v[48:49]
    v_add_f32_dpp v52, v52, v52 row_ror:8 row_mask:0xf bank_mask:0xf
    v_add_f32_dpp v53, v53, v53 row_ror:8 row_mask:0xf bank_mask:0xf
    v_add_f32_dpp v54, v54, v54 row_ror:8 row_mask:0xf bank_mask:0xf
    v_add_f32_dpp v55, v55, v55 row_ror:8 row_mask:0xf bank_mask:0xf
    v_add_f32_dpp v56, v56, v56 row_ror:8 row_mask:0xf bank_mask:0xf
    v_add_f32_dpp v57, v57, v57 row_ror:8 row_mask:0xf bank_mask:0xf
    v_add_f32_dpp v58, v58, v58 row_ror:8 row_mask:0xf bank_mask:0xf
    v_add_f32_dpp v59, v59, v59 row_ror:8 row_mask:0xf bank_mask:0xf
    v_mov_b32 v12, v52
    v_mov_b32 v13, v53
    v_mov_b32 v14, v54
    v_mov_b32 v15, v55
    v_mov_b32 v16, v56
    v_mov_b32 v17, v57
    v_mov_b32 v18, v58
    v_mov_b32 v19, v59
    v_permlane16_swap_b32 v52, v12
    v_permlane16_swap_b32 v53, v13
    v_permlane16_swap_b32 v54, v14
    v_permlane16_swap_b32 v55, v15
    v_permlane16_swap_b32 v56, v16
    v_permlane16_swap_b32 v57, v17
    v_permlane16_swap_b32 v58, v18
    v_permlane16_swap_b32 v59, v19
    v_add_f32 v52, v52, v12
    v_add_f32 v53, v53, v13
    v_add_f32 v54, v54, v14
    v_add_f32 v55, v55, v15
    v_add_f32 v56, v56, v16
    v_add_f32 v57, v57, v17
    v_add_f32 v58, v58, v18
    v_add_f32 v59, v59, v19
    v_mov_b32 v12, v52
    v_mov_b32 v13, v53
    v_mov_b32 v14, v54
    v_mov_b32 v15, v55
    v_mov_b32 v16, v56
    v_mov_b32 v17, v57
    v_mov_b32 v18, v58
    v_mov_b32 v19, v59
    v_permlane32_swap_b32 v52, v12
    v_permlane32_swap_b32 v53, v13
    v_permlane32_swap_b32 v54, v14
    v_permlane32_swap_b32 v55, v15
    v_permlane32_swap_b32 v56, v16
    v_permlane32_swap_b32 v57, v17
    v_permlane32_swap_b32 v58, v18
    v_permlane32_swap_b32 v59, v19
    v_add_f32 v52, v52, v12
    v_add_f32 v53, v53, v13
    v_add_f32 v54, v54, v14
    v_add_f32 v55, v55, v15
    v_add_f32 v56, v56, v16
    v_add_f32 v57, v57, v17
    v_add_f32 v58, v58, v18
    v_add_f32 v59, v59, v19
    s_lshl_b32 s30, s28, 8
    v_lshlrev_b32 v5, 5, v1
    v_add_u32 v5, s30, v5
    s_mov_b64 exec, 0xff
    ds_write_b128 v5, v[52:55]
    ds_write_b128 v5, v[56:59] offset:16
    s_mov_b64 exec, -1
    s_waitcnt lgkmcnt(0)
    s_barrier
    s_cmp_lg_u32 s28, 0
    s_cbranch_scc1 DN_m_29
    v_lshlrev_b32 v5, 2, v1
    ds_read_b32 v12, v5 offset:0
    ds_read_b32 v13, v5 offset:256
    ds_read_b32 v14, v5 offset:512
    ds_read_b32 v15, v5 offset:768
    ds_read_b32 v16, v5 offset:1024
    ds_read_b32 v17, v5 offset:1280
    ds_read_b32 v18, v5 offset:1536
    ds_read_b32 v19, v5 offset:1792
    s_lshl_b32 s30, s33, 8
    s_add_u32 s30, s30, 23085056
    s_waitcnt lgkmcnt(0)
    v_add_f32 v12, v12, v13
    v_add_f32 v12, v12, v14
    v_add_f32 v12, v12, v15
    v_add_f32 v12, v12, v16
    v_add_f32 v12, v12, v17
    v_add_f32 v12, v12, v18
    v_add_f32 v12, v12, v19
    buffer_store_dword v12, v5, s[20:23], s30 offen sc0 sc1
DN_m_29:
    v_mov_b32 v5, 0
    v_mov_b32 v6, 1
    s_waitcnt vmcnt(0)
    s_barrier
    s_cmp_lg_u32 s28, 0
    s_cbranch_scc1 NZ_m_28
    s_mov_b64 exec, 1
    buffer_atomic_add v6, v5, s[56:59], 0 offen sc1
    s_mov_b64 exec, -1
NZ_m_28:
    s_barrier
    s_mov_b32 s52, s72
    s_and_b32 s53, s73, 0xffff
    s_mov_b32 s54, 18874368
    s_mov_b32 s55, 0x20000
    s_mul_i32 s60, s29, 110592
    s_add_u32 s60, s60, 0
    v_lshlrev_b32 v66, 7, v0
    buffer_load_dword v234, v66, s[52:55], s60 offen
    s_add_u32 s60, s60, 65536
    v_mov_b32 v67, 0x7ff00000
    v_cmp_gt_u32 vcc, 352, v0
    s_nop 1
    v_cndmask_b32 v66, v67, v66, vcc
    buffer_load_dword v234, v66, s[52:55], s60 offen
    s_add_u32 s60, s60, 65536
    s_branch P2B_m_5
P2B_m_5:
    s_mov_b32 s20, s84
    s_and_b32 s21, s85, 0xffff
    s_mov_b32 s22, 54525952
    s_mov_b32 s23, 0x20000
    s_waitcnt vmcnt(0)
    s_cmp_lg_u32 s28, 7
    s_cbranch_scc1 P2A_m_4
    s_mov_b32 s56, s82
    s_and_b32 s57, s83, 0xffff
    s_mov_b32 s58, 256
    s_mov_b32 s59, 0x20000
    v_mov_b32 v74, 0
    s_mov_b32 s31, 0
    s_mov_b32 s37, 0x40000
POLL_m_30:
    buffer_load_dword v75, v74, s[56:59], s31 offen sc0 sc1
    s_waitcnt vmcnt(0)
    v_cmp_gt_u32 vcc, 64, v75
    s_sub_u32 s37, s37, 1
    s_cmp_eq_u32 s37, 0
    s_cbranch_scc1 GO_m_31
    s_cbranch_vccz GO_m_31
    s_sleep 1
    s_branch POLL_m_30
GO_m_31:
P2A_m_4:
    s_lshl_b32 s24, s10, 1
    s_and_b32 s25, s11, 1
    s_add_u32 s24, s24, s25
    s_lshr_b32 s25, s11, 1
    v_lshrrev_b32 v3, 5, v1
    v_and_b32 v4, 31, v1
    s_lshr_b32 s26, s28, 2
    s_and_b32 s27, s28, 3
    v_lshlrev_b32 v5, 4, v1
    v_mul_u32_u24 v6, 66560, v3
    v_lshl_add_u32 v6, v4, 4, v6
    s_lshr_b32 s47, s24, 2
    s_and_b32 s31, s24, 3
    s_mul_i32 s34, s47, 9
    s_lshl_b32 s32, s31, 1
    s_add_u32 s44, s32, s34
    s_add_u32 s32, s44, s26
    s_mul_i32 s32, s32, 66560
    s_add_u32 s34, s34, 8
    s_mul_i32 s34, s34, 66560
    s_mul_i32 s44, s44, 66560
    s_add_u32 s44, s44, 4792320
    s_lshr_b32 s30, s31, 1
    s_lshl_b32 s30, s30, 9
    s_add_u32 s41, s34, s30
    s_and_b32 s30, s31, 1
    s_lshl_b32 s30, s30, 3
    v_lshlrev_b32 v7, 4, v4
    v_add_u32 v7, s30, v7
    s_lshl_b32 s45, s31, 6
    s_add_u32 s45, s45, s34
    s_add_u32 s45, s45, 4792320
    v_lshrrev_b32 v74, 2, v1
    v_lshlrev_b32 v74, 8, v74
    v_and_b32 v75, 3, v1
    v_lshl_add_u32 v79, v75, 4, v74
    v_lshlrev_b32 v2, 4, v4
    v_lshl_add_u32 v2, v3, 10, v2
    s_lshl_b32 s33, s25, 2
    s_mul_i32 s30, s27, 3
    s_add_i32 s35, s33, s30
    s_sub_i32 s35, s35, 8
    s_mul_i32 s31, s26, 12
    s_add_u32 s31, s31, s30
    s_lshl_b32 s46, s31, 10
    s_lshl_b32 s30, s28, 1
    s_add_i32 s30, s30, s33
    s_sub_i32 s30, s30, 8
    s_max_i32 s30, s30, 0
    s_lshl_b32 s30, s30, 10
    s_add_u32 s33, s33, s27
    s_lshl_b32 s39, s33, 10
    s_add_u32 s40, s39, s41
    s_add_u32 s39, s39, s32
    s_add_u32 s41, s41, s30
    s_add_u32 s41, s41, 2396160
    s_add_u32 s38, s32, 2396160
    s_lshl_b32 s42, s28, 10
    s_add_u32 s42, s42, 24576
    s_mul_i32 s43, s28, 3
    s_lshl_b32 s36, s25, 3
    s_add_i32 s36, s36, s43
    s_sub_i32 s36, s36, 16
    s_mul_i32 s43, s43, 1168
    s_add_u32 s43, s43, 30720
    v_lshlrev_b32 v74, 2, v3
    v_sub_u32 v74, v4, v74
    v_mov_b32 v75, 0xf149f2ca
    v_mov_b32 v72, 0xffff
    v_mov_b32 v73, 0xffff0000
    v_cmp_gt_i32 s[86:87], 0, v74
    v_cmp_gt_i32 s[88:89], 1, v74
    v_cmp_gt_i32 s[90:91], 2, v74
    v_cmp_gt_i32 s[92:93], 3, v74
    v_cndmask_b32 v80, v75, 0, s[86:87]
    v_cndmask_b32 v81, v75, 0, s[88:89]
    v_cndmask_b32 v82, v75, 0, s[90:91]
    v_cndmask_b32 v83, v75, 0, s[92:93]
    v_cndmask_b32 v208, 0, v75, s[86:87]
    v_cndmask_b32 v209, 0, v75, s[88:89]
    v_cndmask_b32 v210, 0, v75, s[90:91]
    v_cndmask_b32 v211, 0, v75, s[92:93]
    v_cndmask_b32 v236, 0, v72, s[86:87]
    v_cndmask_b32 v76, 0, v73, s[88:89]
    v_or_b32 v236, v236, v76
    v_cndmask_b32 v237, 0, v72, s[90:91]
    v_cndmask_b32 v76, 0, v73, s[92:93]
    v_or_b32 v237, v237, v76
    v_cmp_gt_i32 s[86:87], 8, v74
    v_cmp_gt_i32 s[88:89], 9, v74
    v_cmp_gt_i32 s[90:91], 10, v74
    v_cmp_gt_i32 s[92:93], 11, v74
    v_cndmask_b32 v84, v75, 0, s[86:87]
    v_cndmask_b32 v85, v75, 0, s[88:89]
    v_cndmask_b32 v86, v75, 0, s[90:91]
    v_cndmask_b32 v87, v75, 0, s[92:93]
    v_cndmask_b32 v212, 0, v75, s[86:87]
    v_cndmask_b32 v213, 0, v75, s[88:89]
    v_cndmask_b32 v214, 0, v75, s[90:91]
    v_cndmask_b32 v215, 0, v75, s[92:93]
    v_cndmask_b32 v238, 0, v72, s[86:87]
    v_cndmask_b32 v76, 0, v73, s[88:89]
    v_or_b32 v238, v238, v76
    v_cndmask_b32 v239, 0, v72, s[90:91]
    v_cndmask_b32 v76, 0, v73, s[92:93]
    v_or_b32 v239, v239, v76
    v_cmp_gt_i32 s[86:87], 16, v74
    v_cmp_gt_i32 s[88:89], 17, v74
    v_cmp_gt_i32 s[90:91], 18, v74
    v_cmp_gt_i32 s[92:93], 19, v74
    v_cndmask_b32 v88, v75, 0, s[86:87]
    v_cndmask_b32 v89, v75, 0, s[88:89]
    v_cndmask_b32 v90, v75, 0, s[90:91]
    v_cndmask_b32 v91, v75, 0, s[92:93]
    v_cndmask_b32 v216, 0, v75, s[86:87]
    v_cndmask_b32 v217, 0, v75, s[88:89]
    v_cndmask_b32 v218, 0, v75, s[90:91]
    v_cndmask_b32 v219, 0, v75, s[92:93]
    v_cndmask_b32 v240, 0, v72, s[86:87]
    v_cndmask_b32 v76, 0, v73, s[88:89]
    v_or_b32 v240, v240, v76
    v_cndmask_b32 v241, 0, v72, s[90:91]
    v_cndmask_b32 v76, 0, v73, s[92:93]
    v_or_b32 v241, v241, v76
    v_cmp_gt_i32 s[86:87], 24, v74
    v_cmp_gt_i32 s[88:89], 25, v74
    v_cmp_gt_i32 s[90:91], 26, v74
    v_cmp_gt_i32 s[92:93], 27, v74
    v_cndmask_b32 v92, v75, 0, s[86:87]
    v_cndmask_b32 v93, v75, 0, s[88:89]
    v_cndmask_b32 v94, v75, 0, s[90:91]
    v_cndmask_b32 v95, v75, 0, s[92:93]
    v_cndmask_b32 v220, 0, v75, s[86:87]
    v_cndmask_b32 v221, 0, v75, s[88:89]
    v_cndmask_b32 v222, 0, v75, s[90:91]
    v_cndmask_b32 v223, 0, v75, s[92:93]
    v_cndmask_b32 v242, 0, v72, s[86:87]
    v_cndmask_b32 v76, 0, v73, s[88:89]
    v_or_b32 v242, v242, v76
    v_cndmask_b32 v243, 0, v72, s[90:91]
    v_cndmask_b32 v76, 0, v73, s[92:93]
    v_or_b32 v243, v243, v76
    s_mul_i32 s30, s26, 12
    s_add_u32 s30, s30, s27
    s_lshl_b32 s30, s30, 10
    v_add_u32 v76, s30, v5
    s_lshl_b32 s30, s27, 9
    s_add_u32 s30, s30, 24576
    v_add_u32 v77, s30, v7
    v_mov_b32 v30, 0
    v_mov_b32 v31, 0
    v_mov_b32 v34, 0
    v_mov_b32 v35, 0
    v_mov_b32 v38, 0
    v_mov_b32 v39, 0
    v_mov_b32 v14, 0
    v_mov_b32 v15, 0
    s_lshl_b32 s30, s26, 9
    v_lshlrev_b32 v78, 8, v3
    v_lshl_add_u32 v78, v4, 4, v78
    v_add_u32 v78, s30, v78
    s_lshl_b32 s30, s26, 5
    s_add_u32 s30, s30, 768
    v_lshlrev_b32 v74, 6, v3
    v_lshl_add_u32 v74, v4, 4, v74
    v_add_u32 v74, s30, v74
    v_cmp_lt_u32 vcc, 15, v4
    v_cmp_lt_u32 s[86:87], 17, v4
    v_mov_b32 v73, 1152
    v_cndmask_b32 v78, v78, v74, vcc
    v_cndmask_b32 v78, v78, v73, s[86:87]
    s_mul_i32 s30, s27, 2336
    s_add_u32 s30, s30, 30720
    v_add_u32 v78, s30, v78
    s_sub_i32 s30, 8, s33
    s_cmp_le_i32 s30, 0
    s_cbranch_scc1 NI_m_32
    v_mov_b32 v80, v75
    v_mov_b32 v81, v75
    v_mov_b32 v82, v75
    v_mov_b32 v83, v75
    v_mov_b32 v84, v75
    v_mov_b32 v85, v75
    v_mov_b32 v86, v75
    v_mov_b32 v87, v75
    v_mov_b32 v88, v75
    v_mov_b32 v89, v75
    v_mov_b32 v90, v75
    v_mov_b32 v91, v75
    v_mov_b32 v92, v75
    v_mov_b32 v93, v75
    v_mov_b32 v94, v75
    v_mov_b32 v95, v75
    s_cmp_le_i32 s30, 1
    s_cbranch_scc1 NI_m_32
    v_mov_b32 v96, v75
    v_mov_b32 v97, v75
    v_mov_b32 v98, v75
    v_mov_b32 v99, v75
    v_mov_b32 v100, v75
    v_mov_b32 v101, v75
    v_mov_b32 v102, v75
    v_mov_b32 v103, v75
    v_mov_b32 v104, v75
    v_mov_b32 v105, v75
    v_mov_b32 v106, v75
    v_mov_b32 v107, v75
    v_mov_b32 v108, v75
    v_mov_b32 v109, v75
    v_mov_b32 v110, v75
    v_mov_b32 v111, v75
    s_cmp_le_i32 s30, 2
    s_cbranch_scc1 NI_m_32
    v_mov_b32 v112, v75
    v_mov_b32 v113, v75
    v_mov_b32 v114, v75
    v_mov_b32 v115, v75
    v_mov_b32 v116, v75
    v_mov_b32 v117, v75
    v_mov_b32 v118, v75
    v_mov_b32 v119, v75
    v_mov_b32 v120, v75
    v_mov_b32 v121, v75
    v_mov_b32 v122, v75
    v_mov_b32 v123, v75
    v_mov_b32 v124, v75
    v_mov_b32 v125, v75
    v_mov_b32 v126, v75
    v_mov_b32 v127, v75
    s_cmp_le_i32 s30, 3
    s_cbranch_scc1 NI_m_32
    v_mov_b32 v128, v75
    v_mov_b32 v129, v75
    v_mov_b32 v130, v75
    v_mov_b32 v131, v75
    v_mov_b32 v132, v75
    v_mov_b32 v133, v75
    v_mov_b32 v134, v75
    v_mov_b32 v135, v75
    v_mov_b32 v136, v75
    v_mov_b32 v137, v75
    v_mov_b32 v138, v75
    v_mov_b32 v139, v75
    v_mov_b32 v140, v75
    v_mov_b32 v141, v75
    v_mov_b32 v142, v75
    v_mov_b32 v143, v75
    s_cmp_le_i32 s30, 4
    s_cbranch_scc1 NI_m_32
    v_mov_b32 v144, v75
    v_mov_b32 v145, v75
    v_mov_b32 v146, v75
    v_mov_b32 v147, v75
    v_mov_b32 v148, v75
    v_mov_b32 v149, v75
    v_mov_b32 v150, v75
    v_mov_b32 v151, v75
    v_mov_b32 v152, v75
    v_mov_b32 v153, v75
    v_mov_b32 v154, v75
    v_mov_b32 v155, v75
    v_mov_b32 v156, v75
    v_mov_b32 v157, v75
    v_mov_b32 v158, v75
    v_mov_b32 v159, v75
    s_cmp_le_i32 s30, 5
    s_cbranch_scc1 NI_m_32
    v_mov_b32 v160, v75
    v_mov_b32 v161, v75
    v_mov_b32 v162, v75
    v_mov_b32 v163, v75
    v_mov_b32 v164, v75
    v_mov_b32 v165, v75
    v_mov_b32 v166, v75
    v_mov_b32 v167, v75
    v_mov_b32 v168, v75
    v_mov_b32 v169, v75
    v_mov_b32 v170, v75
    v_mov_b32 v171, v75
    v_mov_b32 v172, v75
    v_mov_b32 v173, v75
    v_mov_b32 v174, v75
    v_mov_b32 v175, v75
    s_cmp_le_i32 s30, 6
    s_cbranch_scc1 NI_m_32
    v_mov_b32 v176, v75
    v_mov_b32 v177, v75
    v_mov_b32 v178, v75
    v_mov_b32 v179, v75
    v_mov_b32 v180, v75
    v_mov_b32 v181, v75
    v_mov_b32 v182, v75
    v_mov_b32 v183, v75
    v_mov_b32 v184, v75
    v_mov_b32 v185, v75
    v_mov_b32 v186, v75
    v_mov_b32 v187, v75
    v_mov_b32 v188, v75
    v_mov_b32 v189, v75
    v_mov_b32 v190, v75
    v_mov_b32 v191, v75
    s_cmp_le_i32 s30, 7
    s_cbranch_scc1 NI_m_32
    v_mov_b32 v192, v75
    v_mov_b32 v193, v75
    v_mov_b32 v194, v75
    v_mov_b32 v195, v75
    v_mov_b32 v196, v75
    v_mov_b32 v197, v75
    v_mov_b32 v198, v75
    v_mov_b32 v199, v75
    v_mov_b32 v200, v75
    v_mov_b32 v201, v75
    v_mov_b32 v202, v75
    v_mov_b32 v203, v75
    v_mov_b32 v204, v75
    v_mov_b32 v205, v75
    v_mov_b32 v206, v75
    v_mov_b32 v207, v75
NI_m_32:
    s_add_i32 s30, s35, 0
    s_max_i32 s30, s30, 0
    s_lshl_b32 s30, s30, 10
    s_add_u32 s86, s30, s38
    s_add_i32 s30, s36, 0
    s_max_i32 s30, s30, 0
    s_lshl_b32 s30, s30, 9
    s_add_u32 s89, s30, s44
    s_add_u32 s92, s30, s45
    s_add_i32 s30, s35, 1
    s_max_i32 s30, s30, 0
    s_lshl_b32 s30, s30, 10
    s_add_u32 s87, s30, s38
    s_add_i32 s30, s36, 1
    s_max_i32 s30, s30, 0
    s_lshl_b32 s30, s30, 9
    s_add_u32 s90, s30, s44
    s_add_u32 s93, s30, s45
    s_add_i32 s30, s35, 2
    s_max_i32 s30, s30, 0
    s_lshl_b32 s30, s30, 10
    s_add_u32 s88, s30, s38
    s_add_i32 s30, s36, 2
    s_max_i32 s30, s30, 0
    s_lshl_b32 s30, s30, 9
    s_add_u32 s91, s30, s44
    s_add_u32 s94, s30, s45
    s_cmp_lg_u32 s28, 7
    s_cbranch_scc1 SONE_m_33
    s_cmp_ge_u32 s2, 192
    s_cbranch_scc1 NG_m_34
    s_mov_b32 s37, 0x400000
LW_m_35:
    v_mov_b32 v74, 160768
    ds_read_b32 v74, v74
    s_waitcnt lgkmcnt(0)
    v_readfirstlane_b32 s31, v74
    s_nop 0
    s_cmp_ge_u32 s31, 5
    s_cbranch_scc1 LG_m_36
    s_sub_u32 s37, s37, 1
    s_cmp_eq_u32 s37, 0
    s_cbranch_scc1 LG_m_36
    s_sleep 1
    s_branch LW_m_35
LG_m_36:
NG_m_34:
    s_lshl_b32 s30, s47, 13
    s_lshl_b32 s31, s25, 9
    s_add_u32 s30, s30, s31
    s_add_u32 s30, s30, 21167104
    s_mov_b64 exec, -1
    v_lshlrev_b32 v74, 7, v1
    s_movk_i32 s31, 0x760
    s_cmp_eq_u32 s25, 0
    s_cselect_b32 s31, 0x700, s31
    s_cmp_ge_u32 s25, 2
    s_cselect_b32 exec_lo, 0x766, s31
    s_mov_b32 exec_hi, 0
    s_mov_b32 s37, 0x40000
POLL_m_37:
    buffer_load_dword v72, v74, s[20:23], s30 offen sc0 sc1
    s_waitcnt vmcnt(0)
    v_cmp_eq_u32 vcc, 0, v72
    s_sub_u32 s37, s37, 1
    s_cmp_eq_u32 s37, 0
    s_cbranch_scc1 GO_m_38
    s_cbranch_vccz GO_m_38
    s_sleep 1
    s_branch POLL_m_37
GO_m_38:
    s_mov_b64 exec, -1
SONE_m_33:
    s_barrier
    s_mov_b32 m0, s42
    s_cmp_ge_u32 s28, 6
    s_cbranch_scc1 SK8_m_39
    buffer_load_dwordx4 v2, s[20:23], s41 offen sc1 lds
SK8_m_39:
    s_add_u32 m0, s46, 0
    s_nop 0
    buffer_load_dwordx4 v5, s[20:23], s86 offen sc1 lds
    s_add_u32 m0, s46, 1024
    s_nop 0
    buffer_load_dwordx4 v5, s[20:23], s87 offen sc1 lds
    s_add_u32 m0, s46, 2048
    s_nop 0
    buffer_load_dwordx4 v5, s[20:23], s88 offen sc1 lds
    buffer_load_dwordx4 v[8:11], v5, s[20:23], s39 offen sc1
    buffer_load_dwordx2 v[12:13], v7, s[20:23], s40 offen sc1
    s_add_u32 m0, s43, 0
    s_nop 0
    buffer_load_dwordx4 v6, s[20:23], s89 offen sc1 lds
    s_add_u32 m0, s43, 1024
    s_mov_b64 exec, 0xff
    buffer_load_dwordx4 v79, s[20:23], s92 offen sc1 lds
    s_mov_b64 exec, -1
    s_add_u32 m0, s43, 1168
    s_nop 0
    buffer_load_dwordx4 v6, s[20:23], s90 offen sc1 lds
    s_add_u32 m0, s43, 2192
    s_mov_b64 exec, 0xff
    buffer_load_dwordx4 v79, s[20:23], s93 offen sc1 lds
    s_mov_b64 exec, -1
    s_add_u32 m0, s43, 2336
    s_nop 0
    buffer_load_dwordx4 v6, s[20:23], s91 offen sc1 lds
    s_add_u32 m0, s43, 3360
    s_mov_b64 exec, 0xff
    buffer_load_dwordx4 v79, s[20:23], s94 offen sc1 lds
    s_mov_b64 exec, -1
    s_cmp_lg_u32 s28, 7
    s_cbranch_scc1 SONE_m_40
    v_mov_b32 v16, 0x3f803f80
    v_mov_b32 v17, 0x3f803f80
    v_mov_b32 v18, 0x3f803f80
    v_mov_b32 v19, 0x3f803f80
    v_mul_u32_u24 v74, 1168, v1
    s_mov_b64 exec, 0xffffff
    ds_write_b128 v74, v[16:19] offset:31872
    s_mov_b64 exec, -1
SONE_m_40:
    s_mov_b32 s48, s68
    s_and_b32 s49, s69, 0xffff
    s_mov_b32 s50, 663552
    s_mov_b32 s51, 0x20000
    s_mov_b32 s12, s64
    s_and_b32 s13, s65, 0xffff
    s_mov_b32 s14, 2359296
    s_mov_b32 s15, 0x20000
    s_lshl_b32 s30, s10, 2
    s_and_b32 s31, s11, 3
    s_add_u32 s30, s30, s31
    s_lshl_b32 s30, s30, 2
    s_and_b32 s31, s28, 3
    s_add_u32 s30, s30, s31
    s_mul_i32 s30, s30, 18432
    s_mul_i32 s44, s31, 3072
    s_add_u32 s44, s44, 61440
    s_lshr_b32 s31, s11, 2
    s_mul_i32 s31, s31, 192
    s_add_u32 s43, s30, s31
    s_movk_i32 s30, 960
    v_add_u32 v224, 0, v1
    v_mul_u32_u24 v227, 5462, v224
    v_lshrrev_b32 v227, 16, v227
    v_lshlrev_b32 v224, 4, v224
    v_mad_u32_u24 v224, v227, s30, v224
    v_add_u32 v225, 64, v1
    v_mul_u32_u24 v227, 5462, v225
    v_lshrrev_b32 v227, 16, v227
    v_lshlrev_b32 v225, 4, v225
    v_mad_u32_u24 v225, v227, s30, v225
    v_add_u32 v226, 128, v1
    v_mul_u32_u24 v227, 5462, v226
    v_lshrrev_b32 v227, 16, v227
    v_lshlrev_b32 v226, 4, v226
    v_mad_u32_u24 v226, v227, s30, v226
    v_lshlrev_b32 v227, 7, v1
    s_mul_i32 s42, s11, 20736
    s_mul_i32 s30, s28, 2688
    s_add_u32 s42, s42, s30
    v_mov_b32 v72, v75
    s_sub_i32 s35, 8, s33
    s_cmp_eq_u32 s26, 0
    s_cselect_b32 s38, -1, 0
    s_cselect_b32 s40, 0, -1
    s_mov_b32 s39, 0
    s_mov_b32 s41, 0
    s_waitcnt vmcnt(6) lgkmcnt(0)
    v_cndmask_b32 v12, 0, v12, s[38:39]
    v_cndmask_b32 v13, 0, v13, s[40:41]
    s_barrier
    ds_read_b128 v[16:19], v76 offset:0
    ds_read_b64 v[28:29], v77 offset:0
    ds_read_b128 v[20:23], v76 offset:1024
    ds_read_b64 v[32:33], v77 offset:512
    s_cmp_ge_u32 s2, 192
    s_cbranch_scc1 XS_m_41
    s_cmp_lt_u32 s28, 4
    s_cbranch_scc1 XS_m_41
    s_add_u32 m0, s44, 0
    s_nop 0
    buffer_load_dwordx4 v224, s[12:15], s43 offen lds
    s_add_u32 m0, s44, 1024
    s_nop 0
    buffer_load_dwordx4 v225, s[12:15], s43 offen lds
    s_add_u32 m0, s44, 2048
    s_nop 0
    buffer_load_dwordx4 v226, s[12:15], s43 offen lds
XS_m_41:
    s_mov_b64 exec, 0x1fffff
    buffer_load_dword v234, v227, s[48:51], s42 offen
    s_mov_b64 exec, -1
    s_mov_b32 s52, s72
    s_and_b32 s53, s73, 0xffff
    s_mov_b32 s54, 18874368
    s_mov_b32 s55, 0x20000
    s_mul_i32 s60, s2, 23040
    s_add_u32 s60, s60, 7077888
    v_lshlrev_b32 v228, 7, v0
    v_mov_b32 v229, 0x7ff00000
    v_cmp_gt_u32 vcc, 180, v0
    s_nop 1
    v_cndmask_b32 v228, v229, v228, vcc
    buffer_load_dword v234, v228, s[52:55], s60 offen
    s_add_u32 s60, s60, 65536
    ds_read_b128 v[24:27], v76 offset:2048
    ds_read_b64 v[36:37], v77 offset:1024
    s_cmp_gt_i32 s35, 0
    s_cbranch_scc1 BK_m_42
    s_waitcnt lgkmcnt(4)
    v_mfma_f32_32x32x16_bf16 v[80:95], v[16:19], v[8:11], v[80:95]
    v_mfma_f32_32x32x16_bf16 v[80:95], v[28:31], v[12:15], v[80:95]
BK_m_42:
    ds_read_b128 v[16:19], v76 offset:3072
    ds_read_b64 v[28:29], v77 offset:1536
    s_cmp_gt_i32 s35, 1
    s_cbranch_scc1 BK_m_43
    s_waitcnt lgkmcnt(4)
    v_mfma_f32_32x32x16_bf16 v[96:111], v[20:23], v[8:11], 0
    v_mfma_f32_32x32x16_bf16 v[96:111], v[32:35], v[12:15], v[96:111]
BK_m_43:
    ds_read_b128 v[20:23], v76 offset:4096
    ds_read_b64 v[32:33], v77 offset:2048
    s_cmp_gt_i32 s35, 2
    s_cbranch_scc1 BK_m_44
    s_waitcnt lgkmcnt(4)
    v_mfma_f32_32x32x16_bf16 v[112:127], v[24:27], v[8:11], 0
    v_mfma_f32_32x32x16_bf16 v[112:127], v[36:39], v[12:15], v[112:127]
BK_m_44:
    ds_read_b128 v[24:27], v76 offset:5120
    ds_read_b64 v[36:37], v77 offset:2560
    s_cmp_gt_i32 s35, 3
    s_cbranch_scc1 BK_m_45
    s_waitcnt lgkmcnt(4)
    v_mfma_f32_32x32x16_bf16 v[128:143], v[16:19], v[8:11], 0
    v_mfma_f32_32x32x16_bf16 v[128:143], v[28:31], v[12:15], v[128:143]
BK_m_45:
    s_nop 3
    v_max3_f32 v72, v72, v96, v97
    v_max3_f32 v72, v72, v98, v99
    v_max3_f32 v72, v72, v100, v101
    v_max3_f32 v72, v72, v102, v103
    v_max3_f32 v72, v72, v104, v105
    v_max3_f32 v72, v72, v106, v107
    v_max3_f32 v72, v72, v108, v109
    v_max3_f32 v72, v72, v110, v111
    ds_read_b128 v[16:19], v76 offset:6144
    ds_read_b64 v[28:29], v77 offset:3072
    s_cmp_gt_i32 s35, 4
    s_cbranch_scc1 BK_m_46
    s_waitcnt lgkmcnt(4)
    v_mfma_f32_32x32x16_bf16 v[144:159], v[20:23], v[8:11], 0
    v_mfma_f32_32x32x16_bf16 v[144:159], v[32:35], v[12:15], v[144:159]
BK_m_46:
    v_max3_f32 v72, v72, v112, v113
    v_max3_f32 v72, v72, v114, v115
    v_max3_f32 v72, v72, v116, v117
    v_max3_f32 v72, v72, v118, v119
    v_max3_f32 v72, v72, v120, v121
    v_max3_f32 v72, v72, v122, v123
    v_max3_f32 v72, v72, v124, v125
    v_max3_f32 v72, v72, v126, v127
    ds_read_b128 v[20:23], v76 offset:7168
    ds_read_b64 v[32:33], v77 offset:3584
    s_cmp_gt_i32 s35, 5
    s_cbranch_scc1 BK_m_47
    s_waitcnt lgkmcnt(4)
    v_mfma_f32_32x32x16_bf16 v[160:175], v[24:27], v[8:11], 0
    v_mfma_f32_32x32x16_bf16 v[160:175], v[36:39], v[12:15], v[160:175]
BK_m_47:
    v_max3_f32 v72, v72, v128, v129
    v_max3_f32 v72, v72, v130, v131
    v_max3_f32 v72, v72, v132, v133
    v_max3_f32 v72, v72, v134, v135
    v_max3_f32 v72, v72, v136, v137
    v_max3_f32 v72, v72, v138, v139
    v_max3_f32 v72, v72, v140, v141
    v_max3_f32 v72, v72, v142, v143
    ds_read_b128 v[24:27], v76 offset:8192
    ds_read_b64 v[36:37], v77 offset:4096
    s_cmp_gt_i32 s35, 6
    s_cbranch_scc1 BK_m_48
    s_waitcnt lgkmcnt(4)
    v_mfma_f32_32x32x16_bf16 v[176:191], v[16:19], v[8:11], 0
    v_mfma_f32_32x32x16_bf16 v[176:191], v[28:31], v[12:15], v[176:191]
BK_m_48:
    v_max3_f32 v72, v72, v144, v145
    v_max3_f32 v72, v72, v146, v147
    v_max3_f32 v72, v72, v148, v149
    v_max3_f32 v72, v72, v150, v151
    v_max3_f32 v72, v72, v152, v153
    v_max3_f32 v72, v72, v154, v155
    v_max3_f32 v72, v72, v156, v157
    v_max3_f32 v72, v72, v158, v159
    s_cmp_gt_i32 s35, 7
    s_cbranch_scc1 BK_m_49
    s_waitcnt lgkmcnt(2)
    v_mfma_f32_32x32x16_bf16 v[192:207], v[20:23], v[8:11], 0
    v_mfma_f32_32x32x16_bf16 v[192:207], v[32:35], v[12:15], v[192:207]
BK_m_49:
    v_max3_f32 v72, v72, v160, v161
    v_max3_f32 v72, v72, v162, v163
    v_max3_f32 v72, v72, v164, v165
    v_max3_f32 v72, v72, v166, v167
    v_max3_f32 v72, v72, v168, v169
    v_max3_f32 v72, v72, v170, v171
    v_max3_f32 v72, v72, v172, v173
    v_max3_f32 v72, v72, v174, v175
    s_waitcnt lgkmcnt(0)
    v_mfma_f32_32x32x16_bf16 v[208:223], v[24:27], v[8:11], v[208:223]
    v_mfma_f32_32x32x16_bf16 v[208:223], v[36:39], v[12:15], v[208:223]
    v_max3_f32 v72, v72, v176, v177
    v_max3_f32 v72, v72, v178, v179
    v_max3_f32 v72, v72, v180, v181
    v_max3_f32 v72, v72, v182, v183
    v_max3_f32 v72, v72, v184, v185
    v_max3_f32 v72, v72, v186, v187
    v_max3_f32 v72, v72, v188, v189
    v_max3_f32 v72, v72, v190, v191
    v_max3_f32 v72, v72, v192, v193
    v_max3_f32 v72, v72, v194, v195
    v_max3_f32 v72, v72, v196, v197
    v_max3_f32 v72, v72, v198, v199
    v_max3_f32 v72, v72, v200, v201
    v_max3_f32 v72, v72, v202, v203
    v_max3_f32 v72, v72, v204, v205
    v_max3_f32 v72, v72, v206, v207
    s_cmp_ge_u32 s2, 192
    s_cbranch_scc1 WA_m_50
    s_cmp_lt_u32 s28, 4
    s_cbranch_scc1 WA_m_50
    s_waitcnt vmcnt(5)
    s_branch WB_m_51
WA_m_50:
    s_waitcnt vmcnt(2)
WB_m_51:
    s_barrier
    ds_read_b128 v[40:43], v78 offset:0
    ds_read_b128 v[44:47], v78 offset:1168
    v_max_f32 v80, v80, v208
    v_max_f32 v81, v81, v209
    v_max_f32 v82, v82, v210
    v_max_f32 v83, v83, v211
    v_max_f32 v84, v84, v212
    v_max_f32 v85, v85, v213
    v_max_f32 v86, v86, v214
    v_max_f32 v87, v87, v215
    v_max_f32 v88, v88, v216
    v_max_f32 v89, v89, v217
    v_max_f32 v90, v90, v218
    v_max_f32 v91, v91, v219
    v_max_f32 v92, v92, v220
    v_max_f32 v93, v93, v221
    v_max_f32 v94, v94, v222
    v_max_f32 v95, v95, v223
    v_max3_f32 v72, v72, v80, v81
    v_max3_f32 v72, v72, v82, v83
    v_max3_f32 v72, v72, v84, v85
    v_max3_f32 v72, v72, v86, v87
    v_max3_f32 v72, v72, v88, v89
    v_max3_f32 v72, v72, v90, v91
    v_max3_f32 v72, v72, v92, v93
    v_max3_f32 v72, v72, v94, v95
    v_mov_b32 v73, v72
    s_nop 1
    v_permlane32_swap_b32 v72, v73
    v_max_f32 v72, v72, v73
    s_mov_b32 s86, 0x07060302
    v_sub_f32 v80, v80, v72
    v_sub_f32 v81, v81, v72
    v_sub_f32 v82, v82, v72
    v_sub_f32 v83, v83, v72
    v_sub_f32 v84, v84, v72
    v_sub_f32 v85, v85, v72
    v_sub_f32 v86, v86, v72
    v_sub_f32 v87, v87, v72
    v_sub_f32 v88, v88, v72
    v_sub_f32 v89, v89, v72
    v_sub_f32 v90, v90, v72
    v_sub_f32 v91, v91, v72
    v_sub_f32 v92, v92, v72
    v_sub_f32 v93, v93, v72
    v_sub_f32 v94, v94, v72
    v_sub_f32 v95, v95, v72
    v_exp_f32 v80, v80
    v_exp_f32 v81, v81
    v_exp_f32 v82, v82
    v_exp_f32 v83, v83
    v_exp_f32 v84, v84
    v_exp_f32 v85, v85
    v_exp_f32 v86, v86
    v_exp_f32 v87, v87
    v_exp_f32 v88, v88
    v_exp_f32 v89, v89
    v_exp_f32 v90, v90
    v_exp_f32 v91, v91
    v_exp_f32 v92, v92
    v_exp_f32 v93, v93
    v_exp_f32 v94, v94
    v_exp_f32 v95, v95
    v_cvt_pk_bf16_f32 v80, v80, v81
    v_cvt_pk_bf16_f32 v81, v82, v83
    v_cvt_pk_bf16_f32 v82, v84, v85
    v_cvt_pk_bf16_f32 v83, v86, v87
    v_cvt_pk_bf16_f32 v84, v88, v89
    v_cvt_pk_bf16_f32 v85, v90, v91
    v_cvt_pk_bf16_f32 v86, v92, v93
    v_cvt_pk_bf16_f32 v87, v94, v95
    v_bfi_b32 v208, v236, 0, v80
    v_bfi_b32 v209, v237, 0, v81
    v_bfi_b32 v210, v238, 0, v82
    v_bfi_b32 v211, v239, 0, v83
    v_bfi_b32 v212, v240, 0, v84
    v_bfi_b32 v213, v241, 0, v85
    v_bfi_b32 v214, v242, 0, v86
    v_bfi_b32 v215, v243, 0, v87
    v_and_b32 v80, v236, v80
    v_and_b32 v81, v237, v81
    v_and_b32 v82, v238, v82
    v_and_b32 v83, v239, v83
    v_and_b32 v84, v240, v84
    v_and_b32 v85, v241, v85
    v_and_b32 v86, v242, v86
    v_and_b32 v87, v243, v87
    ds_read_b128 v[48:51], v78 offset:2336
    ds_read_b128 v[52:55], v78 offset:3504
    v_sub_f32 v96, v96, v72
    v_sub_f32 v97, v97, v72
    v_sub_f32 v98, v98, v72
    v_sub_f32 v99, v99, v72
    s_waitcnt lgkmcnt(2)
    v_mfma_f32_32x32x16_bf16 v[56:71], v[40:43], v[80:83], 0
    v_sub_f32 v100, v100, v72
    v_sub_f32 v101, v101, v72
    v_sub_f32 v102, v102, v72
    v_sub_f32 v103, v103, v72
    v_sub_f32 v104, v104, v72
    v_sub_f32 v105, v105, v72
    v_sub_f32 v106, v106, v72
    v_sub_f32 v107, v107, v72
    v_sub_f32 v108, v108, v72
    v_sub_f32 v109, v109, v72
    v_sub_f32 v110, v110, v72
    v_sub_f32 v111, v111, v72
    v_exp_f32 v96, v96
    v_exp_f32 v97, v97
    v_exp_f32 v98, v98
    v_exp_f32 v99, v99
    v_mfma_f32_32x32x16_bf16 v[56:71], v[44:47], v[84:87], v[56:71]
    v_exp_f32 v100, v100
    v_exp_f32 v101, v101
    v_exp_f32 v102, v102
    v_exp_f32 v103, v103
    v_exp_f32 v104, v104
    v_exp_f32 v105, v105
    v_exp_f32 v106, v106
    v_exp_f32 v107, v107
    v_exp_f32 v108, v108
    v_exp_f32 v109, v109
    v_exp_f32 v110, v110
    v_exp_f32 v111, v111
    v_cvt_pk_bf16_f32 v96, v96, v97
    v_cvt_pk_bf16_f32 v97, v98, v99
    v_cvt_pk_bf16_f32 v98, v100, v101
    v_cvt_pk_bf16_f32 v99, v102, v103
    v_cvt_pk_bf16_f32 v100, v104, v105
    v_cvt_pk_bf16_f32 v101, v106, v107
    v_cvt_pk_bf16_f32 v102, v108, v109
    v_cvt_pk_bf16_f32 v103, v110, v111
    ds_read_b128 v[40:43], v78 offset:4672
    ds_read_b128 v[44:47], v78 offset:5840
    v_sub_f32 v112, v112, v72
    v_sub_f32 v113, v113, v72
    v_sub_f32 v114, v114, v72
    v_sub_f32 v115, v115, v72
    s_waitcnt lgkmcnt(2)
    v_mfma_f32_32x32x16_bf16 v[56:71], v[48:51], v[96:99], v[56:71]
    v_sub_f32 v116, v116, v72
    v_sub_f32 v117, v117, v72
    v_sub_f32 v118, v118, v72
    v_sub_f32 v119, v119, v72
    v_sub_f32 v120, v120, v72
    v_sub_f32 v121, v121, v72
    v_sub_f32 v122, v122, v72
    v_sub_f32 v123, v123, v72
    v_sub_f32 v124, v124, v72
    v_sub_f32 v125, v125, v72
    v_sub_f32 v126, v126, v72
    v_sub_f32 v127, v127, v72
    v_exp_f32 v112, v112
    v_exp_f32 v113, v113
    v_exp_f32 v114, v114
    v_exp_f32 v115, v115
    v_mfma_f32_32x32x16_bf16 v[56:71], v[52:55], v[100:103], v[56:71]
    v_exp_f32 v116, v116
    v_exp_f32 v117, v117
    v_exp_f32 v118, v118
    v_exp_f32 v119, v119
    v_exp_f32 v120, v120
    v_exp_f32 v121, v121
    v_exp_f32 v122, v122
    v_exp_f32 v123, v123
    v_exp_f32 v124, v124
    v_exp_f32 v125, v125
    v_exp_f32 v126, v126
    v_exp_f32 v127, v127
    v_cvt_pk_bf16_f32 v112, v112, v113
    v_cvt_pk_bf16_f32 v113, v114, v115
    v_cvt_pk_bf16_f32 v114, v116, v117
    v_cvt_pk_bf16_f32 v115, v118, v119
    v_cvt_pk_bf16_f32 v116, v120, v121
    v_cvt_pk_bf16_f32 v117, v122, v123
    v_cvt_pk_bf16_f32 v118, v124, v125
    v_cvt_pk_bf16_f32 v119, v126, v127
    ds_read_b128 v[48:51], v78 offset:7008
    ds_read_b128 v[52:55], v78 offset:8176
    v_sub_f32 v128, v128, v72
    v_sub_f32 v129, v129, v72
    v_sub_f32 v130, v130, v72
    v_sub_f32 v131, v131, v72
    s_waitcnt lgkmcnt(2)
    v_mfma_f32_32x32x16_bf16 v[56:71], v[40:43], v[112:115], v[56:71]
    v_sub_f32 v132, v132, v72
    v_sub_f32 v133, v133, v72
    v_sub_f32 v134, v134, v72
    v_sub_f32 v135, v135, v72
    v_sub_f32 v136, v136, v72
    v_sub_f32 v137, v137, v72
    v_sub_f32 v138, v138, v72
    v_sub_f32 v139, v139, v72
    v_sub_f32 v140, v140, v72
    v_sub_f32 v141, v141, v72
    v_sub_f32 v142, v142, v72
    v_sub_f32 v143, v143, v72
    v_exp_f32 v128, v128
    v_exp_f32 v129, v129
    v_exp_f32 v130, v130
    v_exp_f32 v131, v131
    v_mfma_f32_32x32x16_bf16 v[56:71], v[44:47], v[116:119], v[56:71]
    v_exp_f32 v132, v132
    v_exp_f32 v133, v133
    v_exp_f32 v134, v134
    v_exp_f32 v135, v135
    v_exp_f32 v136, v136
    v_exp_f32 v137, v137
    v_exp_f32 v138, v138
    v_exp_f32 v139, v139
    v_exp_f32 v140, v140
    v_exp_f32 v141, v141
    v_exp_f32 v142, v142
    v_exp_f32 v143, v143
    v_cvt_pk_bf16_f32 v128, v128, v129
    v_cvt_pk_bf16_f32 v129, v130, v131
    v_cvt_pk_bf16_f32 v130, v132, v133
    v_cvt_pk_bf16_f32 v131, v134, v135
    v_cvt_pk_bf16_f32 v132, v136, v137
    v_cvt_pk_bf16_f32 v133, v138, v139
    v_cvt_pk_bf16_f32 v134, v140, v141
    v_cvt_pk_bf16_f32 v135, v142, v143
    ds_read_b128 v[40:43], v78 offset:9344
    ds_read_b128 v[44:47], v78 offset:10512
    v_sub_f32 v144, v144, v72
    v_sub_f32 v145, v145, v72
    v_sub_f32 v146, v146, v72
    v_sub_f32 v147, v147, v72
    s_waitcnt lgkmcnt(2)
    v_mfma_f32_32x32x16_bf16 v[56:71], v[48:51], v[128:131], v[56:71]
    v_sub_f32 v148, v148, v72
    v_sub_f32 v149, v149, v72
    v_sub_f32 v150, v150, v72
    v_sub_f32 v151, v151, v72
    v_sub_f32 v152, v152, v72
    v_sub_f32 v153, v153, v72
    v_sub_f32 v154, v154, v72
    v_sub_f32 v155, v155, v72
    v_sub_f32 v156, v156, v72
    v_sub_f32 v157, v157, v72
    v_sub_f32 v158, v158, v72
    v_sub_f32 v159, v159, v72
    v_exp_f32 v144, v144
    v_exp_f32 v145, v145
    v_exp_f32 v146, v146
    v_exp_f32 v147, v147
    v_mfma_f32_32x32x16_bf16 v[56:71], v[52:55], v[132:135], v[56:71]
    v_exp_f32 v148, v148
    v_exp_f32 v149, v149
    v_exp_f32 v150, v150
    v_exp_f32 v151, v151
    v_exp_f32 v152, v152
    v_exp_f32 v153, v153
    v_exp_f32 v154, v154
    v_exp_f32 v155, v155
    v_exp_f32 v156, v156
    v_exp_f32 v157, v157
    v_exp_f32 v158, v158
    v_exp_f32 v159, v159
    v_cvt_pk_bf16_f32 v144, v144, v145
    v_cvt_pk_bf16_f32 v145, v146, v147
    v_cvt_pk_bf16_f32 v146, v148, v149
    v_cvt_pk_bf16_f32 v147, v150, v151
    v_cvt_pk_bf16_f32 v148, v152, v153
    v_cvt_pk_bf16_f32 v149, v154, v155
    v_cvt_pk_bf16_f32 v150, v156, v157
    v_cvt_pk_bf16_f32 v151, v158, v159
    ds_read_b128 v[48:51], v78 offset:11680
    ds_read_b128 v[52:55], v78 offset:12848
    v_sub_f32 v160, v160, v72
    v_sub_f32 v161, v161, v72
    v_sub_f32 v162, v162, v72
    v_sub_f32 v163, v163, v72
    s_waitcnt lgkmcnt(2)
    v_mfma_f32_32x32x16_bf16 v[56:71], v[40:43], v[144:147], v[56:71]
    v_sub_f32 v164, v164, v72
    v_sub_f32 v165, v165, v72
    v_sub_f32 v166, v166, v72
    v_sub_f32 v167, v167, v72
    v_sub_f32 v168, v168, v72
    v_sub_f32 v169, v169, v72
    v_sub_f32 v170, v170, v72
    v_sub_f32 v171, v171, v72
    v_sub_f32 v172, v172, v72
    v_sub_f32 v173, v173, v72
    v_sub_f32 v174, v174, v72
    v_sub_f32 v175, v175, v72
    v_exp_f32 v160, v160
    v_exp_f32 v161, v161
    v_exp_f32 v162, v162
    v_exp_f32 v163, v163
    v_mfma_f32_32x32x16_bf16 v[56:71], v[44:47], v[148:151], v[56:71]
    v_exp_f32 v164, v164
    v_exp_f32 v165, v165
    v_exp_f32 v166, v166
    v_exp_f32 v167, v167
    v_exp_f32 v168, v168
    v_exp_f32 v169, v169
    v_exp_f32 v170, v170
    v_exp_f32 v171, v171
    v_exp_f32 v172, v172
    v_exp_f32 v173, v173
    v_exp_f32 v174, v174
    v_exp_f32 v175, v175
    v_cvt_pk_bf16_f32 v160, v160, v161
    v_cvt_pk_bf16_f32 v161, v162, v163
    v_cvt_pk_bf16_f32 v162, v164, v165
    v_cvt_pk_bf16_f32 v163, v166, v167
    v_cvt_pk_bf16_f32 v164, v168, v169
    v_cvt_pk_bf16_f32 v165, v170, v171
    v_cvt_pk_bf16_f32 v166, v172, v173
    v_cvt_pk_bf16_f32 v167, v174, v175
    ds_read_b128 v[40:43], v78 offset:14016
    ds_read_b128 v[44:47], v78 offset:15184
    v_sub_f32 v176, v176, v72
    v_sub_f32 v177, v177, v72
    v_sub_f32 v178, v178, v72
    v_sub_f32 v179, v179, v72
    s_waitcnt lgkmcnt(2)
    v_mfma_f32_32x32x16_bf16 v[56:71], v[48:51], v[160:163], v[56:71]
    v_sub_f32 v180, v180, v72
    v_sub_f32 v181, v181, v72
    v_sub_f32 v182, v182, v72
    v_sub_f32 v183, v183, v72
    v_sub_f32 v184, v184, v72
    v_sub_f32 v185, v185, v72
    v_sub_f32 v186, v186, v72
    v_sub_f32 v187, v187, v72
    v_sub_f32 v188, v188, v72
    v_sub_f32 v189, v189, v72
    v_sub_f32 v190, v190, v72
    v_sub_f32 v191, v191, v72
    v_exp_f32 v176, v176
    v_exp_f32 v177, v177
    v_exp_f32 v178, v178
    v_exp_f32 v179, v179
    v_mfma_f32_32x32x16_bf16 v[56:71], v[52:55], v[164:167], v[56:71]
    v_exp_f32 v180, v180
    v_exp_f32 v181, v181
    v_exp_f32 v182, v182
    v_exp_f32 v183, v183
    v_exp_f32 v184, v184
    v_exp_f32 v185, v185
    v_exp_f32 v186, v186
    v_exp_f32 v187, v187
    v_exp_f32 v188, v188
    v_exp_f32 v189, v189
    v_exp_f32 v190, v190
    v_exp_f32 v191, v191
    v_cvt_pk_bf16_f32 v176, v176, v177
    v_cvt_pk_bf16_f32 v177, v178, v179
    v_cvt_pk_bf16_f32 v178, v180, v181
    v_cvt_pk_bf16_f32 v179, v182, v183
    v_cvt_pk_bf16_f32 v180, v184, v185
    v_cvt_pk_bf16_f32 v181, v186, v187
    v_cvt_pk_bf16_f32 v182, v188, v189
    v_cvt_pk_bf16_f32 v183, v190, v191
    ds_read_b128 v[48:51], v78 offset:16352
    ds_read_b128 v[52:55], v78 offset:17520
    v_sub_f32 v192, v192, v72
    v_sub_f32 v193, v193, v72
    v_sub_f32 v194, v194, v72
    v_sub_f32 v195, v195, v72
    s_waitcnt lgkmcnt(2)
    v_mfma_f32_32x32x16_bf16 v[56:71], v[40:43], v[176:179], v[56:71]
    v_sub_f32 v196, v196, v72
    v_sub_f32 v197, v197, v72
    v_sub_f32 v198, v198, v72
    v_sub_f32 v199, v199, v72
    v_sub_f32 v200, v200, v72
    v_sub_f32 v201, v201, v72
    v_sub_f32 v202, v202, v72
    v_sub_f32 v203, v203, v72
    v_sub_f32 v204, v204, v72
    v_sub_f32 v205, v205, v72
    v_sub_f32 v206, v206, v72
    v_sub_f32 v207, v207, v72
    v_exp_f32 v192, v192
    v_exp_f32 v193, v193
    v_exp_f32 v194, v194
    v_exp_f32 v195, v195
    v_mfma_f32_32x32x16_bf16 v[56:71], v[44:47], v[180:183], v[56:71]
    v_exp_f32 v196, v196
    v_exp_f32 v197, v197
    v_exp_f32 v198, v198
    v_exp_f32 v199, v199
    v_exp_f32 v200, v200
    v_exp_f32 v201, v201
    v_exp_f32 v202, v202
    v_exp_f32 v203, v203
    v_exp_f32 v204, v204
    v_exp_f32 v205, v205
    v_exp_f32 v206, v206
    v_exp_f32 v207, v207
    v_cvt_pk_bf16_f32 v192, v192, v193
    v_cvt_pk_bf16_f32 v193, v194, v195
    v_cvt_pk_bf16_f32 v194, v196, v197
    v_cvt_pk_bf16_f32 v195, v198, v199
    v_cvt_pk_bf16_f32 v196, v200, v201
    v_cvt_pk_bf16_f32 v197, v202, v203
    v_cvt_pk_bf16_f32 v198, v204, v205
    v_cvt_pk_bf16_f32 v199, v206, v207
    ds_read_b128 v[40:43], v78 offset:18688
    ds_read_b128 v[44:47], v78 offset:19856
    s_waitcnt lgkmcnt(2)
    v_mfma_f32_32x32x16_bf16 v[56:71], v[48:51], v[192:195], v[56:71]
    v_mfma_f32_32x32x16_bf16 v[56:71], v[52:55], v[196:199], v[56:71]
    s_waitcnt lgkmcnt(0)
    v_mfma_f32_32x32x16_bf16 v[56:71], v[40:43], v[208:211], v[56:71]
    v_mfma_f32_32x32x16_bf16 v[56:71], v[44:47], v[212:215], v[56:71]
    s_lshl_b32 s34, s24, 1
    s_add_u32 s34, s34, s26
    s_mul_i32 s30, s34, 66560
    s_lshl_b32 s31, s33, 10
    s_add_u32 s30, s30, s31
    s_add_u32 s30, s30, 8388608
    s_lshl_b32 s31, s34, 13
    s_lshl_b32 s34, s33, 7
    s_add_u32 s31, s31, s34
    s_add_u32 s31, s31, 11534336
    v_lshlrev_b32 v77, 2, v4
    s_nop 0
    v_rcp_f32 v72, v66
    s_nop 0
    v_mul_f32 v56, v56, v72
    v_mul_f32 v57, v57, v72
    v_mul_f32 v58, v58, v72
    v_mul_f32 v59, v59, v72
    v_mul_f32 v60, v60, v72
    v_mul_f32 v61, v61, v72
    v_mul_f32 v62, v62, v72
    v_mul_f32 v63, v63, v72
    v_mul_f32 v64, v64, v72
    v_mul_f32 v65, v65, v72
    v_cvt_pk_bf16_f32 v16, v56, v57
    v_cvt_pk_bf16_f32 v17, v58, v59
    v_cvt_pk_bf16_f32 v18, v60, v61
    v_cvt_pk_bf16_f32 v19, v62, v63
    v_cvt_pk_bf16_f32 v20, v64, v65
    buffer_store_dwordx4 v[16:19], v5, s[20:23], s30 offen sc0 sc1
    s_mov_b32 exec_hi, 0
    buffer_store_dword v20, v77, s[20:23], s31 offen sc0 sc1
    s_mov_b32 exec_hi, -1
    s_lshl_b32 s30, s25, 11
    s_lshl_b32 s31, s24, 7
    s_add_u32 s30, s30, s31
    s_add_u32 s30, s30, 21200896
    v_mov_b32 v74, 0
    v_mov_b32 v75, 1
    s_waitcnt vmcnt(0)
    s_barrier
    s_cmp_lg_u32 s28, 6
    s_cbranch_scc1 P3_m_6
    s_mov_b64 exec, 1
    buffer_store_dword v75, v74, s[20:23], s30 offen sc0 sc1
    s_mov_b64 exec, -1
    s_branch P3_m_6
P3_m_6:
    s_cmp_ge_u32 s2, 192
    s_cbranch_scc1 P3PF_m_52
    s_lshl_b32 s24, s10, 2
    s_and_b32 s25, s11, 3
    s_add_u32 s24, s24, s25
    s_lshr_b32 s25, s11, 2
    v_lshrrev_b32 v3, 4, v1
    v_and_b32 v4, 15, v1
    v_lshlrev_b32 v9, 4, v1
    s_cmp_ge_u32 s28, 4
    s_cbranch_scc1 P3PROD_m_53
    s_lshr_b32 s26, s28, 1
    s_and_b32 s27, s28, 1
    v_and_b32 v6, 1, v3
    v_bfe_u32 v5, v1, 2, 2
    v_lshl_add_u32 v5, v3, 2, v5
    v_mul_u32_u24 v5, 192, v5
    v_and_b32 v7, 3, v1
    v_lshl_add_u32 v5, v7, 3, v5
    v_add_u32 v5, 73728, v5
    s_mul_i32 s30, s27, 3
    s_add_u32 s31, s30, 0
    v_xor_b32 v7, s31, v6
    v_lshl_add_u32 v10, v7, 5, v5
    v_add_u32 v13, 49152, v10
    s_add_u32 s31, s30, 1
    v_xor_b32 v7, s31, v6
    v_lshl_add_u32 v11, v7, 5, v5
    v_add_u32 v14, 49152, v11
    s_add_u32 s31, s30, 2
    v_xor_b32 v7, s31, v6
    v_lshl_add_u32 v12, v7, 5, v5
    v_add_u32 v15, 49152, v12
    s_lshl_b32 s30, s26, 11
    v_add_u32 v16, s30, v9
    v_add_u32 v17, 32768, v16
    v_lshlrev_b32 v5, 8, v3
    v_lshl_add_u32 v5, v4, 2, v5
    v_add_u32 v18, s30, v5
    v_add_u32 v18, 65536, v18
    v_lshlrev_b32 v5, 3, v3
    v_sub_u32 v5, v4, v5
    v_mov_b32 v6, 0x3f80
    v_mov_b32 v7, 0x3f800000
    v_cmp_eq_u32 vcc, 0, v5
    v_cmp_eq_u32 s[30:31], 1, v5
    s_nop 0
    v_cndmask_b32 v24, 0, v6, vcc
    v_cndmask_b32 v24, v24, v7, s[30:31]
    v_cmp_eq_u32 vcc, 2, v5
    v_cmp_eq_u32 s[30:31], 3, v5
    s_nop 0
    v_cndmask_b32 v25, 0, v6, vcc
    v_cndmask_b32 v25, v25, v7, s[30:31]
    v_cmp_eq_u32 vcc, 4, v5
    v_cmp_eq_u32 s[30:31], 5, v5
    s_nop 0
    v_cndmask_b32 v26, 0, v6, vcc
    v_cndmask_b32 v26, v26, v7, s[30:31]
    v_cmp_eq_u32 vcc, 6, v5
    v_cmp_eq_u32 s[30:31], 7, v5
    s_nop 0
    v_cndmask_b32 v27, 0, v6, vcc
    v_cndmask_b32 v27, v27, v7, s[30:31]
    s_mul_i32 s30, s26, 6144
    s_mul_i32 s31, s27, 96
    s_add_u32 s30, s30, s31
    s_add_u32 s30, s30, 61440
    v_mul_u32_u24 v5, 192, v4
    v_and_b32 v6, 16, v1
    v_add3_u32 v5, v5, v6, s30
    ds_read_b128 v[28:31], v5 offset:0
    ds_read_b128 v[32:35], v5 offset:32
    ds_read_b128 v[36:39], v5 offset:64
    ds_read_b128 v[40:43], v5 offset:3072
    ds_read_b128 v[44:47], v5 offset:3104
    ds_read_b128 v[48:51], v5 offset:3136
    s_waitcnt lgkmcnt(0)
    v_mfma_f32_16x16x32_bf16 v[52:55], v[28:31], v[24:27], 0
    v_mfma_f32_16x16x32_bf16 v[56:59], v[32:35], v[24:27], 0
    v_mfma_f32_16x16x32_bf16 v[60:63], v[36:39], v[24:27], 0
    v_mfma_f32_16x16x32_bf16 v[64:67], v[40:43], v[24:27], 0
    v_mfma_f32_16x16x32_bf16 v[68:71], v[44:47], v[24:27], 0
    v_mfma_f32_16x16x32_bf16 v[72:75], v[48:51], v[24:27], 0
    s_barrier
    ds_read_b128 v[76:79], v16 offset:0
    ds_read_b128 v[80:83], v16 offset:1024
    ds_read_b64_tr_b16 v[100:101], v10 offset:0
    ds_read_b64_tr_b16 v[102:103], v10 offset:3072
    ds_read_b64_tr_b16 v[104:105], v11 offset:0
    ds_read_b64_tr_b16 v[106:107], v11 offset:3072
    ds_read_b64_tr_b16 v[108:109], v12 offset:0
    ds_read_b64_tr_b16 v[110:111], v12 offset:3072
    ds_read_b128 v[84:87], v16 offset:4096
    ds_read_b128 v[88:91], v16 offset:5120
    ds_read_b64_tr_b16 v[112:113], v10 offset:6144
    ds_read_b64_tr_b16 v[114:115], v10 offset:9216
    ds_read_b64_tr_b16 v[116:117], v11 offset:6144
    ds_read_b64_tr_b16 v[118:119], v11 offset:9216
    ds_read_b64_tr_b16 v[120:121], v12 offset:6144
    ds_read_b64_tr_b16 v[122:123], v12 offset:9216
    s_waitcnt lgkmcnt(8)
    v_mfma_f32_16x16x32_bf16 v[52:55], v[76:79], v[100:103], v[52:55]
    ds_read_b128 v[92:95], v16 offset:8192
    ds_read_b128 v[96:99], v16 offset:9216
    v_mfma_f32_16x16x32_bf16 v[56:59], v[76:79], v[104:107], v[56:59]
    ds_read_b64_tr_b16 v[124:125], v10 offset:12288
    ds_read_b64_tr_b16 v[126:127], v10 offset:15360
    v_mfma_f32_16x16x32_bf16 v[60:63], v[76:79], v[108:111], v[60:63]
    ds_read_b64_tr_b16 v[128:129], v11 offset:12288
    ds_read_b64_tr_b16 v[130:131], v11 offset:15360
    v_mfma_f32_16x16x32_bf16 v[64:67], v[80:83], v[100:103], v[64:67]
    ds_read_b64_tr_b16 v[132:133], v12 offset:12288
    ds_read_b64_tr_b16 v[134:135], v12 offset:15360
    v_mfma_f32_16x16x32_bf16 v[68:71], v[80:83], v[104:107], v[68:71]
    v_mfma_f32_16x16x32_bf16 v[72:75], v[80:83], v[108:111], v[72:75]
    s_waitcnt lgkmcnt(8)
    v_mfma_f32_16x16x32_bf16 v[52:55], v[84:87], v[112:115], v[52:55]
    ds_read_b128 v[76:79], v16 offset:12288
    ds_read_b128 v[80:83], v16 offset:13312
    v_mfma_f32_16x16x32_bf16 v[56:59], v[84:87], v[116:119], v[56:59]
    ds_read_b64_tr_b16 v[100:101], v10 offset:18432
    ds_read_b64_tr_b16 v[102:103], v10 offset:21504
    v_mfma_f32_16x16x32_bf16 v[60:63], v[84:87], v[120:123], v[60:63]
    ds_read_b64_tr_b16 v[104:105], v11 offset:18432
    ds_read_b64_tr_b16 v[106:107], v11 offset:21504
    v_mfma_f32_16x16x32_bf16 v[64:67], v[88:91], v[112:115], v[64:67]
    ds_read_b64_tr_b16 v[108:109], v12 offset:18432
    ds_read_b64_tr_b16 v[110:111], v12 offset:21504
    v_mfma_f32_16x16x32_bf16 v[68:71], v[88:91], v[116:119], v[68:71]
    v_mfma_f32_16x16x32_bf16 v[72:75], v[88:91], v[120:123], v[72:75]
    s_waitcnt lgkmcnt(0)
    s_barrier
    v_mfma_f32_16x16x32_bf16 v[52:55], v[92:95], v[124:127], v[52:55]
    ds_read_b128 v[84:87], v16 offset:16384
    ds_read_b128 v[88:91], v16 offset:17408
    v_mfma_f32_16x16x32_bf16 v[56:59], v[92:95], v[128:131], v[56:59]
    ds_read_b64_tr_b16 v[112:113], v10 offset:24576
    ds_read_b64_tr_b16 v[114:115], v10 offset:27648
    v_mfma_f32_16x16x32_bf16 v[60:63], v[92:95], v[132:135], v[60:63]
    ds_read_b64_tr_b16 v[116:117], v11 offset:24576
    ds_read_b64_tr_b16 v[118:119], v11 offset:27648
    v_mfma_f32_16x16x32_bf16 v[64:67], v[96:99], v[124:127], v[64:67]
    ds_read_b64_tr_b16 v[120:121], v12 offset:24576
    ds_read_b64_tr_b16 v[122:123], v12 offset:27648
    v_mfma_f32_16x16x32_bf16 v[68:71], v[96:99], v[128:131], v[68:71]
    v_mfma_f32_16x16x32_bf16 v[72:75], v[96:99], v[132:135], v[72:75]
    s_waitcnt lgkmcnt(8)
    v_mfma_f32_16x16x32_bf16 v[52:55], v[76:79], v[100:103], v[52:55]
    ds_read_b128 v[92:95], v16 offset:20480
    ds_read_b128 v[96:99], v16 offset:21504
    v_mfma_f32_16x16x32_bf16 v[56:59], v[76:79], v[104:107], v[56:59]
    ds_read_b64_tr_b16 v[124:125], v10 offset:30720
    ds_read_b64_tr_b16 v[126:127], v10 offset:33792
    v_mfma_f32_16x16x32_bf16 v[60:63], v[76:79], v[108:111], v[60:63]
    ds_read_b64_tr_b16 v[128:129], v11 offset:30720
    ds_read_b64_tr_b16 v[130:131], v11 offset:33792
    v_mfma_f32_16x16x32_bf16 v[64:67], v[80:83], v[100:103], v[64:67]
    ds_read_b64_tr_b16 v[132:133], v12 offset:30720
    ds_read_b64_tr_b16 v[134:135], v12 offset:33792
    v_mfma_f32_16x16x32_bf16 v[68:71], v[80:83], v[104:107], v[68:71]
    v_mfma_f32_16x16x32_bf16 v[72:75], v[80:83], v[108:111], v[72:75]
    s_waitcnt lgkmcnt(8)
    v_mfma_f32_16x16x32_bf16 v[52:55], v[84:87], v[112:115], v[52:55]
    ds_read_b128 v[76:79], v16 offset:24576
    ds_read_b128 v[80:83], v16 offset:25600
    v_mfma_f32_16x16x32_bf16 v[56:59], v[84:87], v[116:119], v[56:59]
    ds_read_b64_tr_b16 v[100:101], v10 offset:36864
    ds_read_b64_tr_b16 v[102:103], v10 offset:39936
    v_mfma_f32_16x16x32_bf16 v[60:63], v[84:87], v[120:123], v[60:63]
    ds_read_b64_tr_b16 v[104:105], v11 offset:36864
    ds_read_b64_tr_b16 v[106:107], v11 offset:39936
    v_mfma_f32_16x16x32_bf16 v[64:67], v[88:91], v[112:115], v[64:67]
    ds_read_b64_tr_b16 v[108:109], v12 offset:36864
    ds_read_b64_tr_b16 v[110:111], v12 offset:39936
    v_mfma_f32_16x16x32_bf16 v[68:71], v[88:91], v[116:119], v[68:71]
    v_mfma_f32_16x16x32_bf16 v[72:75], v[88:91], v[120:123], v[72:75]
    s_waitcnt lgkmcnt(8)
    v_mfma_f32_16x16x32_bf16 v[52:55], v[92:95], v[124:127], v[52:55]
    ds_read_b128 v[84:87], v16 offset:28672
    ds_read_b128 v[88:91], v16 offset:29696
    v_mfma_f32_16x16x32_bf16 v[56:59], v[92:95], v[128:131], v[56:59]
    ds_read_b64_tr_b16 v[112:113], v10 offset:43008
    ds_read_b64_tr_b16 v[114:115], v10 offset:46080
    v_mfma_f32_16x16x32_bf16 v[60:63], v[92:95], v[132:135], v[60:63]
    ds_read_b64_tr_b16 v[116:117], v11 offset:43008
    ds_read_b64_tr_b16 v[118:119], v11 offset:46080
    v_mfma_f32_16x16x32_bf16 v[64:67], v[96:99], v[124:127], v[64:67]
    ds_read_b64_tr_b16 v[120:121], v12 offset:43008
    ds_read_b64_tr_b16 v[122:123], v12 offset:46080
    v_mfma_f32_16x16x32_bf16 v[68:71], v[96:99], v[128:131], v[68:71]
    v_mfma_f32_16x16x32_bf16 v[72:75], v[96:99], v[132:135], v[72:75]
    s_waitcnt lgkmcnt(8)
    v_mfma_f32_16x16x32_bf16 v[52:55], v[76:79], v[100:103], v[52:55]
    ds_read_b128 v[92:95], v17 offset:0
    ds_read_b128 v[96:99], v17 offset:1024
    v_mfma_f32_16x16x32_bf16 v[56:59], v[76:79], v[104:107], v[56:59]
    ds_read_b64_tr_b16 v[124:125], v13 offset:0
    ds_read_b64_tr_b16 v[126:127], v13 offset:3072
    v_mfma_f32_16x16x32_bf16 v[60:63], v[76:79], v[108:111], v[60:63]
    ds_read_b64_tr_b16 v[128:129], v14 offset:0
    ds_read_b64_tr_b16 v[130:131], v14 offset:3072
    v_mfma_f32_16x16x32_bf16 v[64:67], v[80:83], v[100:103], v[64:67]
    ds_read_b64_tr_b16 v[132:133], v15 offset:0
    ds_read_b64_tr_b16 v[134:135], v15 offset:3072
    v_mfma_f32_16x16x32_bf16 v[68:71], v[80:83], v[104:107], v[68:71]
    v_mfma_f32_16x16x32_bf16 v[72:75], v[80:83], v[108:111], v[72:75]
    s_waitcnt lgkmcnt(8)
    v_mfma_f32_16x16x32_bf16 v[52:55], v[84:87], v[112:115], v[52:55]
    ds_read_b128 v[76:79], v17 offset:4096
    ds_read_b128 v[80:83], v17 offset:5120
    v_mfma_f32_16x16x32_bf16 v[56:59], v[84:87], v[116:119], v[56:59]
    ds_read_b64_tr_b16 v[100:101], v13 offset:6144
    ds_read_b64_tr_b16 v[102:103], v13 offset:9216
    v_mfma_f32_16x16x32_bf16 v[60:63], v[84:87], v[120:123], v[60:63]
    ds_read_b64_tr_b16 v[104:105], v14 offset:6144
    ds_read_b64_tr_b16 v[106:107], v14 offset:9216
    v_mfma_f32_16x16x32_bf16 v[64:67], v[88:91], v[112:115], v[64:67]
    ds_read_b64_tr_b16 v[108:109], v15 offset:6144
    ds_read_b64_tr_b16 v[110:111], v15 offset:9216
    v_mfma_f32_16x16x32_bf16 v[68:71], v[88:91], v[116:119], v[68:71]
    v_mfma_f32_16x16x32_bf16 v[72:75], v[88:91], v[120:123], v[72:75]
    s_waitcnt lgkmcnt(8)
    s_barrier
    v_mfma_f32_16x16x32_bf16 v[52:55], v[92:95], v[124:127], v[52:55]
    ds_read_b128 v[84:87], v17 offset:8192
    ds_read_b128 v[88:91], v17 offset:9216
    v_mfma_f32_16x16x32_bf16 v[56:59], v[92:95], v[128:131], v[56:59]
    ds_read_b64_tr_b16 v[112:113], v13 offset:12288
    ds_read_b64_tr_b16 v[114:115], v13 offset:15360
    v_mfma_f32_16x16x32_bf16 v[60:63], v[92:95], v[132:135], v[60:63]
    ds_read_b64_tr_b16 v[116:117], v14 offset:12288
    ds_read_b64_tr_b16 v[118:119], v14 offset:15360
    v_mfma_f32_16x16x32_bf16 v[64:67], v[96:99], v[124:127], v[64:67]
    ds_read_b64_tr_b16 v[120:121], v15 offset:12288
    ds_read_b64_tr_b16 v[122:123], v15 offset:15360
    v_mfma_f32_16x16x32_bf16 v[68:71], v[96:99], v[128:131], v[68:71]
    v_mfma_f32_16x16x32_bf16 v[72:75], v[96:99], v[132:135], v[72:75]
    s_waitcnt lgkmcnt(8)
    v_mfma_f32_16x16x32_bf16 v[52:55], v[76:79], v[100:103], v[52:55]
    ds_read_b128 v[92:95], v17 offset:12288
    ds_read_b128 v[96:99], v17 offset:13312
    v_mfma_f32_16x16x32_bf16 v[56:59], v[76:79], v[104:107], v[56:59]
    ds_read_b64_tr_b16 v[124:125], v13 offset:18432
    ds_read_b64_tr_b16 v[126:127], v13 offset:21504
    v_mfma_f32_16x16x32_bf16 v[60:63], v[76:79], v[108:111], v[60:63]
    ds_read_b64_tr_b16 v[128:129], v14 offset:18432
    ds_read_b64_tr_b16 v[130:131], v14 offset:21504
    v_mfma_f32_16x16x32_bf16 v[64:67], v[80:83], v[100:103], v[64:67]
    ds_read_b64_tr_b16 v[132:133], v15 offset:18432
    ds_read_b64_tr_b16 v[134:135], v15 offset:21504
    v_mfma_f32_16x16x32_bf16 v[68:71], v[80:83], v[104:107], v[68:71]
    v_mfma_f32_16x16x32_bf16 v[72:75], v[80:83], v[108:111], v[72:75]
    s_waitcnt lgkmcnt(8)
    v_mfma_f32_16x16x32_bf16 v[52:55], v[84:87], v[112:115], v[52:55]
    ds_read_b128 v[76:79], v17 offset:16384
    ds_read_b128 v[80:83], v17 offset:17408
    v_mfma_f32_16x16x32_bf16 v[56:59], v[84:87], v[116:119], v[56:59]
    ds_read_b64_tr_b16 v[100:101], v13 offset:24576
    ds_read_b64_tr_b16 v[102:103], v13 offset:27648
    v_mfma_f32_16x16x32_bf16 v[60:63], v[84:87], v[120:123], v[60:63]
    ds_read_b64_tr_b16 v[104:105], v14 offset:24576
    ds_read_b64_tr_b16 v[106:107], v14 offset:27648
    v_mfma_f32_16x16x32_bf16 v[64:67], v[88:91], v[112:115], v[64:67]
    ds_read_b64_tr_b16 v[108:109], v15 offset:24576
    ds_read_b64_tr_b16 v[110:111], v15 offset:27648
    v_mfma_f32_16x16x32_bf16 v[68:71], v[88:91], v[116:119], v[68:71]
    v_mfma_f32_16x16x32_bf16 v[72:75], v[88:91], v[120:123], v[72:75]
    s_waitcnt lgkmcnt(8)
    v_mfma_f32_16x16x32_bf16 v[52:55], v[92:95], v[124:127], v[52:55]
    ds_read_b128 v[84:87], v17 offset:20480
    ds_read_b128 v[88:91], v17 offset:21504
    v_mfma_f32_16x16x32_bf16 v[56:59], v[92:95], v[128:131], v[56:59]
    ds_read_b64_tr_b16 v[112:113], v13 offset:30720
    ds_read_b64_tr_b16 v[114:115], v13 offset:33792
    v_mfma_f32_16x16x32_bf16 v[60:63], v[92:95], v[132:135], v[60:63]
    ds_read_b64_tr_b16 v[116:117], v14 offset:30720
    ds_read_b64_tr_b16 v[118:119], v14 offset:33792
    v_mfma_f32_16x16x32_bf16 v[64:67], v[96:99], v[124:127], v[64:67]
    ds_read_b64_tr_b16 v[120:121], v15 offset:30720
    ds_read_b64_tr_b16 v[122:123], v15 offset:33792
    v_mfma_f32_16x16x32_bf16 v[68:71], v[96:99], v[128:131], v[68:71]
    v_mfma_f32_16x16x32_bf16 v[72:75], v[96:99], v[132:135], v[72:75]
    s_waitcnt lgkmcnt(8)
    s_barrier
    v_mfma_f32_16x16x32_bf16 v[52:55], v[76:79], v[100:103], v[52:55]
    ds_read_b128 v[92:95], v17 offset:24576
    ds_read_b128 v[96:99], v17 offset:25600
    v_mfma_f32_16x16x32_bf16 v[56:59], v[76:79], v[104:107], v[56:59]
    ds_read_b64_tr_b16 v[124:125], v10 offset:0
    ds_read_b64_tr_b16 v[126:127], v10 offset:3072
    v_mfma_f32_16x16x32_bf16 v[60:63], v[76:79], v[108:111], v[60:63]
    ds_read_b64_tr_b16 v[128:129], v11 offset:0
    ds_read_b64_tr_b16 v[130:131], v11 offset:3072
    v_mfma_f32_16x16x32_bf16 v[64:67], v[80:83], v[100:103], v[64:67]
    ds_read_b64_tr_b16 v[132:133], v12 offset:0
    ds_read_b64_tr_b16 v[134:135], v12 offset:3072
    v_mfma_f32_16x16x32_bf16 v[68:71], v[80:83], v[104:107], v[68:71]
    v_mfma_f32_16x16x32_bf16 v[72:75], v[80:83], v[108:111], v[72:75]
    s_waitcnt lgkmcnt(8)
    v_mfma_f32_16x16x32_bf16 v[52:55], v[84:87], v[112:115], v[52:55]
    ds_read_b128 v[76:79], v17 offset:28672
    ds_read_b128 v[80:83], v17 offset:29696
    v_mfma_f32_16x16x32_bf16 v[56:59], v[84:87], v[116:119], v[56:59]
    ds_read_b64_tr_b16 v[100:101], v10 offset:6144
    ds_read_b64_tr_b16 v[102:103], v10 offset:9216
    v_mfma_f32_16x16x32_bf16 v[60:63], v[84:87], v[120:123], v[60:63]
    ds_read_b64_tr_b16 v[104:105], v11 offset:6144
    ds_read_b64_tr_b16 v[106:107], v11 offset:9216
    v_mfma_f32_16x16x32_bf16 v[64:67], v[88:91], v[112:115], v[64:67]
    ds_read_b64_tr_b16 v[108:109], v12 offset:6144
    ds_read_b64_tr_b16 v[110:111], v12 offset:9216
    v_mfma_f32_16x16x32_bf16 v[68:71], v[88:91], v[116:119], v[68:71]
    v_mfma_f32_16x16x32_bf16 v[72:75], v[88:91], v[120:123], v[72:75]
    s_waitcnt lgkmcnt(8)
    v_mfma_f32_16x16x32_bf16 v[52:55], v[92:95], v[124:127], v[52:55]
    ds_read_b32 v84, v18 offset:0
    ds_read_b32 v85, v18 offset:64
    v_mfma_f32_16x16x32_bf16 v[56:59], v[92:95], v[128:131], v[56:59]
    ds_read_b32 v86, v18 offset:128
    ds_read_b32 v87, v18 offset:192
    v_mfma_f32_16x16x32_bf16 v[60:63], v[92:95], v[132:135], v[60:63]
    ds_read_b32 v88, v18 offset:1024
    ds_read_b32 v89, v18 offset:1088
    v_mfma_f32_16x16x32_bf16 v[64:67], v[96:99], v[124:127], v[64:67]
    ds_read_b32 v90, v18 offset:1152
    ds_read_b32 v91, v18 offset:1216
    v_mfma_f32_16x16x32_bf16 v[68:71], v[96:99], v[128:131], v[68:71]
    ds_read_b64_tr_b16 v[112:113], v10 offset:12288
    ds_read_b64_tr_b16 v[114:115], v10 offset:15360
    v_mfma_f32_16x16x32_bf16 v[72:75], v[96:99], v[132:135], v[72:75]
    ds_read_b64_tr_b16 v[116:117], v11 offset:12288
    ds_read_b64_tr_b16 v[118:119], v11 offset:15360
    ds_read_b64_tr_b16 v[120:121], v12 offset:12288
    ds_read_b64_tr_b16 v[122:123], v12 offset:15360
    s_waitcnt lgkmcnt(14)
    v_mfma_f32_16x16x32_bf16 v[52:55], v[76:79], v[100:103], v[52:55]
    ds_read_b32 v92, v18 offset:4096
    ds_read_b32 v93, v18 offset:4160
    v_mfma_f32_16x16x32_bf16 v[56:59], v[76:79], v[104:107], v[56:59]
    ds_read_b32 v94, v18 offset:4224
    ds_read_b32 v95, v18 offset:4288
    v_mfma_f32_16x16x32_bf16 v[60:63], v[76:79], v[108:111], v[60:63]
    ds_read_b32 v96, v18 offset:5120
    ds_read_b32 v97, v18 offset:5184
    v_mfma_f32_16x16x32_bf16 v[64:67], v[80:83], v[100:103], v[64:67]
    ds_read_b32 v98, v18 offset:5248
    ds_read_b32 v99, v18 offset:5312
    v_mfma_f32_16x16x32_bf16 v[68:71], v[80:83], v[104:107], v[68:71]
    ds_read_b64_tr_b16 v[124:125], v10 offset:18432
    ds_read_b64_tr_b16 v[126:127], v10 offset:21504
    v_mfma_f32_16x16x32_bf16 v[72:75], v[80:83], v[108:111], v[72:75]
    ds_read_b64_tr_b16 v[128:129], v11 offset:18432
    ds_read_b64_tr_b16 v[130:131], v11 offset:21504
    ds_read_b64_tr_b16 v[132:133], v12 offset:18432
    ds_read_b64_tr_b16 v[134:135], v12 offset:21504
    s_waitcnt lgkmcnt(0)
    s_barrier
    v_mfma_f32_16x16x32_bf16 v[52:55], v[84:87], v[112:115], v[52:55]
    v_mfma_f32_16x16x32_bf16 v[56:59], v[84:87], v[116:119], v[56:59]
    v_mfma_f32_16x16x32_bf16 v[60:63], v[84:87], v[120:123], v[60:63]
    v_mfma_f32_16x16x32_bf16 v[64:67], v[88:91], v[112:115], v[64:67]
    v_mfma_f32_16x16x32_bf16 v[68:71], v[88:91], v[116:119], v[68:71]
    v_mfma_f32_16x16x32_bf16 v[72:75], v[88:91], v[120:123], v[72:75]
    v_mfma_f32_16x16x32_bf16 v[52:55], v[92:95], v[124:127], v[52:55]
    v_mfma_f32_16x16x32_bf16 v[56:59], v[92:95], v[128:131], v[56:59]
    v_mfma_f32_16x16x32_bf16 v[60:63], v[92:95], v[132:135], v[60:63]
    v_mfma_f32_16x16x32_bf16 v[64:67], v[96:99], v[124:127], v[64:67]
    v_mfma_f32_16x16x32_bf16 v[68:71], v[96:99], v[128:131], v[68:71]
    v_mfma_f32_16x16x32_bf16 v[72:75], v[96:99], v[132:135], v[72:75]
    s_nop 2
    v_cvt_pk_bf16_f32 v28, v52, v53
    v_cvt_pk_bf16_f32 v29, v54, v55
    s_nop 0
    v_cvt_pk_bf16_f32 v30, v64, v65
    v_cvt_pk_bf16_f32 v31, v66, v67
    v_cvt_pk_bf16_f32 v32, v56, v57
    v_cvt_pk_bf16_f32 v33, v58, v59
    v_cvt_pk_bf16_f32 v34, v68, v69
    v_cvt_pk_bf16_f32 v35, v70, v71
    v_cvt_pk_bf16_f32 v36, v60, v61
    v_cvt_pk_bf16_f32 v37, v62, v63
    v_cvt_pk_bf16_f32 v38, v72, v73
    v_cvt_pk_bf16_f32 v39, v74, v75
    v_lshlrev_b32 v52, 16, v28
    v_and_b32 v53, 0xffff0000, v28
    v_pk_mul_f32 v[84:85], v[52:53], v[52:53]
    v_lshlrev_b32 v54, 16, v29
    v_and_b32 v55, 0xffff0000, v29
    v_pk_mul_f32 v[86:87], v[54:55], v[54:55]
    v_lshlrev_b32 v64, 16, v30
    v_and_b32 v65, 0xffff0000, v30
    v_pk_mul_f32 v[88:89], v[64:65], v[64:65]
    v_lshlrev_b32 v66, 16, v31
    v_and_b32 v67, 0xffff0000, v31
    v_pk_mul_f32 v[90:91], v[66:67], v[66:67]
    v_lshlrev_b32 v56, 16, v32
    v_and_b32 v57, 0xffff0000, v32
    v_pk_fma_f32 v[84:85], v[56:57], v[56:57], v[84:85]
    v_pk_add_f32 v[76:77], v[52:53], v[56:57]
    v_lshlrev_b32 v58, 16, v33
    v_and_b32 v59, 0xffff0000, v33
    v_pk_fma_f32 v[86:87], v[58:59], v[58:59], v[86:87]
    v_pk_add_f32 v[78:79], v[54:55], v[58:59]
    v_lshlrev_b32 v68, 16, v34
    v_and_b32 v69, 0xffff0000, v34
    v_pk_fma_f32 v[88:89], v[68:69], v[68:69], v[88:89]
    v_pk_add_f32 v[80:81], v[64:65], v[68:69]
    v_lshlrev_b32 v70, 16, v35
    v_and_b32 v71, 0xffff0000, v35
    v_pk_fma_f32 v[90:91], v[70:71], v[70:71], v[90:91]
    v_pk_add_f32 v[82:83], v[66:67], v[70:71]
    v_lshlrev_b32 v60, 16, v36
    v_and_b32 v61, 0xffff0000, v36
    v_pk_fma_f32 v[84:85], v[60:61], v[60:61], v[84:85]
    v_pk_add_f32 v[76:77], v[76:77], v[60:61]
    v_lshlrev_b32 v62, 16, v37
    v_and_b32 v63, 0xffff0000, v37
    v_pk_fma_f32 v[86:87], v[62:63], v[62:63], v[86:87]
    v_pk_add_f32 v[78:79], v[78:79], v[62:63]
    v_lshlrev_b32 v72, 16, v38
    v_and_b32 v73, 0xffff0000, v38
    v_pk_fma_f32 v[88:89], v[72:73], v[72:73], v[88:89]
    v_pk_add_f32 v[80:81], v[80:81], v[72:73]
    v_lshlrev_b32 v74, 16, v39
    v_and_b32 v75, 0xffff0000, v39
    v_pk_fma_f32 v[90:91], v[74:75], v[74:75], v[90:91]
    v_pk_add_f32 v[82:83], v[82:83], v[74:75]
    v_add_f32_dpp v76, v76, v76 row_ror:8 row_mask:0xf bank_mask:0xf
    v_add_f32_dpp v77, v77, v77 row_ror:8 row_mask:0xf bank_mask:0xf
    v_add_f32_dpp v78, v78, v78 row_ror:8 row_mask:0xf bank_mask:0xf
    v_add_f32_dpp v79, v79, v79 row_ror:8 row_mask:0xf bank_mask:0xf
    v_add_f32_dpp v80, v80, v80 row_ror:8 row_mask:0xf bank_mask:0xf
    v_add_f32_dpp v81, v81, v81 row_ror:8 row_mask:0xf bank_mask:0xf
    v_add_f32_dpp v82, v82, v82 row_ror:8 row_mask:0xf bank_mask:0xf
    v_add_f32_dpp v83, v83, v83 row_ror:8 row_mask:0xf bank_mask:0xf
    v_add_f32_dpp v84, v84, v84 row_ror:8 row_mask:0xf bank_mask:0xf
    v_add_f32_dpp v85, v85, v85 row_ror:8 row_mask:0xf bank_mask:0xf
    v_add_f32_dpp v86, v86, v86 row_ror:8 row_mask:0xf bank_mask:0xf
    v_add_f32_dpp v87, v87, v87 row_ror:8 row_mask:0xf bank_mask:0xf
    v_add_f32_dpp v88, v88, v88 row_ror:8 row_mask:0xf bank_mask:0xf
    v_add_f32_dpp v89, v89, v89 row_ror:8 row_mask:0xf bank_mask:0xf
    v_add_f32_dpp v90, v90, v90 row_ror:8 row_mask:0xf bank_mask:0xf
    v_add_f32_dpp v91, v91, v91 row_ror:8 row_mask:0xf bank_mask:0xf
    v_add_f32_dpp v76, v76, v76 row_ror:4 row_mask:0xf bank_mask:0xf
    v_add_f32_dpp v77, v77, v77 row_ror:4 row_mask:0xf bank_mask:0xf
    v_add_f32_dpp v78, v78, v78 row_ror:4 row_mask:0xf bank_mask:0xf
    v_add_f32_dpp v79, v79, v79 row_ror:4 row_mask:0xf bank_mask:0xf
    v_add_f32_dpp v80, v80, v80 row_ror:4 row_mask:0xf bank_mask:0xf
    v_add_f32_dpp v81, v81, v81 row_ror:4 row_mask:0xf bank_mask:0xf
    v_add_f32_dpp v82, v82, v82 row_ror:4 row_mask:0xf bank_mask:0xf
    v_add_f32_dpp v83, v83, v83 row_ror:4 row_mask:0xf bank_mask:0xf
    v_add_f32_dpp v84, v84, v84 row_ror:4 row_mask:0xf bank_mask:0xf
    v_add_f32_dpp v85, v85, v85 row_ror:4 row_mask:0xf bank_mask:0xf
    v_add_f32_dpp v86, v86, v86 row_ror:4 row_mask:0xf bank_mask:0xf
    v_add_f32_dpp v87, v87, v87 row_ror:4 row_mask:0xf bank_mask:0xf
    v_add_f32_dpp v88, v88, v88 row_ror:4 row_mask:0xf bank_mask:0xf
    v_add_f32_dpp v89, v89, v89 row_ror:4 row_mask:0xf bank_mask:0xf
    v_add_f32_dpp v90, v90, v90 row_ror:4 row_mask:0xf bank_mask:0xf
    v_add_f32_dpp v91, v91, v91 row_ror:4 row_mask:0xf bank_mask:0xf
    v_add_f32_dpp v76, v76, v76 row_ror:2 row_mask:0xf bank_mask:0xf
    v_add_f32_dpp v77, v77, v77 row_ror:2 row_mask:0xf bank_mask:0xf
    v_add_f32_dpp v78, v78, v78 row_ror:2 row_mask:0xf bank_mask:0xf
    v_add_f32_dpp v79, v79, v79 row_ror:2 row_mask:0xf bank_mask:0xf
    v_add_f32_dpp v80, v80, v80 row_ror:2 row_mask:0xf bank_mask:0xf
    v_add_f32_dpp v81, v81, v81 row_ror:2 row_mask:0xf bank_mask:0xf
    v_add_f32_dpp v82, v82, v82 row_ror:2 row_mask:0xf bank_mask:0xf
    v_add_f32_dpp v83, v83, v83 row_ror:2 row_mask:0xf bank_mask:0xf
    v_add_f32_dpp v84, v84, v84 row_ror:2 row_mask:0xf bank_mask:0xf
    v_add_f32_dpp v85, v85, v85 row_ror:2 row_mask:0xf bank_mask:0xf
    v_add_f32_dpp v86, v86, v86 row_ror:2 row_mask:0xf bank_mask:0xf
    v_add_f32_dpp v87, v87, v87 row_ror:2 row_mask:0xf bank_mask:0xf
    v_add_f32_dpp v88, v88, v88 row_ror:2 row_mask:0xf bank_mask:0xf
    v_add_f32_dpp v89, v89, v89 row_ror:2 row_mask:0xf bank_mask:0xf
    v_add_f32_dpp v90, v90, v90 row_ror:2 row_mask:0xf bank_mask:0xf
    v_add_f32_dpp v91, v91, v91 row_ror:2 row_mask:0xf bank_mask:0xf
    v_add_f32_dpp v76, v76, v76 row_ror:1 row_mask:0xf bank_mask:0xf
    v_add_f32_dpp v77, v77, v77 row_ror:1 row_mask:0xf bank_mask:0xf
    v_add_f32_dpp v78, v78, v78 row_ror:1 row_mask:0xf bank_mask:0xf
    v_add_f32_dpp v79, v79, v79 row_ror:1 row_mask:0xf bank_mask:0xf
    v_add_f32_dpp v80, v80, v80 row_ror:1 row_mask:0xf bank_mask:0xf
    v_add_f32_dpp v81, v81, v81 row_ror:1 row_mask:0xf bank_mask:0xf
    v_add_f32_dpp v82, v82, v82 row_ror:1 row_mask:0xf bank_mask:0xf
    v_add_f32_dpp v83, v83, v83 row_ror:1 row_mask:0xf bank_mask:0xf
    v_add_f32_dpp v84, v84, v84 row_ror:1 row_mask:0xf bank_mask:0xf
    v_add_f32_dpp v85, v85, v85 row_ror:1 row_mask:0xf bank_mask:0xf
    v_add_f32_dpp v86, v86, v86 row_ror:1 row_mask:0xf bank_mask:0xf
    v_add_f32_dpp v87, v87, v87 row_ror:1 row_mask:0xf bank_mask:0xf
    v_add_f32_dpp v88, v88, v88 row_ror:1 row_mask:0xf bank_mask:0xf
    v_add_f32_dpp v89, v89, v89 row_ror:1 row_mask:0xf bank_mask:0xf
    v_add_f32_dpp v90, v90, v90 row_ror:1 row_mask:0xf bank_mask:0xf
    v_add_f32_dpp v91, v91, v91 row_ror:1 row_mask:0xf bank_mask:0xf
    v_mov_b32 v112, v76
    v_or_b32 v113, 0x80000000, v84
    v_mov_b32 v114, v77
    v_or_b32 v115, 0x80000000, v85
    v_mov_b32 v116, v78
    v_or_b32 v117, 0x80000000, v86
    v_mov_b32 v118, v79
    v_or_b32 v119, 0x80000000, v87
    v_mov_b32 v120, v80
    v_or_b32 v121, 0x80000000, v88
    v_mov_b32 v122, v81
    v_or_b32 v123, 0x80000000, v89
    v_mov_b32 v124, v82
    v_or_b32 v125, 0x80000000, v90
    v_mov_b32 v126, v83
    v_or_b32 v127, 0x80000000, v91
    s_lshl_b32 s31, s24, 1
    s_add_u32 s31, s31, s26
    s_lshl_b32 s33, s31, 8
    s_add_u32 s33, s33, 20971520
    s_lshl_b32 s30, s25, 1
    s_add_u32 s30, s30, s27
    s_lshl_b32 s30, s30, 14
    s_add_u32 s30, s30, s33
    v_cmp_eq_u32 s[38:39], 1, v4
    v_cmp_eq_u32 s[40:41], 2, v4
    v_cmp_eq_u32 s[42:43], 3, v4
    v_cmp_gt_u32 vcc, 4, v4
    v_lshrrev_b32 v5, 1, v4
    v_lshlrev_b32 v5, 7, v5
    v_lshl_add_u32 v5, v3, 5, v5
    v_and_b32 v6, 1, v4
    v_lshl_add_u32 v5, v6, 4, v5
    v_cndmask_b32 v112, v112, v116, s[38:39]
    v_cndmask_b32 v113, v113, v117, s[38:39]
    v_cndmask_b32 v114, v114, v118, s[38:39]
    v_cndmask_b32 v115, v115, v119, s[38:39]
    v_cndmask_b32 v112, v112, v120, s[40:41]
    v_cndmask_b32 v113, v113, v121, s[40:41]
    v_cndmask_b32 v114, v114, v122, s[40:41]
    v_cndmask_b32 v115, v115, v123, s[40:41]
    v_cndmask_b32 v112, v112, v124, s[42:43]
    v_cndmask_b32 v113, v113, v125, s[42:43]
    v_cndmask_b32 v114, v114, v126, s[42:43]
    v_cndmask_b32 v115, v115, v127, s[42:43]
    s_and_saveexec_b64 s[38:39], vcc
    buffer_store_dwordx4 v[112:115], v5, s[20:23], s30 offen sc0 sc1
    s_mov_b64 exec, s[38:39]
    v_lshlrev_b32 v10, 4, v1
    s_mul_i32 s30, s25, 6
    s_mul_i32 s32, s27, 3
    s_add_u32 s30, s30, s32
    s_mul_i32 s30, s30, 66560
    s_lshl_b32 s32, s31, 10
    s_add_u32 s30, s30, s32
    s_add_u32 s32, s30, 16777216
    s_add_u32 s30, s30, 12582912
    s_mov_b32 s35, s30
    v_lshrrev_b32 v5, 5, v1
    v_mul_u32_u24 v11, 98304, v5
    v_and_b32 v5, 31, v1
    v_lshl_add_u32 v11, v5, 3, v11
    s_add_u32 s40, s33, 0
    s_add_u32 s41, s33, 16384
    s_add_u32 s42, s33, 32768
    s_add_u32 s43, s33, 49152
    s_add_u32 s44, s33, 65536
    s_add_u32 s45, s33, 81920
    s_mov_b32 s37, 0x40000
    s_waitcnt vmcnt(0)
POLL_m_55:
    buffer_load_dwordx2 v[100:101], v11, s[20:23], s40 offen sc0 sc1
    buffer_load_dwordx2 v[102:103], v11, s[20:23], s41 offen sc0 sc1
    buffer_load_dwordx2 v[104:105], v11, s[20:23], s42 offen sc0 sc1
    buffer_load_dwordx2 v[106:107], v11, s[20:23], s43 offen sc0 sc1
    buffer_load_dwordx2 v[108:109], v11, s[20:23], s44 offen sc0 sc1
    buffer_load_dwordx2 v[110:111], v11, s[20:23], s45 offen sc0 sc1
    s_waitcnt vmcnt(0)
    v_and_b32 v6, v101, v103
    v_and_b32 v7, v105, v107
    v_and_b32 v8, v109, v111
    v_and_b32 v6, v6, v7
    v_and_b32 v6, v6, v8
    v_cmp_le_i32 vcc, 0, v6
    s_sub_u32 s37, s37, 1
    s_cmp_eq_u32 s37, 0
    s_cbranch_scc1 GO_m_56
    s_cbranch_vccz GO_m_56
    s_sleep 1
    s_branch POLL_m_55
GO_m_56:
    buffer_store_dwordx4 v[28:31], v10, s[20:23], s35 offen sc0 sc1
    s_add_u32 s35, s35, 66560
    buffer_store_dwordx4 v[32:35], v10, s[20:23], s35 offen sc0 sc1
    s_add_u32 s35, s35, 66560
    buffer_store_dwordx4 v[36:39], v10, s[20:23], s35 offen sc0 sc1
    s_add_u32 s35, s35, 66560
    v_add_f32 v100, v100, v102
    v_add_f32 v101, v101, v103
    v_add_f32 v100, v100, v104
    v_add_f32 v101, v101, v105
    v_add_f32 v100, v100, v106
    v_add_f32 v101, v101, v107
    v_add_f32 v100, v100, v108
    v_add_f32 v101, v101, v109
    v_add_f32 v100, v100, v110
    v_add_f32 v101, v101, v111
    v_mov_b32 v102, v100
    v_mov_b32 v103, v101
    s_nop 0
    v_permlane32_swap_b32 v100, v102
    v_permlane32_swap_b32 v101, v103
    v_add_f32 v100, v100, v102
    v_add_f32 v101, v101, v103
    s_mov_b32 s34, 0x3ae38e39
    v_mul_f32 v100, s34, v100
    v_mul_f32 v101, s34, -v101
    v_fma_f32 v101, -v100, v100, v101
    v_max_f32 v101, 0, v101
    v_add_f32 v102, 0x3727c5ac, v101
    v_rsq_f32 v102, v102
    s_nop 0
    v_mul_f32 v101, v101, v102
    v_mul_f32 v101, v101, v102
    v_add_f32 v101, 0x3727c5ac, v101
    v_rsq_f32 v101, v101
    s_nop 0
    v_mul_f32 v102, v102, v101
    v_mul_f32 v103, -v100, v102
    s_lshl_b32 s33, s28, 8
    s_add_u32 s33, s33, 159744
    v_lshlrev_b32 v5, 3, v5
    v_add_u32 v5, s33, v5
    ds_write_b64 v5, v[102:103]
    v_lshlrev_b32 v5, 5, v3
    v_add_u32 v5, s33, v5
    s_waitcnt lgkmcnt(0)
    ds_read_b128 v[76:79], v5 offset:0
    ds_read_b128 v[80:83], v5 offset:16
    ds_read_b128 v[84:87], v5 offset:128
    ds_read_b128 v[88:91], v5 offset:144
    s_lshl_b32 s30, s25, 12
    s_lshl_b32 s31, s24, 7
    s_add_u32 s30, s30, s31
    s_add_u32 s30, s30, 21233664
    v_mov_b32 v6, 0
    v_mov_b32 v7, 1
    s_waitcnt lgkmcnt(0)
    v_fma_f32 v52, v52, v76, v77
    v_fma_f32 v53, v53, v78, v79
    v_fma_f32 v54, v54, v80, v81
    v_fma_f32 v55, v55, v82, v83
    v_cvt_pk_bf16_f32 v40, v52, v53
    v_cvt_pk_bf16_f32 v41, v54, v55
    v_fma_f32 v64, v64, v84, v85
    v_fma_f32 v65, v65, v86, v87
    v_fma_f32 v66, v66, v88, v89
    v_fma_f32 v67, v67, v90, v91
    v_cvt_pk_bf16_f32 v42, v64, v65
    v_cvt_pk_bf16_f32 v43, v66, v67
    buffer_store_dwordx4 v[40:43], v10, s[20:23], s32 offen sc0 sc1
    s_add_u32 s32, s32, 66560
    v_fma_f32 v56, v56, v76, v77
    v_fma_f32 v57, v57, v78, v79
    v_fma_f32 v58, v58, v80, v81
    v_fma_f32 v59, v59, v82, v83
    v_cvt_pk_bf16_f32 v44, v56, v57
    v_cvt_pk_bf16_f32 v45, v58, v59
    v_fma_f32 v68, v68, v84, v85
    v_fma_f32 v69, v69, v86, v87
    v_fma_f32 v70, v70, v88, v89
    v_fma_f32 v71, v71, v90, v91
    v_cvt_pk_bf16_f32 v46, v68, v69
    v_cvt_pk_bf16_f32 v47, v70, v71
    buffer_store_dwordx4 v[44:47], v10, s[20:23], s32 offen sc0 sc1
    s_add_u32 s32, s32, 66560
    v_fma_f32 v60, v60, v76, v77
    v_fma_f32 v61, v61, v78, v79
    v_fma_f32 v62, v62, v80, v81
    v_fma_f32 v63, v63, v82, v83
    v_cvt_pk_bf16_f32 v48, v60, v61
    v_cvt_pk_bf16_f32 v49, v62, v63
    v_fma_f32 v72, v72, v84, v85
    v_fma_f32 v73, v73, v86, v87
    v_fma_f32 v74, v74, v88, v89
    v_fma_f32 v75, v75, v90, v91
    v_cvt_pk_bf16_f32 v50, v72, v73
    v_cvt_pk_bf16_f32 v51, v74, v75
    buffer_store_dwordx4 v[48:51], v10, s[20:23], s32 offen sc0 sc1
    s_add_u32 s32, s32, 66560
    s_waitcnt vmcnt(0)
    v_mov_b32 v8, 160772
    s_mov_b64 exec, 1
    ds_add_rtn_u32 v8, v8, v7
    s_waitcnt lgkmcnt(0)
    v_readfirstlane_b32 s31, v8
    s_nop 0
    s_cmp_lg_u32 s31, 3
    s_cbranch_scc1 NL_m_57
    buffer_store_dword v7, v6, s[20:23], s30 offen sc0 sc1
    v_mov_b32 v8, 160772
    s_waitcnt vmcnt(0)
    ds_add_u32 v8, v7
NL_m_57:
    s_mov_b64 exec, -1
    s_branch P4_m_7
P3PROD_m_53:
    s_and_b32 s29, s28, 1
    s_cmp_ge_u32 s28, 6
    s_cbranch_scc1 P3PO_m_54
    v_add_u32 v5, 0, v1
    v_mul_u32_u24 v6, 5462, v5
    v_lshrrev_b32 v6, 16, v6
    v_mul_u32_u24 v7, 12, v6
    v_sub_u32 v5, v5, v7
    v_bfe_u32 v7, v6, 2, 1
    v_lshlrev_b32 v7, 1, v7
    v_xor_b32 v5, v5, v7
    v_lshlrev_b32 v16, 4, v5
    v_and_b32 v7, 7, v6
    v_bfe_u32 v8, v6, 3, 1
    v_mad_u32_u24 v7, v8, 20, v7
    v_bfe_u32 v8, v6, 4, 1
    v_lshl_add_u32 v7, v8, 3, v7
    v_mul_u32_u24 v7, 1152, v7
    v_add_u32 v10, v7, v16
    v_add_u32 v5, 64, v1
    v_mul_u32_u24 v6, 5462, v5
    v_lshrrev_b32 v6, 16, v6
    v_mul_u32_u24 v7, 12, v6
    v_sub_u32 v5, v5, v7
    v_bfe_u32 v7, v6, 2, 1
    v_lshlrev_b32 v7, 1, v7
    v_xor_b32 v5, v5, v7
    v_lshlrev_b32 v17, 4, v5
    v_and_b32 v7, 7, v6
    v_bfe_u32 v8, v6, 3, 1
    v_mad_u32_u24 v7, v8, 20, v7
    v_bfe_u32 v8, v6, 4, 1
    v_lshl_add_u32 v7, v8, 3, v7
    v_mul_u32_u24 v7, 1152, v7
    v_add_u32 v11, v7, v17
    v_add_u32 v5, 128, v1
    v_mul_u32_u24 v6, 5462, v5
    v_lshrrev_b32 v6, 16, v6
    v_mul_u32_u24 v7, 12, v6
    v_sub_u32 v5, v5, v7
    v_bfe_u32 v7, v6, 2, 1
    v_lshlrev_b32 v7, 1, v7
    v_xor_b32 v5, v5, v7
    v_lshlrev_b32 v18, 4, v5
    v_and_b32 v7, 7, v6
    v_bfe_u32 v8, v6, 3, 1
    v_mad_u32_u24 v7, v8, 20, v7
    v_bfe_u32 v8, v6, 4, 1
    v_lshl_add_u32 v7, v8, 3, v7
    v_mul_u32_u24 v7, 1152, v7
    v_add_u32 v12, v7, v18
    v_add_u32 v5, 192, v1
    v_mul_u32_u24 v6, 5462, v5
    v_lshrrev_b32 v6, 16, v6
    v_mul_u32_u24 v7, 12, v6
    v_sub_u32 v5, v5, v7
    v_bfe_u32 v7, v6, 2, 1
    v_lshlrev_b32 v7, 1, v7
    v_xor_b32 v5, v5, v7
    v_lshlrev_b32 v19, 4, v5
    v_and_b32 v7, 7, v6
    v_bfe_u32 v8, v6, 3, 1
    v_mad_u32_u24 v7, v8, 20, v7
    v_bfe_u32 v8, v6, 4, 1
    v_lshl_add_u32 v7, v8, 3, v7
    v_mul_u32_u24 v7, 1152, v7
    v_add_u32 v13, v7, v19
    v_add_u32 v5, 256, v1
    v_mul_u32_u24 v6, 5462, v5
    v_lshrrev_b32 v6, 16, v6
    v_mul_u32_u24 v7, 12, v6
    v_sub_u32 v5, v5, v7
    v_bfe_u32 v7, v6, 2, 1
    v_lshlrev_b32 v7, 1, v7
    v_xor_b32 v5, v5, v7
    v_lshlrev_b32 v20, 4, v5
    v_and_b32 v7, 7, v6
    v_bfe_u32 v8, v6, 3, 1
    v_mad_u32_u24 v7, v8, 20, v7
    v_bfe_u32 v8, v6, 4, 1
    v_lshl_add_u32 v7, v8, 3, v7
    v_mul_u32_u24 v7, 1152, v7
    v_add_u32 v14, v7, v20
    v_add_u32 v5, 320, v1
    v_mul_u32_u24 v6, 5462, v5
    v_lshrrev_b32 v6, 16, v6
    v_mul_u32_u24 v7, 12, v6
    v_sub_u32 v5, v5, v7
    v_bfe_u32 v7, v6, 2, 1
    v_lshlrev_b32 v7, 1, v7
    v_xor_b32 v5, v5, v7
    v_lshlrev_b32 v21, 4, v5
    v_and_b32 v7, 7, v6
    v_bfe_u32 v8, v6, 3, 1
    v_mad_u32_u24 v7, v8, 20, v7
    v_bfe_u32 v8, v6, 4, 1
    v_lshl_add_u32 v7, v8, 3, v7
    v_mul_u32_u24 v7, 1152, v7
    v_add_u32 v15, v7, v21
    s_mul_i32 s33, s25, 192
    s_mul_i32 s30, s29, 331776
    s_add_u32 s39, s33, s30
    s_mul_i32 s30, s29, 41472
    s_add_u32 s33, s33, s30
    s_mul_i32 s35, s29, 6144
    s_add_u32 s35, s35, 73728
    s_mov_b32 s16, s68
    s_and_b32 s17, s69, 0xffff
    s_mov_b32 s18, 663552
    s_mov_b32 s19, 0x20000
    s_add_u32 m0, s35, 0
    s_nop 0
    buffer_load_dwordx4 v10, s[16:19], s33 offen lds
    s_add_u32 m0, s35, 1024
    s_nop 0
    buffer_load_dwordx4 v11, s[16:19], s33 offen lds
    s_add_u32 m0, s35, 2048
    s_nop 0
    buffer_load_dwordx4 v12, s[16:19], s33 offen lds
    s_add_u32 m0, s35, 3072
    s_nop 0
    buffer_load_dwordx4 v13, s[16:19], s33 offen lds
    s_add_u32 m0, s35, 4096
    s_nop 0
    buffer_load_dwordx4 v14, s[16:19], s33 offen lds
    s_add_u32 m0, s35, 5120
    s_nop 0
    buffer_load_dwordx4 v15, s[16:19], s33 offen lds
    s_add_u32 s33, s33, 82944
    s_add_u32 m0, s35, 12288
    s_nop 0
    buffer_load_dwordx4 v10, s[16:19], s33 offen lds
    s_add_u32 m0, s35, 13312
    s_nop 0
    buffer_load_dwordx4 v11, s[16:19], s33 offen lds
    s_add_u32 m0, s35, 14336
    s_nop 0
    buffer_load_dwordx4 v12, s[16:19], s33 offen lds
    s_add_u32 m0, s35, 15360
    s_nop 0
    buffer_load_dwordx4 v13, s[16:19], s33 offen lds
    s_add_u32 m0, s35, 16384
    s_nop 0
    buffer_load_dwordx4 v14, s[16:19], s33 offen lds
    s_add_u32 m0, s35, 17408
    s_nop 0
    buffer_load_dwordx4 v15, s[16:19], s33 offen lds
    s_add_u32 s33, s33, 82944
    s_add_u32 m0, s35, 24576
    s_nop 0
    buffer_load_dwordx4 v10, s[16:19], s33 offen lds
    s_add_u32 m0, s35, 25600
    s_nop 0
    buffer_load_dwordx4 v11, s[16:19], s33 offen lds
    s_add_u32 m0, s35, 26624
    s_nop 0
    buffer_load_dwordx4 v12, s[16:19], s33 offen lds
    s_add_u32 m0, s35, 27648
    s_nop 0
    buffer_load_dwordx4 v13, s[16:19], s33 offen lds
    s_add_u32 m0, s35, 28672
    s_nop 0
    buffer_load_dwordx4 v14, s[16:19], s33 offen lds
    s_add_u32 m0, s35, 29696
    s_nop 0
    buffer_load_dwordx4 v15, s[16:19], s33 offen lds
    s_add_u32 s33, s33, 82944
    s_add_u32 m0, s35, 36864
    s_nop 0
    buffer_load_dwordx4 v10, s[16:19], s33 offen lds
    s_add_u32 m0, s35, 37888
    s_nop 0
    buffer_load_dwordx4 v11, s[16:19], s33 offen lds
    s_add_u32 m0, s35, 38912
    s_nop 0
    buffer_load_dwordx4 v12, s[16:19], s33 offen lds
    s_add_u32 m0, s35, 39936
    s_nop 0
    buffer_load_dwordx4 v13, s[16:19], s33 offen lds
    s_add_u32 m0, s35, 40960
    s_nop 0
    buffer_load_dwordx4 v14, s[16:19], s33 offen lds
    s_add_u32 m0, s35, 41984
    s_nop 0
    buffer_load_dwordx4 v15, s[16:19], s33 offen lds
    s_add_u32 s33, s33, 82944
    s_add_u32 m0, s35, 49152
    s_nop 0
    buffer_load_dwordx4 v10, s[16:19], s33 offen lds
    s_add_u32 m0, s35, 50176
    s_nop 0
    buffer_load_dwordx4 v11, s[16:19], s33 offen lds
    s_add_u32 m0, s35, 51200
    s_nop 0
    buffer_load_dwordx4 v12, s[16:19], s33 offen lds
    s_add_u32 m0, s35, 52224
    s_nop 0
    buffer_load_dwordx4 v13, s[16:19], s33 offen lds
    s_add_u32 m0, s35, 53248
    s_nop 0
    buffer_load_dwordx4 v14, s[16:19], s33 offen lds
    s_add_u32 m0, s35, 54272
    s_nop 0
    buffer_load_dwordx4 v15, s[16:19], s33 offen lds
    s_add_u32 s33, s33, 82944
    s_add_u32 m0, s35, 61440
    s_nop 0
    buffer_load_dwordx4 v10, s[16:19], s33 offen lds
    s_add_u32 m0, s35, 62464
    s_nop 0
    buffer_load_dwordx4 v11, s[16:19], s33 offen lds
    s_add_u32 m0, s35, 63488
    s_nop 0
    buffer_load_dwordx4 v12, s[16:19], s33 offen lds
    s_add_u32 m0, s35, 64512
    s_nop 0
    buffer_load_dwordx4 v13, s[16:19], s33 offen lds
    s_add_u32 m0, s35, 65536
    s_nop 0
    buffer_load_dwordx4 v14, s[16:19], s33 offen lds
    s_add_u32 m0, s35, 66560
    s_nop 0
    buffer_load_dwordx4 v15, s[16:19], s33 offen lds
    s_add_u32 s33, s33, 82944
    s_add_u32 m0, s35, 73728
    s_nop 0
    buffer_load_dwordx4 v10, s[16:19], s33 offen lds
    s_add_u32 m0, s35, 74752
    s_nop 0
    buffer_load_dwordx4 v11, s[16:19], s33 offen lds
    s_add_u32 m0, s35, 75776
    s_nop 0
    buffer_load_dwordx4 v12, s[16:19], s33 offen lds
    s_add_u32 m0, s35, 76800
    s_nop 0
    buffer_load_dwordx4 v13, s[16:19], s33 offen lds
    s_add_u32 m0, s35, 77824
    s_nop 0
    buffer_load_dwordx4 v14, s[16:19], s33 offen lds
    s_add_u32 m0, s35, 78848
    s_nop 0
    buffer_load_dwordx4 v15, s[16:19], s33 offen lds
    s_add_u32 s33, s33, 82944
    v_add_u32 v5, 0, v1
    v_mul_u32_u24 v6, 5462, v5
    v_lshrrev_b32 v6, 16, v6
    v_bfe_u32 v7, v6, 2, 2
    v_lshlrev_b32 v7, 1, v7
    v_bfe_u32 v8, v6, 4, 1
    v_add_u32 v7, v7, v8
    v_mul_u32_u24 v7, 36, v7
    v_and_b32 v8, 3, v6
    v_add3_u32 v7, v7, v8, 16
    v_mul_u32_u24 v7, 1152, v7
    v_add_u32 v16, v7, v16
    v_add_u32 v5, 64, v1
    v_mul_u32_u24 v6, 5462, v5
    v_lshrrev_b32 v6, 16, v6
    v_bfe_u32 v7, v6, 2, 2
    v_lshlrev_b32 v7, 1, v7
    v_bfe_u32 v8, v6, 4, 1
    v_add_u32 v7, v7, v8
    v_mul_u32_u24 v7, 36, v7
    v_and_b32 v8, 3, v6
    v_add3_u32 v7, v7, v8, 16
    v_mul_u32_u24 v7, 1152, v7
    v_add_u32 v17, v7, v17
    v_add_u32 v5, 128, v1
    v_mul_u32_u24 v6, 5462, v5
    v_lshrrev_b32 v6, 16, v6
    v_bfe_u32 v7, v6, 2, 2
    v_lshlrev_b32 v7, 1, v7
    v_bfe_u32 v8, v6, 4, 1
    v_add_u32 v7, v7, v8
    v_mul_u32_u24 v7, 36, v7
    v_and_b32 v8, 3, v6
    v_add3_u32 v7, v7, v8, 16
    v_mul_u32_u24 v7, 1152, v7
    v_add_u32 v18, v7, v18
    v_add_u32 v5, 192, v1
    v_mul_u32_u24 v6, 5462, v5
    v_lshrrev_b32 v6, 16, v6
    v_bfe_u32 v7, v6, 2, 2
    v_lshlrev_b32 v7, 1, v7
    v_bfe_u32 v8, v6, 4, 1
    v_add_u32 v7, v7, v8
    v_mul_u32_u24 v7, 36, v7
    v_and_b32 v8, 3, v6
    v_add3_u32 v7, v7, v8, 16
    v_mul_u32_u24 v7, 1152, v7
    v_add_u32 v19, v7, v19
    v_add_u32 v5, 256, v1
    v_mul_u32_u24 v6, 5462, v5
    v_lshrrev_b32 v6, 16, v6
    v_bfe_u32 v7, v6, 2, 2
    v_lshlrev_b32 v7, 1, v7
    v_bfe_u32 v8, v6, 4, 1
    v_add_u32 v7, v7, v8
    v_mul_u32_u24 v7, 36, v7
    v_and_b32 v8, 3, v6
    v_add3_u32 v7, v7, v8, 16
    v_mul_u32_u24 v7, 1152, v7
    v_add_u32 v20, v7, v20
    v_add_u32 v5, 320, v1
    v_mul_u32_u24 v6, 5462, v5
    v_lshrrev_b32 v6, 16, v6
    v_bfe_u32 v7, v6, 2, 2
    v_lshlrev_b32 v7, 1, v7
    v_bfe_u32 v8, v6, 4, 1
    v_add_u32 v7, v7, v8
    v_mul_u32_u24 v7, 36, v7
    v_and_b32 v8, 3, v6
    v_add3_u32 v7, v7, v8, 16
    v_mul_u32_u24 v7, 1152, v7
    v_add_u32 v21, v7, v21
    s_waitcnt vmcnt(0)
    s_barrier
    s_barrier
    s_add_u32 m0, s35, 0
    s_nop 0
    buffer_load_dwordx4 v10, s[16:19], s33 offen lds
    s_add_u32 m0, s35, 1024
    s_nop 0
    buffer_load_dwordx4 v11, s[16:19], s33 offen lds
    s_add_u32 m0, s35, 2048
    s_nop 0
    buffer_load_dwordx4 v12, s[16:19], s33 offen lds
    s_add_u32 m0, s35, 3072
    s_nop 0
    buffer_load_dwordx4 v13, s[16:19], s33 offen lds
    s_add_u32 m0, s35, 4096
    s_nop 0
    buffer_load_dwordx4 v14, s[16:19], s33 offen lds
    s_add_u32 m0, s35, 5120
    s_nop 0
    buffer_load_dwordx4 v15, s[16:19], s33 offen lds
    s_add_u32 s33, s33, 82944
    s_add_u32 m0, s35, 12288
    s_nop 0
    buffer_load_dwordx4 v16, s[16:19], s39 offen lds
    s_add_u32 m0, s35, 13312
    s_nop 0
    buffer_load_dwordx4 v17, s[16:19], s39 offen lds
    s_add_u32 m0, s35, 14336
    s_nop 0
    buffer_load_dwordx4 v18, s[16:19], s39 offen lds
    s_add_u32 m0, s35, 15360
    s_nop 0
    buffer_load_dwordx4 v19, s[16:19], s39 offen lds
    s_add_u32 m0, s35, 16384
    s_nop 0
    buffer_load_dwordx4 v20, s[16:19], s39 offen lds
    s_add_u32 m0, s35, 17408
    s_nop 0
    buffer_load_dwordx4 v21, s[16:19], s39 offen lds
    s_add_u32 s33, s33, 82944
    s_waitcnt vmcnt(12)
    s_barrier
    s_waitcnt vmcnt(0)
    s_barrier
    s_barrier
    s_branch P4_m_7
P3PO_m_54:
    v_lshrrev_b32 v5, 1, v3
    v_mul_u32_u24 v5, 66560, v5
    v_and_b32 v6, 1, v3
    v_lshl_add_u32 v5, v6, 9, v5
    v_lshl_add_u32 v5, v4, 4, v5
    v_lshrrev_b32 v6, 2, v1
    v_lshlrev_b32 v6, 13, v6
    v_and_b32 v7, 3, v1
    v_lshl_add_u32 v6, v7, 4, v6
    v_add_u32 v10, 0, v5
    v_add_u32 v14, 0, v6
    v_add_u32 v11, 256, v5
    v_add_u32 v15, 64, v6
    v_add_u32 v12, 1024, v5
    v_add_u32 v16, 128, v6
    v_add_u32 v13, 1280, v5
    v_add_u32 v17, 192, v6
    s_lshl_b32 s32, s24, 11
    s_mul_i32 s30, s29, 133120
    s_add_u32 s32, s32, s30
    s_add_u32 s32, s32, 8388608
    s_lshl_b32 s30, s29, 17
    s_lshl_b32 s38, s24, 8
    s_add_u32 s38, s38, s30
    s_add_u32 s38, s38, 11534336
    s_lshl_b32 s34, s29, 12
    s_lshr_b32 s30, s24, 1
    s_lshl_b32 s30, s30, 11
    s_add_u32 s30, s30, 21200896
    v_lshlrev_b32 v5, 7, v1
    s_cmp_eq_u32 s28, 7
    s_cbranch_scc1 W7_m_58
    s_waitcnt vmcnt(0)
    s_mov_b64 exec, 0xffff
    s_mov_b32 s37, 0x40000
POLL_m_60:
    buffer_load_dword v6, v5, s[20:23], s30 offen sc0 sc1
    s_waitcnt vmcnt(0)
    v_cmp_eq_u32 vcc, 0, v6
    s_sub_u32 s37, s37, 1
    s_cmp_eq_u32 s37, 0
    s_cbranch_scc1 GO_m_61
    s_cbranch_vccz GO_m_61
    s_sleep 1
    s_branch POLL_m_60
GO_m_61:
    s_mov_b64 exec, -1
    v_mov_b32 v5, 160788
    v_mov_b32 v6, 1
    ds_write_b32 v5, v6
    s_branch WD_m_59
W7_m_58:
    s_mov_b32 s37, 0x400000
LW_m_62:
    v_mov_b32 v5, 160788
    ds_read_b32 v5, v5
    s_waitcnt lgkmcnt(0)
    v_readfirstlane_b32 s31, v5
    s_nop 0
    s_cmp_ge_u32 s31, 1
    s_cbranch_scc1 LG_m_63
    s_sub_u32 s37, s37, 1
    s_cmp_eq_u32 s37, 0
    s_cbranch_scc1 LG_m_63
    s_sleep 1
    s_branch LW_m_62
LG_m_63:
WD_m_59:
    s_add_u32 m0, s34, 0
    s_nop 0
    buffer_load_dwordx4 v10, s[20:23], s32 offen sc1 lds
    s_add_u32 m0, s34, 1024
    s_nop 0
    buffer_load_dwordx4 v11, s[20:23], s32 offen sc1 lds
    s_add_u32 m0, s34, 2048
    s_nop 0
    buffer_load_dwordx4 v12, s[20:23], s32 offen sc1 lds
    s_add_u32 m0, s34, 3072
    s_nop 0
    buffer_load_dwordx4 v13, s[20:23], s32 offen sc1 lds
    s_add_u32 s32, s32, 266240
    s_add_u32 m0, s34, 8192
    s_nop 0
    buffer_load_dwordx4 v10, s[20:23], s32 offen sc1 lds
    s_add_u32 m0, s34, 9216
    s_nop 0
    buffer_load_dwordx4 v11, s[20:23], s32 offen sc1 lds
    s_add_u32 m0, s34, 10240
    s_nop 0
    buffer_load_dwordx4 v12, s[20:23], s32 offen sc1 lds
    s_add_u32 m0, s34, 11264
    s_nop 0
    buffer_load_dwordx4 v13, s[20:23], s32 offen sc1 lds
    s_add_u32 s32, s32, 266240
    s_add_u32 m0, s34, 16384
    s_nop 0
    buffer_load_dwordx4 v10, s[20:23], s32 offen sc1 lds
    s_add_u32 m0, s34, 17408
    s_nop 0
    buffer_load_dwordx4 v11, s[20:23], s32 offen sc1 lds
    s_add_u32 m0, s34, 18432
    s_nop 0
    buffer_load_dwordx4 v12, s[20:23], s32 offen sc1 lds
    s_add_u32 m0, s34, 19456
    s_nop 0
    buffer_load_dwordx4 v13, s[20:23], s32 offen sc1 lds
    s_add_u32 s32, s32, 266240
    s_add_u32 m0, s34, 24576
    s_nop 0
    buffer_load_dwordx4 v10, s[20:23], s32 offen sc1 lds
    s_add_u32 m0, s34, 25600
    s_nop 0
    buffer_load_dwordx4 v11, s[20:23], s32 offen sc1 lds
    s_add_u32 m0, s34, 26624
    s_nop 0
    buffer_load_dwordx4 v12, s[20:23], s32 offen sc1 lds
    s_add_u32 m0, s34, 27648
    s_nop 0
    buffer_load_dwordx4 v13, s[20:23], s32 offen sc1 lds
    s_add_u32 s32, s32, 266240
    s_add_u32 m0, s34, 32768
    s_nop 0
    buffer_load_dwordx4 v10, s[20:23], s32 offen sc1 lds
    s_add_u32 m0, s34, 33792
    s_nop 0
    buffer_load_dwordx4 v11, s[20:23], s32 offen sc1 lds
    s_add_u32 m0, s34, 34816
    s_nop 0
    buffer_load_dwordx4 v12, s[20:23], s32 offen sc1 lds
    s_add_u32 m0, s34, 35840
    s_nop 0
    buffer_load_dwordx4 v13, s[20:23], s32 offen sc1 lds
    s_add_u32 s32, s32, 266240
    s_waitcnt vmcnt(12)
    s_barrier
    s_add_u32 m0, s34, 40960
    s_nop 0
    buffer_load_dwordx4 v10, s[20:23], s32 offen sc1 lds
    s_add_u32 m0, s34, 41984
    s_nop 0
    buffer_load_dwordx4 v11, s[20:23], s32 offen sc1 lds
    s_add_u32 m0, s34, 43008
    s_nop 0
    buffer_load_dwordx4 v12, s[20:23], s32 offen sc1 lds
    s_add_u32 m0, s34, 44032
    s_nop 0
    buffer_load_dwordx4 v13, s[20:23], s32 offen sc1 lds
    s_add_u32 s32, s32, 266240
    s_add_u32 m0, s34, 49152
    s_nop 0
    buffer_load_dwordx4 v10, s[20:23], s32 offen sc1 lds
    s_add_u32 m0, s34, 50176
    s_nop 0
    buffer_load_dwordx4 v11, s[20:23], s32 offen sc1 lds
    s_add_u32 m0, s34, 51200
    s_nop 0
    buffer_load_dwordx4 v12, s[20:23], s32 offen sc1 lds
    s_add_u32 m0, s34, 52224
    s_nop 0
    buffer_load_dwordx4 v13, s[20:23], s32 offen sc1 lds
    s_add_u32 s32, s32, 266240
    s_add_u32 m0, s34, 57344
    s_nop 0
    buffer_load_dwordx4 v10, s[20:23], s32 offen sc1 lds
    s_add_u32 m0, s34, 58368
    s_nop 0
    buffer_load_dwordx4 v11, s[20:23], s32 offen sc1 lds
    s_add_u32 m0, s34, 59392
    s_nop 0
    buffer_load_dwordx4 v12, s[20:23], s32 offen sc1 lds
    s_add_u32 m0, s34, 60416
    s_nop 0
    buffer_load_dwordx4 v13, s[20:23], s32 offen sc1 lds
    s_add_u32 s32, s32, 266240
    s_add_u32 m0, s34, 65536
    s_nop 0
    buffer_load_dwordx4 v14, s[20:23], s38 offen sc1 lds
    s_add_u32 m0, s34, 66560
    s_nop 0
    buffer_load_dwordx4 v15, s[20:23], s38 offen sc1 lds
    s_add_u32 m0, s34, 67584
    s_nop 0
    buffer_load_dwordx4 v16, s[20:23], s38 offen sc1 lds
    s_add_u32 m0, s34, 68608
    s_nop 0
    buffer_load_dwordx4 v17, s[20:23], s38 offen sc1 lds
    s_add_u32 s32, s32, 266240
    s_waitcnt vmcnt(16)
    s_barrier
    s_waitcnt vmcnt(8)
    s_barrier
    s_waitcnt vmcnt(0)
    s_barrier
    s_barrier
    s_branch P4_m_7
P3PF_m_52:
    s_sub_u32 s29, s2, 192
    s_mov_b32 s52, s72
    s_and_b32 s53, s73, 0xffff
    s_mov_b32 s54, 18874368
    s_mov_b32 s55, 0x20000
    s_mul_i32 s60, s29, 92160
    s_add_u32 s60, s60, 12976128
    v_lshlrev_b32 v10, 7, v0
    buffer_load_dword v234, v10, s[52:55], s60 offen
    s_add_u32 s60, s60, 65536
    v_mov_b32 v11, 0x7ff00000
    v_cmp_gt_u32 vcc, 208, v0
    s_nop 1
    v_cndmask_b32 v10, v11, v10, vcc
    buffer_load_dword v234, v10, s[52:55], s60 offen
    s_add_u32 s60, s60, 65536
    s_mov_b32 s52, s76
    s_and_b32 s53, s77, 0xffff
    s_mov_b32 s54, 18874368
    s_mov_b32 s55, 0x20000
    s_mul_i32 s60, s29, 59904
    s_add_u32 s60, s60, 0
    v_lshlrev_b32 v10, 7, v0
    v_mov_b32 v11, 0x7ff00000
    v_cmp_gt_u32 vcc, 468, v0
    s_nop 1
    v_cndmask_b32 v10, v11, v10, vcc
    buffer_load_dword v234, v10, s[52:55], s60 offen
    s_add_u32 s60, s60, 65536
    s_branch P4_m_7
P4_m_7:
    s_cmp_ge_u32 s11, 27
    s_cbranch_scc1 P4PF_m_65
    s_mul_i32 s24, s11, 10923
    s_lshr_b32 s24, s24, 16
    s_mul_i32 s25, s24, 6
    s_sub_u32 s25, s11, s25
    s_and_b32 s29, s10, 1
    s_mul_i32 s30, s29, 5
    s_add_u32 s24, s24, s30
    s_mul_i32 s30, s29, 3
    s_add_u32 s30, s30, s25
    s_cmp_ge_u32 s11, 24
    s_cselect_b32 s24, 4, s24
    s_cselect_b32 s25, s30, s25
    s_mov_b32 s47, s24
    s_lshr_b32 s30, s10, 1
    s_mul_i32 s30, s30, 9
    s_add_u32 s24, s24, s30
    v_lshrrev_b32 v3, 4, v1
    v_and_b32 v4, 15, v1
    s_cmp_ge_u32 s28, 4
    s_cbranch_scc1 P4PROD_m_64
    s_lshr_b32 s26, s28, 1
    s_and_b32 s27, s28, 1
    s_mov_b32 s16, s74
    s_and_b32 s17, s75, 0xffff
    s_mov_b32 s18, 9216
    s_mov_b32 s19, 0x20000
    v_lshlrev_b32 v5, 3, v3
    s_lshl_b32 s30, s24, 8
    s_lshl_b32 s31, s26, 7
    s_add_u32 s30, s30, s31
    buffer_load_dwordx2 v[26:27], v5, s[16:19], s30 offen offset:0
    buffer_load_dwordx2 v[28:29], v5, s[16:19], s30 offen offset:32
    buffer_load_dwordx2 v[30:31], v5, s[16:19], s30 offen offset:64
    buffer_load_dwordx2 v[32:33], v5, s[16:19], s30 offen offset:96
    v_bfe_u32 v5, v1, 2, 2
    v_lshl_add_u32 v5, v3, 2, v5
    v_and_b32 v6, 7, v5
    v_lshlrev_b32 v5, 8, v5
    v_and_b32 v7, 3, v1
    v_lshl_add_u32 v5, v7, 3, v5
    s_lshl_b32 s30, s26, 2
    s_add_u32 s31, s30, 0
    v_xor_b32 v7, s31, v6
    v_lshl_add_u32 v10, v7, 5, v5
    v_add_u32 v14, 57344, v10
    v_add_u32 v18, 114688, v10
    s_add_u32 s31, s30, 1
    v_xor_b32 v7, s31, v6
    v_lshl_add_u32 v11, v7, 5, v5
    v_add_u32 v15, 57344, v11
    v_add_u32 v19, 114688, v11
    s_add_u32 s31, s30, 2
    v_xor_b32 v7, s31, v6
    v_lshl_add_u32 v12, v7, 5, v5
    v_add_u32 v16, 57344, v12
    v_add_u32 v20, 114688, v12
    s_add_u32 s31, s30, 3
    v_xor_b32 v7, s31, v6
    v_lshl_add_u32 v13, v7, 5, v5
    v_add_u32 v17, 57344, v13
    v_add_u32 v21, 114688, v13
    s_mul_i32 s30, s27, 3072
    s_add_u32 s30, s30, 16384
    v_lshlrev_b32 v22, 4, v1
    v_add_u32 v22, s30, v22
    v_add_u32 v23, 57344, v22
    v_add_u32 v24, 114688, v22
    s_mul_i32 s31, s25, 6
    s_mul_i32 s38, s27, 3
    s_add_u32 s31, s31, s38
    s_mul_i32 s31, s31, 147456
    s_lshl_b32 s38, s24, 12
    s_add_u32 s31, s31, s38
    s_lshl_b32 s38, s26, 11
    s_add_u32 s31, s31, s38
    s_add_u32 s40, s31, 25165824
    s_lshr_b32 s30, s10, 1
    s_mul_i32 s30, s30, 6
    s_add_u32 s30, s30, s25
    s_mul_i32 s30, s30, 9
    s_add_u32 s30, s30, s47
    s_lshl_b32 s30, s30, 7
    s_add_u32 s41, s30, 21258240
    s_waitcnt vmcnt(0)
    v_lshlrev_b32 v36, 16, v26
    v_and_b32 v37, 0xffff0000, v26
    v_lshlrev_b32 v38, 16, v27
    v_and_b32 v39, 0xffff0000, v27
    v_lshlrev_b32 v40, 16, v26
    v_and_b32 v41, 0xffff0000, v26
    v_lshlrev_b32 v42, 16, v27
    v_and_b32 v43, 0xffff0000, v27
    v_lshlrev_b32 v44, 16, v26
    v_and_b32 v45, 0xffff0000, v26
    v_lshlrev_b32 v46, 16, v27
    v_and_b32 v47, 0xffff0000, v27
    v_lshlrev_b32 v48, 16, v28
    v_and_b32 v49, 0xffff0000, v28
    v_lshlrev_b32 v50, 16, v29
    v_and_b32 v51, 0xffff0000, v29
    v_lshlrev_b32 v52, 16, v28
    v_and_b32 v53, 0xffff0000, v28
    v_lshlrev_b32 v54, 16, v29
    v_and_b32 v55, 0xffff0000, v29
    v_lshlrev_b32 v56, 16, v28
    v_and_b32 v57, 0xffff0000, v28
    v_lshlrev_b32 v58, 16, v29
    v_and_b32 v59, 0xffff0000, v29
    v_lshlrev_b32 v60, 16, v30
    v_and_b32 v61, 0xffff0000, v30
    v_lshlrev_b32 v62, 16, v31
    v_and_b32 v63, 0xffff0000, v31
    v_lshlrev_b32 v64, 16, v30
    v_and_b32 v65, 0xffff0000, v30
    v_lshlrev_b32 v66, 16, v31
    v_and_b32 v67, 0xffff0000, v31
    v_lshlrev_b32 v68, 16, v30
    v_and_b32 v69, 0xffff0000, v30
    v_lshlrev_b32 v70, 16, v31
    v_and_b32 v71, 0xffff0000, v31
    v_lshlrev_b32 v72, 16, v32
    v_and_b32 v73, 0xffff0000, v32
    v_lshlrev_b32 v74, 16, v33
    v_and_b32 v75, 0xffff0000, v33
    v_lshlrev_b32 v76, 16, v32
    v_and_b32 v77, 0xffff0000, v32
    v_lshlrev_b32 v78, 16, v33
    v_and_b32 v79, 0xffff0000, v33
    v_lshlrev_b32 v80, 16, v32
    v_and_b32 v81, 0xffff0000, v32
    v_lshlrev_b32 v82, 16, v33
    v_and_b32 v83, 0xffff0000, v33
    s_barrier
    ds_read_b128 v[116:119], v22 offset:0
    ds_read_b128 v[120:123], v22 offset:1024
    ds_read_b128 v[124:127], v22 offset:2048
    ds_read_b64_tr_b16 v[84:85], v10 offset:0
    ds_read_b64_tr_b16 v[86:87], v10 offset:4096
    ds_read_b64_tr_b16 v[88:89], v11 offset:0
    ds_read_b64_tr_b16 v[90:91], v11 offset:4096
    ds_read_b64_tr_b16 v[92:93], v12 offset:0
    ds_read_b64_tr_b16 v[94:95], v12 offset:4096
    ds_read_b64_tr_b16 v[96:97], v13 offset:0
    ds_read_b64_tr_b16 v[98:99], v13 offset:4096
    s_mov_b32 s36, 6
CL_m_67:
    s_waitcnt lgkmcnt(4)
    v_mfma_f32_16x16x32_bf16 v[36:39], v[84:87], v[116:119], v[36:39]
    ds_read_b128 v[128:131], v22 offset:6144
    ds_read_b128 v[132:135], v22 offset:7168
    v_mfma_f32_16x16x32_bf16 v[40:43], v[84:87], v[120:123], v[40:43]
    ds_read_b128 v[136:139], v22 offset:8192
    v_mfma_f32_16x16x32_bf16 v[44:47], v[84:87], v[124:127], v[44:47]
    ds_read_b64_tr_b16 v[100:101], v10 offset:8192
    v_mfma_f32_16x16x32_bf16 v[48:51], v[88:91], v[116:119], v[48:51]
    ds_read_b64_tr_b16 v[102:103], v10 offset:12288
    v_mfma_f32_16x16x32_bf16 v[52:55], v[88:91], v[120:123], v[52:55]
    ds_read_b64_tr_b16 v[104:105], v11 offset:8192
    v_mfma_f32_16x16x32_bf16 v[56:59], v[88:91], v[124:127], v[56:59]
    s_waitcnt lgkmcnt(6)
    v_mfma_f32_16x16x32_bf16 v[60:63], v[92:95], v[116:119], v[60:63]
    ds_read_b64_tr_b16 v[106:107], v11 offset:12288
    v_mfma_f32_16x16x32_bf16 v[64:67], v[92:95], v[120:123], v[64:67]
    ds_read_b64_tr_b16 v[108:109], v12 offset:8192
    v_mfma_f32_16x16x32_bf16 v[68:71], v[92:95], v[124:127], v[68:71]
    ds_read_b64_tr_b16 v[110:111], v12 offset:12288
    v_mfma_f32_16x16x32_bf16 v[72:75], v[96:99], v[116:119], v[72:75]
    ds_read_b64_tr_b16 v[112:113], v13 offset:8192
    v_mfma_f32_16x16x32_bf16 v[76:79], v[96:99], v[120:123], v[76:79]
    ds_read_b64_tr_b16 v[114:115], v13 offset:12288
    v_mfma_f32_16x16x32_bf16 v[80:83], v[96:99], v[124:127], v[80:83]
    s_barrier
    s_waitcnt lgkmcnt(4)
    v_mfma_f32_16x16x32_bf16 v[36:39], v[100:103], v[128:131], v[36:39]
    ds_read_b128 v[116:119], v22 offset:28672
    ds_read_b128 v[120:123], v22 offset:29696
    v_mfma_f32_16x16x32_bf16 v[40:43], v[100:103], v[132:135], v[40:43]
    ds_read_b128 v[124:127], v22 offset:30720
    v_mfma_f32_16x16x32_bf16 v[44:47], v[100:103], v[136:139], v[44:47]
    ds_read_b64_tr_b16 v[84:85], v10 offset:28672
    v_mfma_f32_16x16x32_bf16 v[48:51], v[104:107], v[128:131], v[48:51]
    ds_read_b64_tr_b16 v[86:87], v10 offset:32768
    v_mfma_f32_16x16x32_bf16 v[52:55], v[104:107], v[132:135], v[52:55]
    ds_read_b64_tr_b16 v[88:89], v11 offset:28672
    v_mfma_f32_16x16x32_bf16 v[56:59], v[104:107], v[136:139], v[56:59]
    s_waitcnt lgkmcnt(6)
    v_mfma_f32_16x16x32_bf16 v[60:63], v[108:111], v[128:131], v[60:63]
    ds_read_b64_tr_b16 v[90:91], v11 offset:32768
    v_mfma_f32_16x16x32_bf16 v[64:67], v[108:111], v[132:135], v[64:67]
    ds_read_b64_tr_b16 v[92:93], v12 offset:28672
    v_mfma_f32_16x16x32_bf16 v[68:71], v[108:111], v[136:139], v[68:71]
    ds_read_b64_tr_b16 v[94:95], v12 offset:32768
    v_mfma_f32_16x16x32_bf16 v[72:75], v[112:115], v[128:131], v[72:75]
    ds_read_b64_tr_b16 v[96:97], v13 offset:28672
    v_mfma_f32_16x16x32_bf16 v[76:79], v[112:115], v[132:135], v[76:79]
    ds_read_b64_tr_b16 v[98:99], v13 offset:32768
    v_mfma_f32_16x16x32_bf16 v[80:83], v[112:115], v[136:139], v[80:83]
    s_waitcnt lgkmcnt(4)
    v_mfma_f32_16x16x32_bf16 v[36:39], v[84:87], v[116:119], v[36:39]
    ds_read_b128 v[128:131], v22 offset:34816
    ds_read_b128 v[132:135], v22 offset:35840
    v_mfma_f32_16x16x32_bf16 v[40:43], v[84:87], v[120:123], v[40:43]
    ds_read_b128 v[136:139], v22 offset:36864
    v_mfma_f32_16x16x32_bf16 v[44:47], v[84:87], v[124:127], v[44:47]
    ds_read_b64_tr_b16 v[100:101], v10 offset:36864
    v_mfma_f32_16x16x32_bf16 v[48:51], v[88:91], v[116:119], v[48:51]
    ds_read_b64_tr_b16 v[102:103], v10 offset:40960
    v_mfma_f32_16x16x32_bf16 v[52:55], v[88:91], v[120:123], v[52:55]
    ds_read_b64_tr_b16 v[104:105], v11 offset:36864
    v_mfma_f32_16x16x32_bf16 v[56:59], v[88:91], v[124:127], v[56:59]
    s_waitcnt lgkmcnt(6)
    v_mfma_f32_16x16x32_bf16 v[60:63], v[92:95], v[116:119], v[60:63]
    ds_read_b64_tr_b16 v[106:107], v11 offset:40960
    v_mfma_f32_16x16x32_bf16 v[64:67], v[92:95], v[120:123], v[64:67]
    ds_read_b64_tr_b16 v[108:109], v12 offset:36864
    v_mfma_f32_16x16x32_bf16 v[68:71], v[92:95], v[124:127], v[68:71]
    ds_read_b64_tr_b16 v[110:111], v12 offset:40960
    v_mfma_f32_16x16x32_bf16 v[72:75], v[96:99], v[116:119], v[72:75]
    ds_read_b64_tr_b16 v[112:113], v13 offset:36864
    v_mfma_f32_16x16x32_bf16 v[76:79], v[96:99], v[120:123], v[76:79]
    ds_read_b64_tr_b16 v[114:115], v13 offset:40960
    v_mfma_f32_16x16x32_bf16 v[80:83], v[96:99], v[124:127], v[80:83]
    s_barrier
    s_waitcnt lgkmcnt(4)
    v_mfma_f32_16x16x32_bf16 v[36:39], v[100:103], v[128:131], v[36:39]
    ds_read_b128 v[116:119], v23 offset:0
    ds_read_b128 v[120:123], v23 offset:1024
    v_mfma_f32_16x16x32_bf16 v[40:43], v[100:103], v[132:135], v[40:43]
    ds_read_b128 v[124:127], v23 offset:2048
    v_mfma_f32_16x16x32_bf16 v[44:47], v[100:103], v[136:139], v[44:47]
    ds_read_b64_tr_b16 v[84:85], v14 offset:0
    v_mfma_f32_16x16x32_bf16 v[48:51], v[104:107], v[128:131], v[48:51]
    ds_read_b64_tr_b16 v[86:87], v14 offset:4096
    v_mfma_f32_16x16x32_bf16 v[52:55], v[104:107], v[132:135], v[52:55]
    ds_read_b64_tr_b16 v[88:89], v15 offset:0
    v_mfma_f32_16x16x32_bf16 v[56:59], v[104:107], v[136:139], v[56:59]
    s_waitcnt lgkmcnt(6)
    v_mfma_f32_16x16x32_bf16 v[60:63], v[108:111], v[128:131], v[60:63]
    ds_read_b64_tr_b16 v[90:91], v15 offset:4096
    v_mfma_f32_16x16x32_bf16 v[64:67], v[108:111], v[132:135], v[64:67]
    ds_read_b64_tr_b16 v[92:93], v16 offset:0
    v_mfma_f32_16x16x32_bf16 v[68:71], v[108:111], v[136:139], v[68:71]
    ds_read_b64_tr_b16 v[94:95], v16 offset:4096
    v_mfma_f32_16x16x32_bf16 v[72:75], v[112:115], v[128:131], v[72:75]
    ds_read_b64_tr_b16 v[96:97], v17 offset:0
    v_mfma_f32_16x16x32_bf16 v[76:79], v[112:115], v[132:135], v[76:79]
    ds_read_b64_tr_b16 v[98:99], v17 offset:4096
    v_mfma_f32_16x16x32_bf16 v[80:83], v[112:115], v[136:139], v[80:83]
    s_waitcnt lgkmcnt(4)
    v_mfma_f32_16x16x32_bf16 v[36:39], v[84:87], v[116:119], v[36:39]
    ds_read_b128 v[128:131], v23 offset:6144
    ds_read_b128 v[132:135], v23 offset:7168
    v_mfma_f32_16x16x32_bf16 v[40:43], v[84:87], v[120:123], v[40:43]
    ds_read_b128 v[136:139], v23 offset:8192
    v_mfma_f32_16x16x32_bf16 v[44:47], v[84:87], v[124:127], v[44:47]
    ds_read_b64_tr_b16 v[100:101], v14 offset:8192
    v_mfma_f32_16x16x32_bf16 v[48:51], v[88:91], v[116:119], v[48:51]
    ds_read_b64_tr_b16 v[102:103], v14 offset:12288
    v_mfma_f32_16x16x32_bf16 v[52:55], v[88:91], v[120:123], v[52:55]
    ds_read_b64_tr_b16 v[104:105], v15 offset:8192
    v_mfma_f32_16x16x32_bf16 v[56:59], v[88:91], v[124:127], v[56:59]
    s_waitcnt lgkmcnt(6)
    v_mfma_f32_16x16x32_bf16 v[60:63], v[92:95], v[116:119], v[60:63]
    ds_read_b64_tr_b16 v[106:107], v15 offset:12288
    v_mfma_f32_16x16x32_bf16 v[64:67], v[92:95], v[120:123], v[64:67]
    ds_read_b64_tr_b16 v[108:109], v16 offset:8192
    v_mfma_f32_16x16x32_bf16 v[68:71], v[92:95], v[124:127], v[68:71]
    ds_read_b64_tr_b16 v[110:111], v16 offset:12288
    v_mfma_f32_16x16x32_bf16 v[72:75], v[96:99], v[116:119], v[72:75]
    ds_read_b64_tr_b16 v[112:113], v17 offset:8192
    v_mfma_f32_16x16x32_bf16 v[76:79], v[96:99], v[120:123], v[76:79]
    ds_read_b64_tr_b16 v[114:115], v17 offset:12288
    v_mfma_f32_16x16x32_bf16 v[80:83], v[96:99], v[124:127], v[80:83]
    s_barrier
    s_waitcnt lgkmcnt(4)
    v_mfma_f32_16x16x32_bf16 v[36:39], v[100:103], v[128:131], v[36:39]
    ds_read_b128 v[116:119], v23 offset:28672
    ds_read_b128 v[120:123], v23 offset:29696
    v_mfma_f32_16x16x32_bf16 v[40:43], v[100:103], v[132:135], v[40:43]
    ds_read_b128 v[124:127], v23 offset:30720
    v_mfma_f32_16x16x32_bf16 v[44:47], v[100:103], v[136:139], v[44:47]
    ds_read_b64_tr_b16 v[84:85], v14 offset:28672
    v_mfma_f32_16x16x32_bf16 v[48:51], v[104:107], v[128:131], v[48:51]
    ds_read_b64_tr_b16 v[86:87], v14 offset:32768
    v_mfma_f32_16x16x32_bf16 v[52:55], v[104:107], v[132:135], v[52:55]
    ds_read_b64_tr_b16 v[88:89], v15 offset:28672
    v_mfma_f32_16x16x32_bf16 v[56:59], v[104:107], v[136:139], v[56:59]
    s_waitcnt lgkmcnt(6)
    v_mfma_f32_16x16x32_bf16 v[60:63], v[108:111], v[128:131], v[60:63]
    ds_read_b64_tr_b16 v[90:91], v15 offset:32768
    v_mfma_f32_16x16x32_bf16 v[64:67], v[108:111], v[132:135], v[64:67]
    ds_read_b64_tr_b16 v[92:93], v16 offset:28672
    v_mfma_f32_16x16x32_bf16 v[68:71], v[108:111], v[136:139], v[68:71]
    ds_read_b64_tr_b16 v[94:95], v16 offset:32768
    v_mfma_f32_16x16x32_bf16 v[72:75], v[112:115], v[128:131], v[72:75]
    ds_read_b64_tr_b16 v[96:97], v17 offset:28672
    v_mfma_f32_16x16x32_bf16 v[76:79], v[112:115], v[132:135], v[76:79]
    ds_read_b64_tr_b16 v[98:99], v17 offset:32768
    v_mfma_f32_16x16x32_bf16 v[80:83], v[112:115], v[136:139], v[80:83]
    s_waitcnt lgkmcnt(4)
    v_mfma_f32_16x16x32_bf16 v[36:39], v[84:87], v[116:119], v[36:39]
    ds_read_b128 v[128:131], v23 offset:34816
    ds_read_b128 v[132:135], v23 offset:35840
    v_mfma_f32_16x16x32_bf16 v[40:43], v[84:87], v[120:123], v[40:43]
    ds_read_b128 v[136:139], v23 offset:36864
    v_mfma_f32_16x16x32_bf16 v[44:47], v[84:87], v[124:127], v[44:47]
    ds_read_b64_tr_b16 v[100:101], v14 offset:36864
    v_mfma_f32_16x16x32_bf16 v[48:51], v[88:91], v[116:119], v[48:51]
    ds_read_b64_tr_b16 v[102:103], v14 offset:40960
    v_mfma_f32_16x16x32_bf16 v[52:55], v[88:91], v[120:123], v[52:55]
    ds_read_b64_tr_b16 v[104:105], v15 offset:36864
    v_mfma_f32_16x16x32_bf16 v[56:59], v[88:91], v[124:127], v[56:59]
    s_waitcnt lgkmcnt(6)
    v_mfma_f32_16x16x32_bf16 v[60:63], v[92:95], v[116:119], v[60:63]
    ds_read_b64_tr_b16 v[106:107], v15 offset:40960
    v_mfma_f32_16x16x32_bf16 v[64:67], v[92:95], v[120:123], v[64:67]
    ds_read_b64_tr_b16 v[108:109], v16 offset:36864
    v_mfma_f32_16x16x32_bf16 v[68:71], v[92:95], v[124:127], v[68:71]
    ds_read_b64_tr_b16 v[110:111], v16 offset:40960
    v_mfma_f32_16x16x32_bf16 v[72:75], v[96:99], v[116:119], v[72:75]
    ds_read_b64_tr_b16 v[112:113], v17 offset:36864
    v_mfma_f32_16x16x32_bf16 v[76:79], v[96:99], v[120:123], v[76:79]
    ds_read_b64_tr_b16 v[114:115], v17 offset:40960
    v_mfma_f32_16x16x32_bf16 v[80:83], v[96:99], v[124:127], v[80:83]
    s_barrier
    s_waitcnt lgkmcnt(4)
    v_mfma_f32_16x16x32_bf16 v[36:39], v[100:103], v[128:131], v[36:39]
    ds_read_b128 v[116:119], v24 offset:0
    ds_read_b128 v[120:123], v24 offset:1024
    v_mfma_f32_16x16x32_bf16 v[40:43], v[100:103], v[132:135], v[40:43]
    ds_read_b128 v[124:127], v24 offset:2048
    v_mfma_f32_16x16x32_bf16 v[44:47], v[100:103], v[136:139], v[44:47]
    ds_read_b64_tr_b16 v[84:85], v18 offset:0
    v_mfma_f32_16x16x32_bf16 v[48:51], v[104:107], v[128:131], v[48:51]
    ds_read_b64_tr_b16 v[86:87], v18 offset:4096
    v_mfma_f32_16x16x32_bf16 v[52:55], v[104:107], v[132:135], v[52:55]
    ds_read_b64_tr_b16 v[88:89], v19 offset:0
    v_mfma_f32_16x16x32_bf16 v[56:59], v[104:107], v[136:139], v[56:59]
    s_waitcnt lgkmcnt(6)
    v_mfma_f32_16x16x32_bf16 v[60:63], v[108:111], v[128:131], v[60:63]
    ds_read_b64_tr_b16 v[90:91], v19 offset:4096
    v_mfma_f32_16x16x32_bf16 v[64:67], v[108:111], v[132:135], v[64:67]
    ds_read_b64_tr_b16 v[92:93], v20 offset:0
    v_mfma_f32_16x16x32_bf16 v[68:71], v[108:111], v[136:139], v[68:71]
    ds_read_b64_tr_b16 v[94:95], v20 offset:4096
    v_mfma_f32_16x16x32_bf16 v[72:75], v[112:115], v[128:131], v[72:75]
    ds_read_b64_tr_b16 v[96:97], v21 offset:0
    v_mfma_f32_16x16x32_bf16 v[76:79], v[112:115], v[132:135], v[76:79]
    ds_read_b64_tr_b16 v[98:99], v21 offset:4096
    v_mfma_f32_16x16x32_bf16 v[80:83], v[112:115], v[136:139], v[80:83]
    s_waitcnt lgkmcnt(4)
    v_mfma_f32_16x16x32_bf16 v[36:39], v[84:87], v[116:119], v[36:39]
    ds_read_b128 v[128:131], v24 offset:6144
    ds_read_b128 v[132:135], v24 offset:7168
    v_mfma_f32_16x16x32_bf16 v[40:43], v[84:87], v[120:123], v[40:43]
    ds_read_b128 v[136:139], v24 offset:8192
    v_mfma_f32_16x16x32_bf16 v[44:47], v[84:87], v[124:127], v[44:47]
    ds_read_b64_tr_b16 v[100:101], v18 offset:8192
    v_mfma_f32_16x16x32_bf16 v[48:51], v[88:91], v[116:119], v[48:51]
    ds_read_b64_tr_b16 v[102:103], v18 offset:12288
    v_mfma_f32_16x16x32_bf16 v[52:55], v[88:91], v[120:123], v[52:55]
    ds_read_b64_tr_b16 v[104:105], v19 offset:8192
    v_mfma_f32_16x16x32_bf16 v[56:59], v[88:91], v[124:127], v[56:59]
    s_waitcnt lgkmcnt(6)
    v_mfma_f32_16x16x32_bf16 v[60:63], v[92:95], v[116:119], v[60:63]
    ds_read_b64_tr_b16 v[106:107], v19 offset:12288
    v_mfma_f32_16x16x32_bf16 v[64:67], v[92:95], v[120:123], v[64:67]
    ds_read_b64_tr_b16 v[108:109], v20 offset:8192
    v_mfma_f32_16x16x32_bf16 v[68:71], v[92:95], v[124:127], v[68:71]
    ds_read_b64_tr_b16 v[110:111], v20 offset:12288
    v_mfma_f32_16x16x32_bf16 v[72:75], v[96:99], v[116:119], v[72:75]
    ds_read_b64_tr_b16 v[112:113], v21 offset:8192
    v_mfma_f32_16x16x32_bf16 v[76:79], v[96:99], v[120:123], v[76:79]
    ds_read_b64_tr_b16 v[114:115], v21 offset:12288
    v_mfma_f32_16x16x32_bf16 v[80:83], v[96:99], v[124:127], v[80:83]
    s_barrier
    s_waitcnt lgkmcnt(4)
    v_mfma_f32_16x16x32_bf16 v[36:39], v[100:103], v[128:131], v[36:39]
    ds_read_b128 v[116:119], v22 offset:0
    ds_read_b128 v[120:123], v22 offset:1024
    v_mfma_f32_16x16x32_bf16 v[40:43], v[100:103], v[132:135], v[40:43]
    ds_read_b128 v[124:127], v22 offset:2048
    v_mfma_f32_16x16x32_bf16 v[44:47], v[100:103], v[136:139], v[44:47]
    ds_read_b64_tr_b16 v[84:85], v10 offset:0
    v_mfma_f32_16x16x32_bf16 v[48:51], v[104:107], v[128:131], v[48:51]
    ds_read_b64_tr_b16 v[86:87], v10 offset:4096
    v_mfma_f32_16x16x32_bf16 v[52:55], v[104:107], v[132:135], v[52:55]
    ds_read_b64_tr_b16 v[88:89], v11 offset:0
    v_mfma_f32_16x16x32_bf16 v[56:59], v[104:107], v[136:139], v[56:59]
    s_waitcnt lgkmcnt(6)
    v_mfma_f32_16x16x32_bf16 v[60:63], v[108:111], v[128:131], v[60:63]
    ds_read_b64_tr_b16 v[90:91], v11 offset:4096
    v_mfma_f32_16x16x32_bf16 v[64:67], v[108:111], v[132:135], v[64:67]
    ds_read_b64_tr_b16 v[92:93], v12 offset:0
    v_mfma_f32_16x16x32_bf16 v[68:71], v[108:111], v[136:139], v[68:71]
    ds_read_b64_tr_b16 v[94:95], v12 offset:4096
    v_mfma_f32_16x16x32_bf16 v[72:75], v[112:115], v[128:131], v[72:75]
    ds_read_b64_tr_b16 v[96:97], v13 offset:0
    v_mfma_f32_16x16x32_bf16 v[76:79], v[112:115], v[132:135], v[76:79]
    ds_read_b64_tr_b16 v[98:99], v13 offset:4096
    v_mfma_f32_16x16x32_bf16 v[80:83], v[112:115], v[136:139], v[80:83]
    s_sub_u32 s36, s36, 1
    s_cmp_lg_u32 s36, 0
    s_cbranch_scc1 CL_m_67
    s_waitcnt lgkmcnt(4)
    v_mfma_f32_16x16x32_bf16 v[36:39], v[84:87], v[116:119], v[36:39]
    ds_read_b128 v[128:131], v22 offset:6144
    ds_read_b128 v[132:135], v22 offset:7168
    v_mfma_f32_16x16x32_bf16 v[40:43], v[84:87], v[120:123], v[40:43]
    ds_read_b128 v[136:139], v22 offset:8192
    v_mfma_f32_16x16x32_bf16 v[44:47], v[84:87], v[124:127], v[44:47]
    ds_read_b64_tr_b16 v[100:101], v10 offset:8192
    v_mfma_f32_16x16x32_bf16 v[48:51], v[88:91], v[116:119], v[48:51]
    ds_read_b64_tr_b16 v[102:103], v10 offset:12288
    v_mfma_f32_16x16x32_bf16 v[52:55], v[88:91], v[120:123], v[52:55]
    ds_read_b64_tr_b16 v[104:105], v11 offset:8192
    v_mfma_f32_16x16x32_bf16 v[56:59], v[88:91], v[124:127], v[56:59]
    s_waitcnt lgkmcnt(6)
    v_mfma_f32_16x16x32_bf16 v[60:63], v[92:95], v[116:119], v[60:63]
    ds_read_b64_tr_b16 v[106:107], v11 offset:12288
    v_mfma_f32_16x16x32_bf16 v[64:67], v[92:95], v[120:123], v[64:67]
    ds_read_b64_tr_b16 v[108:109], v12 offset:8192
    v_mfma_f32_16x16x32_bf16 v[68:71], v[92:95], v[124:127], v[68:71]
    ds_read_b64_tr_b16 v[110:111], v12 offset:12288
    v_mfma_f32_16x16x32_bf16 v[72:75], v[96:99], v[116:119], v[72:75]
    ds_read_b64_tr_b16 v[112:113], v13 offset:8192
    v_mfma_f32_16x16x32_bf16 v[76:79], v[96:99], v[120:123], v[76:79]
    ds_read_b64_tr_b16 v[114:115], v13 offset:12288
    v_mfma_f32_16x16x32_bf16 v[80:83], v[96:99], v[124:127], v[80:83]
    s_barrier
    s_waitcnt lgkmcnt(4)
    v_mfma_f32_16x16x32_bf16 v[36:39], v[100:103], v[128:131], v[36:39]
    ds_read_b128 v[116:119], v22 offset:28672
    ds_read_b128 v[120:123], v22 offset:29696
    v_mfma_f32_16x16x32_bf16 v[40:43], v[100:103], v[132:135], v[40:43]
    ds_read_b128 v[124:127], v22 offset:30720
    v_mfma_f32_16x16x32_bf16 v[44:47], v[100:103], v[136:139], v[44:47]
    ds_read_b64_tr_b16 v[84:85], v10 offset:28672
    v_mfma_f32_16x16x32_bf16 v[48:51], v[104:107], v[128:131], v[48:51]
    ds_read_b64_tr_b16 v[86:87], v10 offset:32768
    v_mfma_f32_16x16x32_bf16 v[52:55], v[104:107], v[132:135], v[52:55]
    ds_read_b64_tr_b16 v[88:89], v11 offset:28672
    v_mfma_f32_16x16x32_bf16 v[56:59], v[104:107], v[136:139], v[56:59]
    s_waitcnt lgkmcnt(6)
    v_mfma_f32_16x16x32_bf16 v[60:63], v[108:111], v[128:131], v[60:63]
    ds_read_b64_tr_b16 v[90:91], v11 offset:32768
    v_mfma_f32_16x16x32_bf16 v[64:67], v[108:111], v[132:135], v[64:67]
    ds_read_b64_tr_b16 v[92:93], v12 offset:28672
    v_mfma_f32_16x16x32_bf16 v[68:71], v[108:111], v[136:139], v[68:71]
    ds_read_b64_tr_b16 v[94:95], v12 offset:32768
    v_mfma_f32_16x16x32_bf16 v[72:75], v[112:115], v[128:131], v[72:75]
    ds_read_b64_tr_b16 v[96:97], v13 offset:28672
    v_mfma_f32_16x16x32_bf16 v[76:79], v[112:115], v[132:135], v[76:79]
    ds_read_b64_tr_b16 v[98:99], v13 offset:32768
    v_mfma_f32_16x16x32_bf16 v[80:83], v[112:115], v[136:139], v[80:83]
    s_waitcnt lgkmcnt(4)
    v_mfma_f32_16x16x32_bf16 v[36:39], v[84:87], v[116:119], v[36:39]
    ds_read_b128 v[128:131], v22 offset:34816
    ds_read_b128 v[132:135], v22 offset:35840
    v_mfma_f32_16x16x32_bf16 v[40:43], v[84:87], v[120:123], v[40:43]
    ds_read_b128 v[136:139], v22 offset:36864
    v_mfma_f32_16x16x32_bf16 v[44:47], v[84:87], v[124:127], v[44:47]
    ds_read_b64_tr_b16 v[100:101], v10 offset:36864
    v_mfma_f32_16x16x32_bf16 v[48:51], v[88:91], v[116:119], v[48:51]
    ds_read_b64_tr_b16 v[102:103], v10 offset:40960
    v_mfma_f32_16x16x32_bf16 v[52:55], v[88:91], v[120:123], v[52:55]
    ds_read_b64_tr_b16 v[104:105], v11 offset:36864
    v_mfma_f32_16x16x32_bf16 v[56:59], v[88:91], v[124:127], v[56:59]
    s_waitcnt lgkmcnt(6)
    v_mfma_f32_16x16x32_bf16 v[60:63], v[92:95], v[116:119], v[60:63]
    ds_read_b64_tr_b16 v[106:107], v11 offset:40960
    v_mfma_f32_16x16x32_bf16 v[64:67], v[92:95], v[120:123], v[64:67]
    ds_read_b64_tr_b16 v[108:109], v12 offset:36864
    v_mfma_f32_16x16x32_bf16 v[68:71], v[92:95], v[124:127], v[68:71]
    ds_read_b64_tr_b16 v[110:111], v12 offset:40960
    v_mfma_f32_16x16x32_bf16 v[72:75], v[96:99], v[116:119], v[72:75]
    ds_read_b64_tr_b16 v[112:113], v13 offset:36864
    v_mfma_f32_16x16x32_bf16 v[76:79], v[96:99], v[120:123], v[76:79]
    ds_read_b64_tr_b16 v[114:115], v13 offset:40960
    v_mfma_f32_16x16x32_bf16 v[80:83], v[96:99], v[124:127], v[80:83]
    s_waitcnt lgkmcnt(0)
    s_barrier
    v_mfma_f32_16x16x32_bf16 v[36:39], v[100:103], v[128:131], v[36:39]
    v_mfma_f32_16x16x32_bf16 v[40:43], v[100:103], v[132:135], v[40:43]
    v_mfma_f32_16x16x32_bf16 v[44:47], v[100:103], v[136:139], v[44:47]
    v_mfma_f32_16x16x32_bf16 v[48:51], v[104:107], v[128:131], v[48:51]
    v_mfma_f32_16x16x32_bf16 v[52:55], v[104:107], v[132:135], v[52:55]
    v_mfma_f32_16x16x32_bf16 v[56:59], v[104:107], v[136:139], v[56:59]
    v_mfma_f32_16x16x32_bf16 v[60:63], v[108:111], v[128:131], v[60:63]
    v_mfma_f32_16x16x32_bf16 v[64:67], v[108:111], v[132:135], v[64:67]
    v_mfma_f32_16x16x32_bf16 v[68:71], v[108:111], v[136:139], v[68:71]
    v_mfma_f32_16x16x32_bf16 v[72:75], v[112:115], v[128:131], v[72:75]
    v_mfma_f32_16x16x32_bf16 v[76:79], v[112:115], v[132:135], v[76:79]
    v_mfma_f32_16x16x32_bf16 v[80:83], v[112:115], v[136:139], v[80:83]
    v_mov_b32 v10, 0xbdd2d3e8
    v_mov_b32 v11, 0xc0135761
    v_lshlrev_b32 v5, 4, v1
    v_pk_mul_f32 v[100:101], v[36:37], v[36:37]
    v_pk_mul_f32 v[102:103], v[38:39], v[38:39]
    v_pk_mul_f32 v[104:105], v[48:49], v[48:49]
    v_pk_mul_f32 v[106:107], v[50:51], v[50:51]
    v_pk_fma_f32 v[100:101], v[100:101], v[10:11], v[10:11] op_sel:[0,0,1] op_sel_hi:[1,0,1]
    v_pk_fma_f32 v[102:103], v[102:103], v[10:11], v[10:11] op_sel:[0,0,1] op_sel_hi:[1,0,1]
    v_pk_fma_f32 v[104:105], v[104:105], v[10:11], v[10:11] op_sel:[0,0,1] op_sel_hi:[1,0,1]
    v_pk_fma_f32 v[106:107], v[106:107], v[10:11], v[10:11] op_sel:[0,0,1] op_sel_hi:[1,0,1]
    v_pk_mul_f32 v[100:101], v[100:101], v[36:37]
    v_pk_mul_f32 v[102:103], v[102:103], v[38:39]
    v_pk_mul_f32 v[104:105], v[104:105], v[48:49]
    v_pk_mul_f32 v[106:107], v[106:107], v[50:51]
    v_exp_f32 v100, v100
    v_exp_f32 v101, v101
    v_exp_f32 v102, v102
    v_exp_f32 v103, v103
    v_exp_f32 v104, v104
    v_exp_f32 v105, v105
    v_exp_f32 v106, v106
    v_exp_f32 v107, v107
    v_pk_add_f32 v[100:101], v[100:101], 1.0 op_sel_hi:[1,0]
    v_pk_add_f32 v[102:103], v[102:103], 1.0 op_sel_hi:[1,0]
    v_pk_add_f32 v[104:105], v[104:105], 1.0 op_sel_hi:[1,0]
    v_pk_add_f32 v[106:107], v[106:107], 1.0 op_sel_hi:[1,0]
    v_rcp_f32 v100, v100
    v_rcp_f32 v101, v101
    v_rcp_f32 v102, v102
    v_rcp_f32 v103, v103
    v_rcp_f32 v104, v104
    v_rcp_f32 v105, v105
    v_rcp_f32 v106, v106
    v_rcp_f32 v107, v107
    v_pk_mul_f32 v[36:37], v[36:37], v[100:101]
    v_pk_mul_f32 v[38:39], v[38:39], v[102:103]
    v_pk_mul_f32 v[48:49], v[48:49], v[104:105]
    v_pk_mul_f32 v[50:51], v[50:51], v[106:107]
    v_cvt_pk_bf16_f32 v116, v36, v37
    v_cvt_pk_bf16_f32 v117, v38, v39
    v_cvt_pk_bf16_f32 v118, v48, v49
    v_cvt_pk_bf16_f32 v119, v50, v51
    buffer_store_dwordx4 v[116:119], v5, s[20:23], s40 offen offset:0 sc0 sc1
    v_pk_mul_f32 v[100:101], v[60:61], v[60:61]
    v_pk_mul_f32 v[102:103], v[62:63], v[62:63]
    v_pk_mul_f32 v[104:105], v[72:73], v[72:73]
    v_pk_mul_f32 v[106:107], v[74:75], v[74:75]
    v_pk_fma_f32 v[100:101], v[100:101], v[10:11], v[10:11] op_sel:[0,0,1] op_sel_hi:[1,0,1]
    v_pk_fma_f32 v[102:103], v[102:103], v[10:11], v[10:11] op_sel:[0,0,1] op_sel_hi:[1,0,1]
    v_pk_fma_f32 v[104:105], v[104:105], v[10:11], v[10:11] op_sel:[0,0,1] op_sel_hi:[1,0,1]
    v_pk_fma_f32 v[106:107], v[106:107], v[10:11], v[10:11] op_sel:[0,0,1] op_sel_hi:[1,0,1]
    v_pk_mul_f32 v[100:101], v[100:101], v[60:61]
    v_pk_mul_f32 v[102:103], v[102:103], v[62:63]
    v_pk_mul_f32 v[104:105], v[104:105], v[72:73]
    v_pk_mul_f32 v[106:107], v[106:107], v[74:75]
    v_exp_f32 v100, v100
    v_exp_f32 v101, v101
    v_exp_f32 v102, v102
    v_exp_f32 v103, v103
    v_exp_f32 v104, v104
    v_exp_f32 v105, v105
    v_exp_f32 v106, v106
    v_exp_f32 v107, v107
    v_pk_add_f32 v[100:101], v[100:101], 1.0 op_sel_hi:[1,0]
    v_pk_add_f32 v[102:103], v[102:103], 1.0 op_sel_hi:[1,0]
    v_pk_add_f32 v[104:105], v[104:105], 1.0 op_sel_hi:[1,0]
    v_pk_add_f32 v[106:107], v[106:107], 1.0 op_sel_hi:[1,0]
    v_rcp_f32 v100, v100
    v_rcp_f32 v101, v101
    v_rcp_f32 v102, v102
    v_rcp_f32 v103, v103
    v_rcp_f32 v104, v104
    v_rcp_f32 v105, v105
    v_rcp_f32 v106, v106
    v_rcp_f32 v107, v107
    v_pk_mul_f32 v[60:61], v[60:61], v[100:101]
    v_pk_mul_f32 v[62:63], v[62:63], v[102:103]
    v_pk_mul_f32 v[72:73], v[72:73], v[104:105]
    v_pk_mul_f32 v[74:75], v[74:75], v[106:107]
    v_cvt_pk_bf16_f32 v120, v60, v61
    v_cvt_pk_bf16_f32 v121, v62, v63
    v_cvt_pk_bf16_f32 v122, v72, v73
    v_cvt_pk_bf16_f32 v123, v74, v75
    buffer_store_dwordx4 v[120:123], v5, s[20:23], s40 offen offset:1024 sc0 sc1
    s_add_u32 s40, s40, 147456
    v_pk_mul_f32 v[100:101], v[40:41], v[40:41]
    v_pk_mul_f32 v[102:103], v[42:43], v[42:43]
    v_pk_mul_f32 v[104:105], v[52:53], v[52:53]
    v_pk_mul_f32 v[106:107], v[54:55], v[54:55]
    v_pk_fma_f32 v[100:101], v[100:101], v[10:11], v[10:11] op_sel:[0,0,1] op_sel_hi:[1,0,1]
    v_pk_fma_f32 v[102:103], v[102:103], v[10:11], v[10:11] op_sel:[0,0,1] op_sel_hi:[1,0,1]
    v_pk_fma_f32 v[104:105], v[104:105], v[10:11], v[10:11] op_sel:[0,0,1] op_sel_hi:[1,0,1]
    v_pk_fma_f32 v[106:107], v[106:107], v[10:11], v[10:11] op_sel:[0,0,1] op_sel_hi:[1,0,1]
    v_pk_mul_f32 v[100:101], v[100:101], v[40:41]
    v_pk_mul_f32 v[102:103], v[102:103], v[42:43]
    v_pk_mul_f32 v[104:105], v[104:105], v[52:53]
    v_pk_mul_f32 v[106:107], v[106:107], v[54:55]
    v_exp_f32 v100, v100
    v_exp_f32 v101, v101
    v_exp_f32 v102, v102
    v_exp_f32 v103, v103
    v_exp_f32 v104, v104
    v_exp_f32 v105, v105
    v_exp_f32 v106, v106
    v_exp_f32 v107, v107
    v_pk_add_f32 v[100:101], v[100:101], 1.0 op_sel_hi:[1,0]
    v_pk_add_f32 v[102:103], v[102:103], 1.0 op_sel_hi:[1,0]
    v_pk_add_f32 v[104:105], v[104:105], 1.0 op_sel_hi:[1,0]
    v_pk_add_f32 v[106:107], v[106:107], 1.0 op_sel_hi:[1,0]
    v_rcp_f32 v100, v100
    v_rcp_f32 v101, v101
    v_rcp_f32 v102, v102
    v_rcp_f32 v103, v103
    v_rcp_f32 v104, v104
    v_rcp_f32 v105, v105
    v_rcp_f32 v106, v106
    v_rcp_f32 v107, v107
    v_pk_mul_f32 v[40:41], v[40:41], v[100:101]
    v_pk_mul_f32 v[42:43], v[42:43], v[102:103]
    v_pk_mul_f32 v[52:53], v[52:53], v[104:105]
    v_pk_mul_f32 v[54:55], v[54:55], v[106:107]
    v_cvt_pk_bf16_f32 v124, v40, v41
    v_cvt_pk_bf16_f32 v125, v42, v43
    v_cvt_pk_bf16_f32 v126, v52, v53
    v_cvt_pk_bf16_f32 v127, v54, v55
    buffer_store_dwordx4 v[124:127], v5, s[20:23], s40 offen offset:0 sc0 sc1
    v_pk_mul_f32 v[100:101], v[64:65], v[64:65]
    v_pk_mul_f32 v[102:103], v[66:67], v[66:67]
    v_pk_mul_f32 v[104:105], v[76:77], v[76:77]
    v_pk_mul_f32 v[106:107], v[78:79], v[78:79]
    v_pk_fma_f32 v[100:101], v[100:101], v[10:11], v[10:11] op_sel:[0,0,1] op_sel_hi:[1,0,1]
    v_pk_fma_f32 v[102:103], v[102:103], v[10:11], v[10:11] op_sel:[0,0,1] op_sel_hi:[1,0,1]
    v_pk_fma_f32 v[104:105], v[104:105], v[10:11], v[10:11] op_sel:[0,0,1] op_sel_hi:[1,0,1]
    v_pk_fma_f32 v[106:107], v[106:107], v[10:11], v[10:11] op_sel:[0,0,1] op_sel_hi:[1,0,1]
    v_pk_mul_f32 v[100:101], v[100:101], v[64:65]
    v_pk_mul_f32 v[102:103], v[102:103], v[66:67]
    v_pk_mul_f32 v[104:105], v[104:105], v[76:77]
    v_pk_mul_f32 v[106:107], v[106:107], v[78:79]
    v_exp_f32 v100, v100
    v_exp_f32 v101, v101
    v_exp_f32 v102, v102
    v_exp_f32 v103, v103
    v_exp_f32 v104, v104
    v_exp_f32 v105, v105
    v_exp_f32 v106, v106
    v_exp_f32 v107, v107
    v_pk_add_f32 v[100:101], v[100:101], 1.0 op_sel_hi:[1,0]
    v_pk_add_f32 v[102:103], v[102:103], 1.0 op_sel_hi:[1,0]
    v_pk_add_f32 v[104:105], v[104:105], 1.0 op_sel_hi:[1,0]
    v_pk_add_f32 v[106:107], v[106:107], 1.0 op_sel_hi:[1,0]
    v_rcp_f32 v100, v100
    v_rcp_f32 v101, v101
    v_rcp_f32 v102, v102
    v_rcp_f32 v103, v103
    v_rcp_f32 v104, v104
    v_rcp_f32 v105, v105
    v_rcp_f32 v106, v106
    v_rcp_f32 v107, v107
    v_pk_mul_f32 v[64:65], v[64:65], v[100:101]
    v_pk_mul_f32 v[66:67], v[66:67], v[102:103]
    v_pk_mul_f32 v[76:77], v[76:77], v[104:105]
    v_pk_mul_f32 v[78:79], v[78:79], v[106:107]
    v_cvt_pk_bf16_f32 v128, v64, v65
    v_cvt_pk_bf16_f32 v129, v66, v67
    v_cvt_pk_bf16_f32 v130, v76, v77
    v_cvt_pk_bf16_f32 v131, v78, v79
    buffer_store_dwordx4 v[128:131], v5, s[20:23], s40 offen offset:1024 sc0 sc1
    s_add_u32 s40, s40, 147456
    v_pk_mul_f32 v[100:101], v[44:45], v[44:45]
    v_pk_mul_f32 v[102:103], v[46:47], v[46:47]
    v_pk_mul_f32 v[104:105], v[56:57], v[56:57]
    v_pk_mul_f32 v[106:107], v[58:59], v[58:59]
    v_pk_fma_f32 v[100:101], v[100:101], v[10:11], v[10:11] op_sel:[0,0,1] op_sel_hi:[1,0,1]
    v_pk_fma_f32 v[102:103], v[102:103], v[10:11], v[10:11] op_sel:[0,0,1] op_sel_hi:[1,0,1]
    v_pk_fma_f32 v[104:105], v[104:105], v[10:11], v[10:11] op_sel:[0,0,1] op_sel_hi:[1,0,1]
    v_pk_fma_f32 v[106:107], v[106:107], v[10:11], v[10:11] op_sel:[0,0,1] op_sel_hi:[1,0,1]
    v_pk_mul_f32 v[100:101], v[100:101], v[44:45]
    v_pk_mul_f32 v[102:103], v[102:103], v[46:47]
    v_pk_mul_f32 v[104:105], v[104:105], v[56:57]
    v_pk_mul_f32 v[106:107], v[106:107], v[58:59]
    v_exp_f32 v100, v100
    v_exp_f32 v101, v101
    v_exp_f32 v102, v102
    v_exp_f32 v103, v103
    v_exp_f32 v104, v104
    v_exp_f32 v105, v105
    v_exp_f32 v106, v106
    v_exp_f32 v107, v107
    v_pk_add_f32 v[100:101], v[100:101], 1.0 op_sel_hi:[1,0]
    v_pk_add_f32 v[102:103], v[102:103], 1.0 op_sel_hi:[1,0]
    v_pk_add_f32 v[104:105], v[104:105], 1.0 op_sel_hi:[1,0]
    v_pk_add_f32 v[106:107], v[106:107], 1.0 op_sel_hi:[1,0]
    v_rcp_f32 v100, v100
    v_rcp_f32 v101, v101
    v_rcp_f32 v102, v102
    v_rcp_f32 v103, v103
    v_rcp_f32 v104, v104
    v_rcp_f32 v105, v105
    v_rcp_f32 v106, v106
    v_rcp_f32 v107, v107
    v_pk_mul_f32 v[44:45], v[44:45], v[100:101]
    v_pk_mul_f32 v[46:47], v[46:47], v[102:103]
    v_pk_mul_f32 v[56:57], v[56:57], v[104:105]
    v_pk_mul_f32 v[58:59], v[58:59], v[106:107]
    v_cvt_pk_bf16_f32 v132, v44, v45
    v_cvt_pk_bf16_f32 v133, v46, v47
    v_cvt_pk_bf16_f32 v134, v56, v57
    v_cvt_pk_bf16_f32 v135, v58, v59
    buffer_store_dwordx4 v[132:135], v5, s[20:23], s40 offen offset:0 sc0 sc1
    v_pk_mul_f32 v[100:101], v[68:69], v[68:69]
    v_pk_mul_f32 v[102:103], v[70:71], v[70:71]
    v_pk_mul_f32 v[104:105], v[80:81], v[80:81]
    v_pk_mul_f32 v[106:107], v[82:83], v[82:83]
    v_pk_fma_f32 v[100:101], v[100:101], v[10:11], v[10:11] op_sel:[0,0,1] op_sel_hi:[1,0,1]
    v_pk_fma_f32 v[102:103], v[102:103], v[10:11], v[10:11] op_sel:[0,0,1] op_sel_hi:[1,0,1]
    v_pk_fma_f32 v[104:105], v[104:105], v[10:11], v[10:11] op_sel:[0,0,1] op_sel_hi:[1,0,1]
    v_pk_fma_f32 v[106:107], v[106:107], v[10:11], v[10:11] op_sel:[0,0,1] op_sel_hi:[1,0,1]
    v_pk_mul_f32 v[100:101], v[100:101], v[68:69]
    v_pk_mul_f32 v[102:103], v[102:103], v[70:71]
    v_pk_mul_f32 v[104:105], v[104:105], v[80:81]
    v_pk_mul_f32 v[106:107], v[106:107], v[82:83]
    v_exp_f32 v100, v100
    v_exp_f32 v101, v101
    v_exp_f32 v102, v102
    v_exp_f32 v103, v103
    v_exp_f32 v104, v104
    v_exp_f32 v105, v105
    v_exp_f32 v106, v106
    v_exp_f32 v107, v107
    v_pk_add_f32 v[100:101], v[100:101], 1.0 op_sel_hi:[1,0]
    v_pk_add_f32 v[102:103], v[102:103], 1.0 op_sel_hi:[1,0]
    v_pk_add_f32 v[104:105], v[104:105], 1.0 op_sel_hi:[1,0]
    v_pk_add_f32 v[106:107], v[106:107], 1.0 op_sel_hi:[1,0]
    v_rcp_f32 v100, v100
    v_rcp_f32 v101, v101
    v_rcp_f32 v102, v102
    v_rcp_f32 v103, v103
    v_rcp_f32 v104, v104
    v_rcp_f32 v105, v105
    v_rcp_f32 v106, v106
    v_rcp_f32 v107, v107
    v_pk_mul_f32 v[68:69], v[68:69], v[100:101]
    v_pk_mul_f32 v[70:71], v[70:71], v[102:103]
    v_pk_mul_f32 v[80:81], v[80:81], v[104:105]
    v_pk_mul_f32 v[82:83], v[82:83], v[106:107]
    v_cvt_pk_bf16_f32 v136, v68, v69
    v_cvt_pk_bf16_f32 v137, v70, v71
    v_cvt_pk_bf16_f32 v138, v80, v81
    v_cvt_pk_bf16_f32 v139, v82, v83
    buffer_store_dwordx4 v[136:139], v5, s[20:23], s40 offen offset:1024 sc0 sc1
    s_add_u32 s40, s40, 147456
    v_mov_b32 v6, 0
    v_mov_b32 v7, 1
    s_waitcnt vmcnt(0)
    v_mov_b32 v8, 160776
    s_mov_b64 exec, 1
    ds_add_rtn_u32 v8, v8, v7
    s_waitcnt lgkmcnt(0)
    v_readfirstlane_b32 s31, v8
    s_nop 0
    s_cmp_lg_u32 s31, 3
    s_cbranch_scc1 NL_m_68
    buffer_store_dword v7, v6, s[20:23], s41 offen sc0 sc1
    v_mov_b32 v8, 160776
    s_waitcnt vmcnt(0)
    ds_add_u32 v8, v7
NL_m_68:
    s_mov_b64 exec, -1
    s_branch P5_m_8
P4PROD_m_64:
    s_and_b32 s26, s28, 1
    s_cmp_ge_u32 s28, 6
    s_cbranch_scc1 P4PA_m_66
    v_add_u32 v5, 0, v3
    v_lshlrev_b32 v6, 1, v5
    v_xor_b32 v6, v6, v4
    v_lshlrev_b32 v6, 4, v6
    v_mul_u32_u24 v5, 9216, v5
    v_add_u32 v10, v5, v6
    v_add_u32 v5, 4, v3
    v_lshlrev_b32 v6, 1, v5
    v_xor_b32 v6, v6, v4
    v_lshlrev_b32 v6, 4, v6
    v_mul_u32_u24 v5, 9216, v5
    v_add_u32 v11, v5, v6
    v_add_u32 v12, 73728, v10
    v_add_u32 v13, 73728, v11
    v_add_u32 v14, 73728, v12
    v_add_u32 v15, 73728, v13
    v_add_u32 v16, 73728, v14
    v_add_u32 v17, 73728, v15
    s_lshl_b32 s32, s24, 8
    s_mul_i32 s30, s26, 294912
    s_add_u32 s32, s32, s30
    s_lshl_b32 s34, s26, 13
    s_mov_b32 s12, s72
    s_and_b32 s13, s73, 0xffff
    s_mov_b32 s14, 18874368
    s_mov_b32 s15, 0x20000
    s_add_u32 m0, s34, 0
    s_nop 0
    buffer_load_dwordx4 v10, s[12:15], s32 offen lds
    s_add_u32 m0, s34, 1024
    s_nop 0
    buffer_load_dwordx4 v11, s[12:15], s32 offen lds
    s_add_u32 m0, s34, 2048
    s_nop 0
    buffer_load_dwordx4 v12, s[12:15], s32 offen lds
    s_add_u32 m0, s34, 3072
    s_nop 0
    buffer_load_dwordx4 v13, s[12:15], s32 offen lds
    s_add_u32 m0, s34, 4096
    s_nop 0
    buffer_load_dwordx4 v14, s[12:15], s32 offen lds
    s_add_u32 m0, s34, 5120
    s_nop 0
    buffer_load_dwordx4 v15, s[12:15], s32 offen lds
    s_add_u32 m0, s34, 6144
    s_nop 0
    buffer_load_dwordx4 v16, s[12:15], s32 offen lds
    s_add_u32 m0, s34, 7168
    s_nop 0
    buffer_load_dwordx4 v17, s[12:15], s32 offen lds
    s_add_u32 s32, s32, 589824
    s_add_u32 m0, s34, 28672
    s_nop 0
    buffer_load_dwordx4 v10, s[12:15], s32 offen lds
    s_add_u32 m0, s34, 29696
    s_nop 0
    buffer_load_dwordx4 v11, s[12:15], s32 offen lds
    s_add_u32 m0, s34, 30720
    s_nop 0
    buffer_load_dwordx4 v12, s[12:15], s32 offen lds
    s_add_u32 m0, s34, 31744
    s_nop 0
    buffer_load_dwordx4 v13, s[12:15], s32 offen lds
    s_add_u32 m0, s34, 32768
    s_nop 0
    buffer_load_dwordx4 v14, s[12:15], s32 offen lds
    s_add_u32 m0, s34, 33792
    s_nop 0
    buffer_load_dwordx4 v15, s[12:15], s32 offen lds
    s_add_u32 m0, s34, 34816
    s_nop 0
    buffer_load_dwordx4 v16, s[12:15], s32 offen lds
    s_add_u32 m0, s34, 35840
    s_nop 0
    buffer_load_dwordx4 v17, s[12:15], s32 offen lds
    s_add_u32 s32, s32, 589824
    s_waitcnt vmcnt(8)
    s_barrier
    s_add_u32 m0, s34, 57344
    s_nop 0
    buffer_load_dwordx4 v10, s[12:15], s32 offen lds
    s_add_u32 m0, s34, 58368
    s_nop 0
    buffer_load_dwordx4 v11, s[12:15], s32 offen lds
    s_add_u32 m0, s34, 59392
    s_nop 0
    buffer_load_dwordx4 v12, s[12:15], s32 offen lds
    s_add_u32 m0, s34, 60416
    s_nop 0
    buffer_load_dwordx4 v13, s[12:15], s32 offen lds
    s_add_u32 m0, s34, 61440
    s_nop 0
    buffer_load_dwordx4 v14, s[12:15], s32 offen lds
    s_add_u32 m0, s34, 62464
    s_nop 0
    buffer_load_dwordx4 v15, s[12:15], s32 offen lds
    s_add_u32 m0, s34, 63488
    s_nop 0
    buffer_load_dwordx4 v16, s[12:15], s32 offen lds
    s_add_u32 m0, s34, 64512
    s_nop 0
    buffer_load_dwordx4 v17, s[12:15], s32 offen lds
    s_add_u32 s32, s32, 589824
    s_add_u32 m0, s34, 86016
    s_nop 0
    buffer_load_dwordx4 v10, s[12:15], s32 offen lds
    s_add_u32 m0, s34, 87040
    s_nop 0
    buffer_load_dwordx4 v11, s[12:15], s32 offen lds
    s_add_u32 m0, s34, 88064
    s_nop 0
    buffer_load_dwordx4 v12, s[12:15], s32 offen lds
    s_add_u32 m0, s34, 89088
    s_nop 0
    buffer_load_dwordx4 v13, s[12:15], s32 offen lds
    s_add_u32 m0, s34, 90112
    s_nop 0
    buffer_load_dwordx4 v14, s[12:15], s32 offen lds
    s_add_u32 m0, s34, 91136
    s_nop 0
    buffer_load_dwordx4 v15, s[12:15], s32 offen lds
    s_add_u32 m0, s34, 92160
    s_nop 0
    buffer_load_dwordx4 v16, s[12:15], s32 offen lds
    s_add_u32 m0, s34, 93184
    s_nop 0
    buffer_load_dwordx4 v17, s[12:15], s32 offen lds
    s_add_u32 s32, s32, 589824
    s_add_u32 m0, s34, 114688
    s_nop 0
    buffer_load_dwordx4 v10, s[12:15], s32 offen lds
    s_add_u32 m0, s34, 115712
    s_nop 0
    buffer_load_dwordx4 v11, s[12:15], s32 offen lds
    s_add_u32 m0, s34, 116736
    s_nop 0
    buffer_load_dwordx4 v12, s[12:15], s32 offen lds
    s_add_u32 m0, s34, 117760
    s_nop 0
    buffer_load_dwordx4 v13, s[12:15], s32 offen lds
    s_add_u32 m0, s34, 118784
    s_nop 0
    buffer_load_dwordx4 v14, s[12:15], s32 offen lds
    s_add_u32 m0, s34, 119808
    s_nop 0
    buffer_load_dwordx4 v15, s[12:15], s32 offen lds
    s_add_u32 m0, s34, 120832
    s_nop 0
    buffer_load_dwordx4 v16, s[12:15], s32 offen lds
    s_add_u32 m0, s34, 121856
    s_nop 0
    buffer_load_dwordx4 v17, s[12:15], s32 offen lds
    s_add_u32 s32, s32, 589824
    s_waitcnt vmcnt(24)
    s_barrier
    s_waitcnt vmcnt(16)
    s_barrier
    s_mov_b32 s36, 5
PL_m_69:
    s_add_u32 m0, s34, 0
    s_nop 0
    buffer_load_dwordx4 v10, s[12:15], s32 offen lds
    s_add_u32 m0, s34, 1024
    s_nop 0
    buffer_load_dwordx4 v11, s[12:15], s32 offen lds
    s_add_u32 m0, s34, 2048
    s_nop 0
    buffer_load_dwordx4 v12, s[12:15], s32 offen lds
    s_add_u32 m0, s34, 3072
    s_nop 0
    buffer_load_dwordx4 v13, s[12:15], s32 offen lds
    s_add_u32 m0, s34, 4096
    s_nop 0
    buffer_load_dwordx4 v14, s[12:15], s32 offen lds
    s_add_u32 m0, s34, 5120
    s_nop 0
    buffer_load_dwordx4 v15, s[12:15], s32 offen lds
    s_add_u32 m0, s34, 6144
    s_nop 0
    buffer_load_dwordx4 v16, s[12:15], s32 offen lds
    s_add_u32 m0, s34, 7168
    s_nop 0
    buffer_load_dwordx4 v17, s[12:15], s32 offen lds
    s_add_u32 s32, s32, 589824
    s_waitcnt vmcnt(16)
    s_barrier
    s_add_u32 m0, s34, 28672
    s_nop 0
    buffer_load_dwordx4 v10, s[12:15], s32 offen lds
    s_add_u32 m0, s34, 29696
    s_nop 0
    buffer_load_dwordx4 v11, s[12:15], s32 offen lds
    s_add_u32 m0, s34, 30720
    s_nop 0
    buffer_load_dwordx4 v12, s[12:15], s32 offen lds
    s_add_u32 m0, s34, 31744
    s_nop 0
    buffer_load_dwordx4 v13, s[12:15], s32 offen lds
    s_add_u32 m0, s34, 32768
    s_nop 0
    buffer_load_dwordx4 v14, s[12:15], s32 offen lds
    s_add_u32 m0, s34, 33792
    s_nop 0
    buffer_load_dwordx4 v15, s[12:15], s32 offen lds
    s_add_u32 m0, s34, 34816
    s_nop 0
    buffer_load_dwordx4 v16, s[12:15], s32 offen lds
    s_add_u32 m0, s34, 35840
    s_nop 0
    buffer_load_dwordx4 v17, s[12:15], s32 offen lds
    s_add_u32 s32, s32, 589824
    s_waitcnt vmcnt(16)
    s_barrier
    s_add_u32 m0, s34, 57344
    s_nop 0
    buffer_load_dwordx4 v10, s[12:15], s32 offen lds
    s_add_u32 m0, s34, 58368
    s_nop 0
    buffer_load_dwordx4 v11, s[12:15], s32 offen lds
    s_add_u32 m0, s34, 59392
    s_nop 0
    buffer_load_dwordx4 v12, s[12:15], s32 offen lds
    s_add_u32 m0, s34, 60416
    s_nop 0
    buffer_load_dwordx4 v13, s[12:15], s32 offen lds
    s_add_u32 m0, s34, 61440
    s_nop 0
    buffer_load_dwordx4 v14, s[12:15], s32 offen lds
    s_add_u32 m0, s34, 62464
    s_nop 0
    buffer_load_dwordx4 v15, s[12:15], s32 offen lds
    s_add_u32 m0, s34, 63488
    s_nop 0
    buffer_load_dwordx4 v16, s[12:15], s32 offen lds
    s_add_u32 m0, s34, 64512
    s_nop 0
    buffer_load_dwordx4 v17, s[12:15], s32 offen lds
    s_add_u32 s32, s32, 589824
    s_waitcnt vmcnt(16)
    s_barrier
    s_add_u32 m0, s34, 86016
    s_nop 0
    buffer_load_dwordx4 v10, s[12:15], s32 offen lds
    s_add_u32 m0, s34, 87040
    s_nop 0
    buffer_load_dwordx4 v11, s[12:15], s32 offen lds
    s_add_u32 m0, s34, 88064
    s_nop 0
    buffer_load_dwordx4 v12, s[12:15], s32 offen lds
    s_add_u32 m0, s34, 89088
    s_nop 0
    buffer_load_dwordx4 v13, s[12:15], s32 offen lds
    s_add_u32 m0, s34, 90112
    s_nop 0
    buffer_load_dwordx4 v14, s[12:15], s32 offen lds
    s_add_u32 m0, s34, 91136
    s_nop 0
    buffer_load_dwordx4 v15, s[12:15], s32 offen lds
    s_add_u32 m0, s34, 92160
    s_nop 0
    buffer_load_dwordx4 v16, s[12:15], s32 offen lds
    s_add_u32 m0, s34, 93184
    s_nop 0
    buffer_load_dwordx4 v17, s[12:15], s32 offen lds
    s_add_u32 s32, s32, 589824
    s_waitcnt vmcnt(16)
    s_barrier
    s_add_u32 m0, s34, 114688
    s_nop 0
    buffer_load_dwordx4 v10, s[12:15], s32 offen lds
    s_add_u32 m0, s34, 115712
    s_nop 0
    buffer_load_dwordx4 v11, s[12:15], s32 offen lds
    s_add_u32 m0, s34, 116736
    s_nop 0
    buffer_load_dwordx4 v12, s[12:15], s32 offen lds
    s_add_u32 m0, s34, 117760
    s_nop 0
    buffer_load_dwordx4 v13, s[12:15], s32 offen lds
    s_add_u32 m0, s34, 118784
    s_nop 0
    buffer_load_dwordx4 v14, s[12:15], s32 offen lds
    s_add_u32 m0, s34, 119808
    s_nop 0
    buffer_load_dwordx4 v15, s[12:15], s32 offen lds
    s_add_u32 m0, s34, 120832
    s_nop 0
    buffer_load_dwordx4 v16, s[12:15], s32 offen lds
    s_add_u32 m0, s34, 121856
    s_nop 0
    buffer_load_dwordx4 v17, s[12:15], s32 offen lds
    s_add_u32 s32, s32, 589824
    s_waitcnt vmcnt(16)
    s_barrier
    s_sub_u32 s36, s36, 1
    s_cmp_lg_u32 s36, 0
    s_cbranch_scc1 PL_m_69
    s_add_u32 m0, s34, 0
    s_nop 0
    buffer_load_dwordx4 v10, s[12:15], s32 offen lds
    s_add_u32 m0, s34, 1024
    s_nop 0
    buffer_load_dwordx4 v11, s[12:15], s32 offen lds
    s_add_u32 m0, s34, 2048
    s_nop 0
    buffer_load_dwordx4 v12, s[12:15], s32 offen lds
    s_add_u32 m0, s34, 3072
    s_nop 0
    buffer_load_dwordx4 v13, s[12:15], s32 offen lds
    s_add_u32 m0, s34, 4096
    s_nop 0
    buffer_load_dwordx4 v14, s[12:15], s32 offen lds
    s_add_u32 m0, s34, 5120
    s_nop 0
    buffer_load_dwordx4 v15, s[12:15], s32 offen lds
    s_add_u32 m0, s34, 6144
    s_nop 0
    buffer_load_dwordx4 v16, s[12:15], s32 offen lds
    s_add_u32 m0, s34, 7168
    s_nop 0
    buffer_load_dwordx4 v17, s[12:15], s32 offen lds
    s_add_u32 s32, s32, 589824
    s_waitcnt vmcnt(16)
    s_barrier
    s_add_u32 m0, s34, 28672
    s_nop 0
    buffer_load_dwordx4 v10, s[12:15], s32 offen lds
    s_add_u32 m0, s34, 29696
    s_nop 0
    buffer_load_dwordx4 v11, s[12:15], s32 offen lds
    s_add_u32 m0, s34, 30720
    s_nop 0
    buffer_load_dwordx4 v12, s[12:15], s32 offen lds
    s_add_u32 m0, s34, 31744
    s_nop 0
    buffer_load_dwordx4 v13, s[12:15], s32 offen lds
    s_add_u32 m0, s34, 32768
    s_nop 0
    buffer_load_dwordx4 v14, s[12:15], s32 offen lds
    s_add_u32 m0, s34, 33792
    s_nop 0
    buffer_load_dwordx4 v15, s[12:15], s32 offen lds
    s_add_u32 m0, s34, 34816
    s_nop 0
    buffer_load_dwordx4 v16, s[12:15], s32 offen lds
    s_add_u32 m0, s34, 35840
    s_nop 0
    buffer_load_dwordx4 v17, s[12:15], s32 offen lds
    s_add_u32 s32, s32, 589824
    s_waitcnt vmcnt(16)
    s_barrier
    s_waitcnt vmcnt(8)
    s_barrier
    s_waitcnt vmcnt(0)
    s_barrier
    s_barrier
    s_branch P5_m_8
P4PA_m_66:
    v_lshlrev_b32 v10, 4, v1
    v_add_u32 v11, 66560, v10
    v_add_u32 v12, 66560, v11
    v_add_u32 v13, 66560, v12
    v_add_u32 v14, 66560, v13
    v_add_u32 v15, 66560, v14
    s_mul_i32 s33, s25, 399360
    s_lshl_b32 s30, s26, 10
    s_add_u32 s33, s33, s30
    s_add_u32 s33, s33, 16777216
    s_mul_i32 s35, s26, 6144
    s_add_u32 s35, s35, 16384
    s_lshl_b32 s30, s25, 12
    s_add_u32 s30, s30, 21233664
    s_mov_b32 s38, s30
    v_lshlrev_b32 v5, 7, v1
    s_cmp_eq_u32 s28, 7
    s_cbranch_scc1 W7_m_70
    s_cmp_ge_u32 s2, 192
    s_cbranch_scc1 NG_m_72
    s_mov_b32 s37, 0x400000
LW_m_74:
    v_mov_b32 v20, 160772
    ds_read_b32 v20, v20
    s_waitcnt lgkmcnt(0)
    v_readfirstlane_b32 s31, v20
    s_nop 0
    s_cmp_ge_u32 s31, 5
    s_cbranch_scc1 LG_m_75
    s_sub_u32 s37, s37, 1
    s_cmp_eq_u32 s37, 0
    s_cbranch_scc1 LG_m_75
    s_sleep 1
    s_branch LW_m_74
LG_m_75:
    s_branch NG_m_73
NG_m_72:
    s_mov_b64 exec, 1
    s_mov_b32 s37, 0x40000
POLL_m_76:
    buffer_load_dword v20, v5, s[20:23], s30 offen sc0 sc1
    s_waitcnt vmcnt(0)
    v_cmp_eq_u32 vcc, 0, v20
    s_sub_u32 s37, s37, 1
    s_cmp_eq_u32 s37, 0
    s_cbranch_scc1 GO_m_77
    s_cbranch_vccz GO_m_77
    s_sleep 8
    s_branch POLL_m_76
GO_m_77:
    s_mov_b64 exec, -1
NG_m_73:
    s_mov_b64 exec, 31
    s_mov_b32 s37, 0x40000
POLL_m_78:
    buffer_load_dword v20, v5, s[20:23], s30 offen sc0 sc1
    s_waitcnt vmcnt(0)
    v_cmp_eq_u32 vcc, 0, v20
    s_sub_u32 s37, s37, 1
    s_cmp_eq_u32 s37, 0
    s_cbranch_scc1 GO_m_79
    s_cbranch_vccz GO_m_79
    s_sleep 1
    s_branch POLL_m_78
GO_m_79:
    s_mov_b64 exec, -1
    v_mov_b32 v20, 160792
    v_mov_b32 v21, 1
    ds_write_b32 v20, v21
    s_branch WD_m_71
W7_m_70:
    s_mov_b32 s37, 0x400000
LW_m_80:
    v_mov_b32 v20, 160792
    ds_read_b32 v20, v20
    s_waitcnt lgkmcnt(0)
    v_readfirstlane_b32 s31, v20
    s_nop 0
    s_cmp_ge_u32 s31, 1
    s_cbranch_scc1 LG_m_81
    s_sub_u32 s37, s37, 1
    s_cmp_eq_u32 s37, 0
    s_cbranch_scc1 LG_m_81
    s_sleep 1
    s_branch LW_m_80
LG_m_81:
WD_m_71:
    s_add_u32 m0, s35, 0
    s_nop 0
    buffer_load_dwordx4 v10, s[20:23], s33 offen sc1 lds
    s_add_u32 m0, s35, 1024
    s_nop 0
    buffer_load_dwordx4 v11, s[20:23], s33 offen sc1 lds
    s_add_u32 m0, s35, 2048
    s_nop 0
    buffer_load_dwordx4 v12, s[20:23], s33 offen sc1 lds
    s_add_u32 m0, s35, 3072
    s_nop 0
    buffer_load_dwordx4 v13, s[20:23], s33 offen sc1 lds
    s_add_u32 m0, s35, 4096
    s_nop 0
    buffer_load_dwordx4 v14, s[20:23], s33 offen sc1 lds
    s_add_u32 m0, s35, 5120
    s_nop 0
    buffer_load_dwordx4 v15, s[20:23], s33 offen sc1 lds
    s_add_u32 s33, s33, 2048
    s_add_u32 m0, s35, 28672
    s_nop 0
    buffer_load_dwordx4 v10, s[20:23], s33 offen sc1 lds
    s_add_u32 m0, s35, 29696
    s_nop 0
    buffer_load_dwordx4 v11, s[20:23], s33 offen sc1 lds
    s_add_u32 m0, s35, 30720
    s_nop 0
    buffer_load_dwordx4 v12, s[20:23], s33 offen sc1 lds
    s_add_u32 m0, s35, 31744
    s_nop 0
    buffer_load_dwordx4 v13, s[20:23], s33 offen sc1 lds
    s_add_u32 m0, s35, 32768
    s_nop 0
    buffer_load_dwordx4 v14, s[20:23], s33 offen sc1 lds
    s_add_u32 m0, s35, 33792
    s_nop 0
    buffer_load_dwordx4 v15, s[20:23], s33 offen sc1 lds
    s_add_u32 s33, s33, 2048
    s_waitcnt vmcnt(6)
    s_barrier
    s_add_u32 m0, s35, 57344
    s_nop 0
    buffer_load_dwordx4 v10, s[20:23], s33 offen sc1 lds
    s_add_u32 m0, s35, 58368
    s_nop 0
    buffer_load_dwordx4 v11, s[20:23], s33 offen sc1 lds
    s_add_u32 m0, s35, 59392
    s_nop 0
    buffer_load_dwordx4 v12, s[20:23], s33 offen sc1 lds
    s_add_u32 m0, s35, 60416
    s_nop 0
    buffer_load_dwordx4 v13, s[20:23], s33 offen sc1 lds
    s_add_u32 m0, s35, 61440
    s_nop 0
    buffer_load_dwordx4 v14, s[20:23], s33 offen sc1 lds
    s_add_u32 m0, s35, 62464
    s_nop 0
    buffer_load_dwordx4 v15, s[20:23], s33 offen sc1 lds
    s_add_u32 s33, s33, 2048
    s_add_u32 m0, s35, 86016
    s_nop 0
    buffer_load_dwordx4 v10, s[20:23], s33 offen sc1 lds
    s_add_u32 m0, s35, 87040
    s_nop 0
    buffer_load_dwordx4 v11, s[20:23], s33 offen sc1 lds
    s_add_u32 m0, s35, 88064
    s_nop 0
    buffer_load_dwordx4 v12, s[20:23], s33 offen sc1 lds
    s_add_u32 m0, s35, 89088
    s_nop 0
    buffer_load_dwordx4 v13, s[20:23], s33 offen sc1 lds
    s_add_u32 m0, s35, 90112
    s_nop 0
    buffer_load_dwordx4 v14, s[20:23], s33 offen sc1 lds
    s_add_u32 m0, s35, 91136
    s_nop 0
    buffer_load_dwordx4 v15, s[20:23], s33 offen sc1 lds
    s_add_u32 s33, s33, 2048
    s_add_u32 m0, s35, 114688
    s_nop 0
    buffer_load_dwordx4 v10, s[20:23], s33 offen sc1 lds
    s_add_u32 m0, s35, 115712
    s_nop 0
    buffer_load_dwordx4 v11, s[20:23], s33 offen sc1 lds
    s_add_u32 m0, s35, 116736
    s_nop 0
    buffer_load_dwordx4 v12, s[20:23], s33 offen sc1 lds
    s_add_u32 m0, s35, 117760
    s_nop 0
    buffer_load_dwordx4 v13, s[20:23], s33 offen sc1 lds
    s_add_u32 m0, s35, 118784
    s_nop 0
    buffer_load_dwordx4 v14, s[20:23], s33 offen sc1 lds
    s_add_u32 m0, s35, 119808
    s_nop 0
    buffer_load_dwordx4 v15, s[20:23], s33 offen sc1 lds
    s_add_u32 s33, s33, 2048
    s_waitcnt vmcnt(18)
    s_barrier
    s_waitcnt vmcnt(12)
    s_barrier
    s_cmp_eq_u32 s28, 7
    s_cbranch_scc1 W7_m_82
    s_mov_b32 exec_hi, 0
    s_mov_b32 s37, 0x40000
POLL_m_84:
    buffer_load_dword v20, v5, s[20:23], s38 offen sc0 sc1
    s_waitcnt vmcnt(0)
    v_cmp_eq_u32 vcc, 0, v20
    s_sub_u32 s37, s37, 1
    s_cmp_eq_u32 s37, 0
    s_cbranch_scc1 GO_m_85
    s_cbranch_vccz GO_m_85
    s_sleep 1
    s_branch POLL_m_84
GO_m_85:
    s_mov_b32 exec_hi, -1
    v_mov_b32 v20, 160792
    v_mov_b32 v21, 2
    ds_write_b32 v20, v21
    s_branch WD_m_83
W7_m_82:
    s_mov_b32 s37, 0x400000
LW_m_86:
    v_mov_b32 v20, 160792
    ds_read_b32 v20, v20
    s_waitcnt lgkmcnt(0)
    v_readfirstlane_b32 s31, v20
    s_nop 0
    s_cmp_ge_u32 s31, 2
    s_cbranch_scc1 LG_m_87
    s_sub_u32 s37, s37, 1
    s_cmp_eq_u32 s37, 0
    s_cbranch_scc1 LG_m_87
    s_sleep 1
    s_branch LW_m_86
LG_m_87:
WD_m_83:
    s_mov_b32 s36, 5
PL_m_88:
    s_add_u32 m0, s35, 0
    s_nop 0
    buffer_load_dwordx4 v10, s[20:23], s33 offen sc1 lds
    s_add_u32 m0, s35, 1024
    s_nop 0
    buffer_load_dwordx4 v11, s[20:23], s33 offen sc1 lds
    s_add_u32 m0, s35, 2048
    s_nop 0
    buffer_load_dwordx4 v12, s[20:23], s33 offen sc1 lds
    s_add_u32 m0, s35, 3072
    s_nop 0
    buffer_load_dwordx4 v13, s[20:23], s33 offen sc1 lds
    s_add_u32 m0, s35, 4096
    s_nop 0
    buffer_load_dwordx4 v14, s[20:23], s33 offen sc1 lds
    s_add_u32 m0, s35, 5120
    s_nop 0
    buffer_load_dwordx4 v15, s[20:23], s33 offen sc1 lds
    s_add_u32 s33, s33, 2048
    s_waitcnt vmcnt(12)
    s_barrier
    s_add_u32 m0, s35, 28672
    s_nop 0
    buffer_load_dwordx4 v10, s[20:23], s33 offen sc1 lds
    s_add_u32 m0, s35, 29696
    s_nop 0
    buffer_load_dwordx4 v11, s[20:23], s33 offen sc1 lds
    s_add_u32 m0, s35, 30720
    s_nop 0
    buffer_load_dwordx4 v12, s[20:23], s33 offen sc1 lds
    s_add_u32 m0, s35, 31744
    s_nop 0
    buffer_load_dwordx4 v13, s[20:23], s33 offen sc1 lds
    s_add_u32 m0, s35, 32768
    s_nop 0
    buffer_load_dwordx4 v14, s[20:23], s33 offen sc1 lds
    s_add_u32 m0, s35, 33792
    s_nop 0
    buffer_load_dwordx4 v15, s[20:23], s33 offen sc1 lds
    s_add_u32 s33, s33, 2048
    s_waitcnt vmcnt(12)
    s_barrier
    s_add_u32 m0, s35, 57344
    s_nop 0
    buffer_load_dwordx4 v10, s[20:23], s33 offen sc1 lds
    s_add_u32 m0, s35, 58368
    s_nop 0
    buffer_load_dwordx4 v11, s[20:23], s33 offen sc1 lds
    s_add_u32 m0, s35, 59392
    s_nop 0
    buffer_load_dwordx4 v12, s[20:23], s33 offen sc1 lds
    s_add_u32 m0, s35, 60416
    s_nop 0
    buffer_load_dwordx4 v13, s[20:23], s33 offen sc1 lds
    s_add_u32 m0, s35, 61440
    s_nop 0
    buffer_load_dwordx4 v14, s[20:23], s33 offen sc1 lds
    s_add_u32 m0, s35, 62464
    s_nop 0
    buffer_load_dwordx4 v15, s[20:23], s33 offen sc1 lds
    s_add_u32 s33, s33, 2048
    s_waitcnt vmcnt(12)
    s_barrier
    s_add_u32 m0, s35, 86016
    s_nop 0
    buffer_load_dwordx4 v10, s[20:23], s33 offen sc1 lds
    s_add_u32 m0, s35, 87040
    s_nop 0
    buffer_load_dwordx4 v11, s[20:23], s33 offen sc1 lds
    s_add_u32 m0, s35, 88064
    s_nop 0
    buffer_load_dwordx4 v12, s[20:23], s33 offen sc1 lds
    s_add_u32 m0, s35, 89088
    s_nop 0
    buffer_load_dwordx4 v13, s[20:23], s33 offen sc1 lds
    s_add_u32 m0, s35, 90112
    s_nop 0
    buffer_load_dwordx4 v14, s[20:23], s33 offen sc1 lds
    s_add_u32 m0, s35, 91136
    s_nop 0
    buffer_load_dwordx4 v15, s[20:23], s33 offen sc1 lds
    s_add_u32 s33, s33, 2048
    s_waitcnt vmcnt(12)
    s_barrier
    s_add_u32 m0, s35, 114688
    s_nop 0
    buffer_load_dwordx4 v10, s[20:23], s33 offen sc1 lds
    s_add_u32 m0, s35, 115712
    s_nop 0
    buffer_load_dwordx4 v11, s[20:23], s33 offen sc1 lds
    s_add_u32 m0, s35, 116736
    s_nop 0
    buffer_load_dwordx4 v12, s[20:23], s33 offen sc1 lds
    s_add_u32 m0, s35, 117760
    s_nop 0
    buffer_load_dwordx4 v13, s[20:23], s33 offen sc1 lds
    s_add_u32 m0, s35, 118784
    s_nop 0
    buffer_load_dwordx4 v14, s[20:23], s33 offen sc1 lds
    s_add_u32 m0, s35, 119808
    s_nop 0
    buffer_load_dwordx4 v15, s[20:23], s33 offen sc1 lds
    s_add_u32 s33, s33, 2048
    s_waitcnt vmcnt(12)
    s_barrier
    s_sub_u32 s36, s36, 1
    s_cmp_lg_u32 s36, 0
    s_cbranch_scc1 PL_m_88
    s_add_u32 m0, s35, 0
    s_nop 0
    buffer_load_dwordx4 v10, s[20:23], s33 offen sc1 lds
    s_add_u32 m0, s35, 1024
    s_nop 0
    buffer_load_dwordx4 v11, s[20:23], s33 offen sc1 lds
    s_add_u32 m0, s35, 2048
    s_nop 0
    buffer_load_dwordx4 v12, s[20:23], s33 offen sc1 lds
    s_add_u32 m0, s35, 3072
    s_nop 0
    buffer_load_dwordx4 v13, s[20:23], s33 offen sc1 lds
    s_add_u32 m0, s35, 4096
    s_nop 0
    buffer_load_dwordx4 v14, s[20:23], s33 offen sc1 lds
    s_add_u32 m0, s35, 5120
    s_nop 0
    buffer_load_dwordx4 v15, s[20:23], s33 offen sc1 lds
    s_add_u32 s33, s33, 2048
    s_waitcnt vmcnt(12)
    s_barrier
    s_add_u32 m0, s35, 28672
    s_nop 0
    buffer_load_dwordx4 v10, s[20:23], s33 offen sc1 lds
    s_add_u32 m0, s35, 29696
    s_nop 0
    buffer_load_dwordx4 v11, s[20:23], s33 offen sc1 lds
    s_add_u32 m0, s35, 30720
    s_nop 0
    buffer_load_dwordx4 v12, s[20:23], s33 offen sc1 lds
    s_add_u32 m0, s35, 31744
    s_nop 0
    buffer_load_dwordx4 v13, s[20:23], s33 offen sc1 lds
    s_add_u32 m0, s35, 32768
    s_nop 0
    buffer_load_dwordx4 v14, s[20:23], s33 offen sc1 lds
    s_add_u32 m0, s35, 33792
    s_nop 0
    buffer_load_dwordx4 v15, s[20:23], s33 offen sc1 lds
    s_add_u32 s33, s33, 2048
    s_waitcnt vmcnt(12)
    s_barrier
    s_waitcnt vmcnt(6)
    s_barrier
    s_waitcnt vmcnt(0)
    s_barrier
    s_barrier
    s_branch P5_m_8
P4PF_m_65:
    s_sub_u32 s29, s2, 216
    s_mov_b32 s52, s76
    s_and_b32 s53, s77, 0xffff
    s_mov_b32 s54, 18874368
    s_mov_b32 s55, 0x20000
    s_mul_i32 s60, s29, 376064
    s_add_u32 s60, s60, 3833856
    v_lshlrev_b32 v10, 7, v0
    buffer_load_dword v234, v10, s[52:55], s60 offen
    s_add_u32 s60, s60, 65536
    buffer_load_dword v234, v10, s[52:55], s60 offen
    s_add_u32 s60, s60, 65536
    buffer_load_dword v234, v10, s[52:55], s60 offen
    s_add_u32 s60, s60, 65536
    buffer_load_dword v234, v10, s[52:55], s60 offen
    s_add_u32 s60, s60, 65536
    buffer_load_dword v234, v10, s[52:55], s60 offen
    s_add_u32 s60, s60, 65536
    v_mov_b32 v11, 0x7ff00000
    v_cmp_gt_u32 vcc, 378, v0
    s_nop 1
    v_cndmask_b32 v10, v11, v10, vcc
    buffer_load_dword v234, v10, s[52:55], s60 offen
    s_add_u32 s60, s60, 65536
    s_branch P5_m_8
P5_m_8:
    s_lshr_b32 s26, s10, 1
    s_and_b32 s25, s11, 3
    s_lshr_b32 s24, s11, 2
    s_sub_u32 s30, s10, 5
    s_cmp_lt_u32 s30, 2
    s_cselect_b32 s30, 7, 6
    s_add_u32 s24, s24, s30
    s_and_b32 s24, s24, 7
    s_and_b32 s29, s10, 1
    s_lshl_b32 s29, s29, 3
    s_add_u32 s24, s24, s29
    s_and_b32 s29, s26, 1
    v_lshrrev_b32 v3, 4, v1
    v_and_b32 v4, 15, v1
    s_cmp_ge_u32 s28, 4
    s_cbranch_scc1 P5PROD_m_89
    s_mov_b32 s16, s78
    s_and_b32 s17, s79, 0xffff
    s_mov_b32 s18, 4096
    s_mov_b32 s19, 0x20000
    s_mov_b32 s40, s80
    s_and_b32 s41, s81, 0xffff
    s_mov_b32 s42, 2359296
    s_mov_b32 s43, 0x20000
    s_lshl_b32 s30, s24, 8
    s_lshl_b32 s31, s28, 6
    s_add_u32 s30, s30, s31
    s_lshl_b32 s31, s29, 5
    s_add_u32 s30, s30, s31
    v_lshlrev_b32 v5, 1, v4
    buffer_load_ushort v22, v5, s[16:19], s30 offen
    v_lshlrev_b32 v8, 4, v1
    s_mul_i32 s49, s25, 599040
    s_lshl_b32 s32, s24, 12
    s_add_u32 s49, s49, s32
    s_lshl_b32 s32, s28, 10
    s_add_u32 s49, s49, s32
    s_add_u32 s49, s49, 12582912
    s_lshr_b32 s32, s26, 1
    s_mul_i32 s32, s32, 332800
    s_add_u32 s49, s49, s32
    v_bfe_u32 v5, v1, 2, 2
    v_lshl_add_u32 v5, v3, 2, v5
    v_and_b32 v6, 7, v5
    v_lshlrev_b32 v5, 8, v5
    v_and_b32 v7, 3, v1
    v_lshl_add_u32 v5, v7, 3, v5
    s_lshl_b32 s30, s28, 1
    s_add_u32 s30, s30, s29
    s_xor_b32 s31, s30, 0
    v_xor_b32 v7, s31, v6
    v_lshl_add_u32 v10, v7, 5, v5
    v_add_u32 v12, 34816, v10
    v_add_u32 v14, 69632, v10
    v_add_u32 v16, 104448, v10
    s_xor_b32 s31, s30, 1
    v_xor_b32 v7, s31, v6
    v_lshl_add_u32 v11, v7, 5, v5
    v_add_u32 v13, 34816, v11
    v_add_u32 v15, 69632, v11
    v_add_u32 v17, 104448, v11
    v_lshlrev_b32 v18, 4, v1
    v_add_u32 v18, 16384, v18
    v_add_u32 v19, 34816, v18
    v_add_u32 v20, 69632, v18
    v_add_u32 v21, 104448, v18
    v_lshlrev_b32 v5, 2, v3
    v_sub_u32 v5, v4, v5
    v_mov_b32 v6, 0x3f80
    v_mov_b32 v7, 0x3f800000
    s_cmp_eq_u32 s29, 0
    s_cselect_b64 s[38:39], -1, 0
    v_cmp_eq_u32 vcc, 0, v5
    s_nop 1
    v_cndmask_b32 v48, 0, v6, vcc
    v_cmp_eq_u32 vcc, 1, v5
    s_nop 1
    v_cndmask_b32 v48, v48, v7, vcc
    v_cndmask_b32 v24, 0, v48, s[38:39]
    v_cndmask_b32 v26, v48, 0, s[38:39]
    v_cmp_eq_u32 vcc, 2, v5
    s_nop 1
    v_cndmask_b32 v48, 0, v6, vcc
    v_cmp_eq_u32 vcc, 3, v5
    s_nop 1
    v_cndmask_b32 v48, v48, v7, vcc
    v_cndmask_b32 v25, 0, v48, s[38:39]
    v_cndmask_b32 v27, v48, 0, s[38:39]
    v_mov_b32 v136, 0
    v_mov_b32 v137, 0
    v_mov_b32 v138, 0
    v_mov_b32 v139, 0
    v_mov_b32 v140, 0
    v_mov_b32 v141, 0
    v_mov_b32 v142, 0
    v_mov_b32 v143, 0
    v_mov_b32 v144, 0
    v_mov_b32 v145, 0
    v_mov_b32 v146, 0
    v_mov_b32 v147, 0
    v_mov_b32 v148, 0
    v_mov_b32 v149, 0
    v_mov_b32 v150, 0
    v_mov_b32 v151, 0
    v_mov_b32 v152, 0
    v_mov_b32 v153, 0
    v_mov_b32 v154, 0
    v_mov_b32 v155, 0
    v_mov_b32 v156, 0
    v_mov_b32 v157, 0
    v_mov_b32 v158, 0
    v_mov_b32 v159, 0
    v_mov_b32 v160, 0
    v_mov_b32 v161, 0
    v_mov_b32 v162, 0
    v_mov_b32 v163, 0
    v_mov_b32 v164, 0
    v_mov_b32 v165, 0
    v_mov_b32 v166, 0
    v_mov_b32 v167, 0
    v_mov_b32 v168, 0
    v_mov_b32 v169, 0
    v_mov_b32 v170, 0
    v_mov_b32 v171, 0
    v_mov_b32 v172, 0
    v_mov_b32 v173, 0
    v_mov_b32 v174, 0
    v_mov_b32 v175, 0
    v_mov_b32 v176, 0
    v_mov_b32 v177, 0
    v_mov_b32 v178, 0
    v_mov_b32 v179, 0
    v_mov_b32 v180, 0
    v_mov_b32 v181, 0
    v_mov_b32 v182, 0
    v_mov_b32 v183, 0
    v_mov_b32 v184, 0
    v_mov_b32 v185, 0
    v_mov_b32 v186, 0
    v_mov_b32 v187, 0
    v_mov_b32 v188, 0
    v_mov_b32 v189, 0
    v_mov_b32 v190, 0
    v_mov_b32 v191, 0
    v_mov_b32 v192, 0
    v_mov_b32 v193, 0
    v_mov_b32 v194, 0
    v_mov_b32 v195, 0
    v_mov_b32 v196, 0
    v_mov_b32 v197, 0
    v_mov_b32 v198, 0
    v_mov_b32 v199, 0
    v_mov_b32 v200, 0
    v_mov_b32 v201, 0
    v_mov_b32 v202, 0
    v_mov_b32 v203, 0
    v_mov_b32 v204, 0
    v_mov_b32 v205, 0
    v_mov_b32 v206, 0
    v_mov_b32 v207, 0
    s_lshl_b32 s32, s24, 2
    s_add_u32 s32, s32, s25
    s_mul_i32 s33, s32, 122880
    s_mul_i32 s30, s28, 2560
    s_add_u32 s33, s33, s30
    s_add_u32 s33, s33, 33554432
    s_xor_b32 s30, s26, 1
    s_sub_u32 s31, s26, s30
    s_sub_u32 s31, s31, 1
    s_and_b32 s31, s31, 3
    s_mul_i32 s30, s30, 3
    s_add_u32 s30, s30, s31
    s_mul_i32 s30, s30, 10240
    s_add_u32 s45, s30, s33
    s_xor_b32 s30, s26, 2
    s_sub_u32 s31, s26, s30
    s_sub_u32 s31, s31, 1
    s_and_b32 s31, s31, 3
    s_mul_i32 s30, s30, 3
    s_add_u32 s30, s30, s31
    s_mul_i32 s30, s30, 10240
    s_add_u32 s46, s30, s33
    s_xor_b32 s30, s26, 3
    s_sub_u32 s31, s26, s30
    s_sub_u32 s31, s31, 1
    s_and_b32 s31, s31, 3
    s_mul_i32 s30, s30, 3
    s_add_u32 s30, s30, s31
    s_mul_i32 s30, s30, 10240
    s_add_u32 s47, s30, s33
    s_mul_i32 s30, s26, 30720
    s_add_u32 s33, s33, s30
    s_lshl_b32 s35, s32, 11
    s_lshl_b32 s30, s28, 9
    s_add_u32 s35, s35, s30
    s_add_u32 s35, s35, 21285888
    s_lshl_b32 s30, s26, 7
    s_add_u32 s34, s30, s35
    s_lshl_b32 s48, s24, 7
    s_lshl_b32 s31, s28, 5
    s_add_u32 s48, s48, s31
    s_lshl_b32 s31, s29, 4
    s_add_u32 s48, s48, s31
    s_mul_i32 s48, s48, 1152
    s_mul_i32 s31, s25, 288
    s_add_u32 s48, s48, s31
    s_mov_b32 s56, s82
    s_and_b32 s57, s83, 0xffff
    s_mov_b32 s58, 256
    s_mov_b32 s59, 0x20000
    v_mov_b32 v208, 4
    s_barrier
    ds_read_b64_tr_b16 v[120:121], v10 offset:0
    ds_read_b64_tr_b16 v[122:123], v10 offset:4096
    ds_read_b64_tr_b16 v[124:125], v11 offset:0
    ds_read_b64_tr_b16 v[126:127], v11 offset:4096
    ds_read_b128 v[48:51], v18 offset:0
    ds_read_b128 v[52:55], v18 offset:1024
    ds_read_b128 v[56:59], v18 offset:2048
    ds_read_b128 v[60:63], v18 offset:3072
    ds_read_b128 v[64:67], v18 offset:4096
    ds_read_b128 v[68:71], v18 offset:5120
    ds_read_b128 v[72:75], v18 offset:6144
    ds_read_b128 v[76:79], v18 offset:7168
    ds_read_b128 v[80:83], v18 offset:8192
    buffer_load_dwordx4 v[28:31], v8, s[20:23], s49 offen sc1
    s_add_u32 s49, s49, 66560
    buffer_load_dwordx4 v[32:35], v8, s[20:23], s49 offen sc1
    s_add_u32 s49, s49, 66560
    buffer_load_dwordx4 v[36:39], v8, s[20:23], s49 offen sc1
    s_add_u32 s49, s49, 66560
    buffer_load_dwordx4 v[40:43], v8, s[20:23], s49 offen sc1
    s_add_u32 s49, s49, 66560
    buffer_load_dwordx4 v[44:47], v8, s[20:23], s49 offen sc1
    s_add_u32 s49, s49, 66560
    s_mov_b32 s36, 4
CL_m_92:
    s_waitcnt lgkmcnt(6)
    v_mfma_f32_16x16x32_bf16 v[136:139], v[48:51], v[120:123], v[136:139]
    ds_read_b64_tr_b16 v[128:129], v10 offset:8192
    v_mfma_f32_16x16x32_bf16 v[140:143], v[48:51], v[124:127], v[140:143]
    ds_read_b64_tr_b16 v[130:131], v10 offset:12288
    v_mfma_f32_16x16x32_bf16 v[144:147], v[52:55], v[120:123], v[144:147]
    ds_read_b64_tr_b16 v[132:133], v11 offset:8192
    v_mfma_f32_16x16x32_bf16 v[148:151], v[52:55], v[124:127], v[148:151]
    ds_read_b64_tr_b16 v[134:135], v11 offset:12288
    v_mfma_f32_16x16x32_bf16 v[152:155], v[56:59], v[120:123], v[152:155]
    ds_read_b128 v[84:87], v18 offset:9216
    v_mfma_f32_16x16x32_bf16 v[156:159], v[56:59], v[124:127], v[156:159]
    s_waitcnt lgkmcnt(8)
    v_mfma_f32_16x16x32_bf16 v[160:163], v[60:63], v[120:123], v[160:163]
    ds_read_b128 v[88:91], v18 offset:10240
    v_mfma_f32_16x16x32_bf16 v[164:167], v[60:63], v[124:127], v[164:167]
    ds_read_b128 v[92:95], v18 offset:11264
    v_mfma_f32_16x16x32_bf16 v[168:171], v[64:67], v[120:123], v[168:171]
    ds_read_b128 v[96:99], v18 offset:12288
    v_mfma_f32_16x16x32_bf16 v[172:175], v[64:67], v[124:127], v[172:175]
    ds_read_b128 v[100:103], v18 offset:13312
    v_mfma_f32_16x16x32_bf16 v[176:179], v[68:71], v[120:123], v[176:179]
    ds_read_b128 v[104:107], v18 offset:14336
    v_mfma_f32_16x16x32_bf16 v[180:183], v[68:71], v[124:127], v[180:183]
    s_waitcnt lgkmcnt(10)
    v_mfma_f32_16x16x32_bf16 v[184:187], v[72:75], v[120:123], v[184:187]
    ds_read_b128 v[108:111], v18 offset:15360
    v_mfma_f32_16x16x32_bf16 v[188:191], v[72:75], v[124:127], v[188:191]
    ds_read_b128 v[112:115], v18 offset:16384
    v_mfma_f32_16x16x32_bf16 v[192:195], v[76:79], v[120:123], v[192:195]
    ds_read_b128 v[116:119], v18 offset:17408
    v_mfma_f32_16x16x32_bf16 v[196:199], v[76:79], v[124:127], v[196:199]
    v_mfma_f32_16x16x32_bf16 v[200:203], v[80:83], v[120:123], v[200:203]
    v_mfma_f32_16x16x32_bf16 v[204:207], v[80:83], v[124:127], v[204:207]
    s_barrier
    s_waitcnt lgkmcnt(6)
    v_mfma_f32_16x16x32_bf16 v[136:139], v[84:87], v[128:131], v[136:139]
    ds_read_b64_tr_b16 v[120:121], v12 offset:0
    v_mfma_f32_16x16x32_bf16 v[140:143], v[84:87], v[132:135], v[140:143]
    ds_read_b64_tr_b16 v[122:123], v12 offset:4096
    v_mfma_f32_16x16x32_bf16 v[144:147], v[88:91], v[128:131], v[144:147]
    ds_read_b64_tr_b16 v[124:125], v13 offset:0
    v_mfma_f32_16x16x32_bf16 v[148:151], v[88:91], v[132:135], v[148:151]
    ds_read_b64_tr_b16 v[126:127], v13 offset:4096
    v_mfma_f32_16x16x32_bf16 v[152:155], v[92:95], v[128:131], v[152:155]
    ds_read_b128 v[48:51], v19 offset:0
    v_mfma_f32_16x16x32_bf16 v[156:159], v[92:95], v[132:135], v[156:159]
    s_waitcnt lgkmcnt(8)
    v_mfma_f32_16x16x32_bf16 v[160:163], v[96:99], v[128:131], v[160:163]
    ds_read_b128 v[52:55], v19 offset:1024
    v_mfma_f32_16x16x32_bf16 v[164:167], v[96:99], v[132:135], v[164:167]
    ds_read_b128 v[56:59], v19 offset:2048
    v_mfma_f32_16x16x32_bf16 v[168:171], v[100:103], v[128:131], v[168:171]
    ds_read_b128 v[60:63], v19 offset:3072
    v_mfma_f32_16x16x32_bf16 v[172:175], v[100:103], v[132:135], v[172:175]
    ds_read_b128 v[64:67], v19 offset:4096
    v_mfma_f32_16x16x32_bf16 v[176:179], v[104:107], v[128:131], v[176:179]
    ds_read_b128 v[68:71], v19 offset:5120
    v_mfma_f32_16x16x32_bf16 v[180:183], v[104:107], v[132:135], v[180:183]
    s_waitcnt lgkmcnt(10)
    v_mfma_f32_16x16x32_bf16 v[184:187], v[108:111], v[128:131], v[184:187]
    ds_read_b128 v[72:75], v19 offset:6144
    v_mfma_f32_16x16x32_bf16 v[188:191], v[108:111], v[132:135], v[188:191]
    ds_read_b128 v[76:79], v19 offset:7168
    v_mfma_f32_16x16x32_bf16 v[192:195], v[112:115], v[128:131], v[192:195]
    ds_read_b128 v[80:83], v19 offset:8192
    v_mfma_f32_16x16x32_bf16 v[196:199], v[112:115], v[132:135], v[196:199]
    v_mfma_f32_16x16x32_bf16 v[200:203], v[116:119], v[128:131], v[200:203]
    v_mfma_f32_16x16x32_bf16 v[204:207], v[116:119], v[132:135], v[204:207]
    s_waitcnt lgkmcnt(6)
    v_mfma_f32_16x16x32_bf16 v[136:139], v[48:51], v[120:123], v[136:139]
    ds_read_b64_tr_b16 v[128:129], v12 offset:8192
    v_mfma_f32_16x16x32_bf16 v[140:143], v[48:51], v[124:127], v[140:143]
    ds_read_b64_tr_b16 v[130:131], v12 offset:12288
    v_mfma_f32_16x16x32_bf16 v[144:147], v[52:55], v[120:123], v[144:147]
    ds_read_b64_tr_b16 v[132:133], v13 offset:8192
    v_mfma_f32_16x16x32_bf16 v[148:151], v[52:55], v[124:127], v[148:151]
    ds_read_b64_tr_b16 v[134:135], v13 offset:12288
    v_mfma_f32_16x16x32_bf16 v[152:155], v[56:59], v[120:123], v[152:155]
    ds_read_b128 v[84:87], v19 offset:9216
    v_mfma_f32_16x16x32_bf16 v[156:159], v[56:59], v[124:127], v[156:159]
    s_waitcnt lgkmcnt(8)
    v_mfma_f32_16x16x32_bf16 v[160:163], v[60:63], v[120:123], v[160:163]
    ds_read_b128 v[88:91], v19 offset:10240
    v_mfma_f32_16x16x32_bf16 v[164:167], v[60:63], v[124:127], v[164:167]
    ds_read_b128 v[92:95], v19 offset:11264
    v_mfma_f32_16x16x32_bf16 v[168:171], v[64:67], v[120:123], v[168:171]
    ds_read_b128 v[96:99], v19 offset:12288
    v_mfma_f32_16x16x32_bf16 v[172:175], v[64:67], v[124:127], v[172:175]
    ds_read_b128 v[100:103], v19 offset:13312
    v_mfma_f32_16x16x32_bf16 v[176:179], v[68:71], v[120:123], v[176:179]
    ds_read_b128 v[104:107], v19 offset:14336
    v_mfma_f32_16x16x32_bf16 v[180:183], v[68:71], v[124:127], v[180:183]
    s_waitcnt lgkmcnt(10)
    v_mfma_f32_16x16x32_bf16 v[184:187], v[72:75], v[120:123], v[184:187]
    ds_read_b128 v[108:111], v19 offset:15360
    v_mfma_f32_16x16x32_bf16 v[188:191], v[72:75], v[124:127], v[188:191]
    ds_read_b128 v[112:115], v19 offset:16384
    v_mfma_f32_16x16x32_bf16 v[192:195], v[76:79], v[120:123], v[192:195]
    ds_read_b128 v[116:119], v19 offset:17408
    v_mfma_f32_16x16x32_bf16 v[196:199], v[76:79], v[124:127], v[196:199]
    v_mfma_f32_16x16x32_bf16 v[200:203], v[80:83], v[120:123], v[200:203]
    v_mfma_f32_16x16x32_bf16 v[204:207], v[80:83], v[124:127], v[204:207]
    s_barrier
    s_waitcnt lgkmcnt(6)
    v_mfma_f32_16x16x32_bf16 v[136:139], v[84:87], v[128:131], v[136:139]
    ds_read_b64_tr_b16 v[120:121], v14 offset:0
    v_mfma_f32_16x16x32_bf16 v[140:143], v[84:87], v[132:135], v[140:143]
    ds_read_b64_tr_b16 v[122:123], v14 offset:4096
    v_mfma_f32_16x16x32_bf16 v[144:147], v[88:91], v[128:131], v[144:147]
    ds_read_b64_tr_b16 v[124:125], v15 offset:0
    v_mfma_f32_16x16x32_bf16 v[148:151], v[88:91], v[132:135], v[148:151]
    ds_read_b64_tr_b16 v[126:127], v15 offset:4096
    v_mfma_f32_16x16x32_bf16 v[152:155], v[92:95], v[128:131], v[152:155]
    ds_read_b128 v[48:51], v20 offset:0
    v_mfma_f32_16x16x32_bf16 v[156:159], v[92:95], v[132:135], v[156:159]
    s_waitcnt lgkmcnt(8)
    v_mfma_f32_16x16x32_bf16 v[160:163], v[96:99], v[128:131], v[160:163]
    ds_read_b128 v[52:55], v20 offset:1024
    v_mfma_f32_16x16x32_bf16 v[164:167], v[96:99], v[132:135], v[164:167]
    ds_read_b128 v[56:59], v20 offset:2048
    v_mfma_f32_16x16x32_bf16 v[168:171], v[100:103], v[128:131], v[168:171]
    ds_read_b128 v[60:63], v20 offset:3072
    v_mfma_f32_16x16x32_bf16 v[172:175], v[100:103], v[132:135], v[172:175]
    ds_read_b128 v[64:67], v20 offset:4096
    v_mfma_f32_16x16x32_bf16 v[176:179], v[104:107], v[128:131], v[176:179]
    ds_read_b128 v[68:71], v20 offset:5120
    v_mfma_f32_16x16x32_bf16 v[180:183], v[104:107], v[132:135], v[180:183]
    s_waitcnt lgkmcnt(10)
    v_mfma_f32_16x16x32_bf16 v[184:187], v[108:111], v[128:131], v[184:187]
    ds_read_b128 v[72:75], v20 offset:6144
    v_mfma_f32_16x16x32_bf16 v[188:191], v[108:111], v[132:135], v[188:191]
    ds_read_b128 v[76:79], v20 offset:7168
    v_mfma_f32_16x16x32_bf16 v[192:195], v[112:115], v[128:131], v[192:195]
    ds_read_b128 v[80:83], v20 offset:8192
    v_mfma_f32_16x16x32_bf16 v[196:199], v[112:115], v[132:135], v[196:199]
    v_mfma_f32_16x16x32_bf16 v[200:203], v[116:119], v[128:131], v[200:203]
    v_mfma_f32_16x16x32_bf16 v[204:207], v[116:119], v[132:135], v[204:207]
    s_waitcnt lgkmcnt(6)
    v_mfma_f32_16x16x32_bf16 v[136:139], v[48:51], v[120:123], v[136:139]
    ds_read_b64_tr_b16 v[128:129], v14 offset:8192
    v_mfma_f32_16x16x32_bf16 v[140:143], v[48:51], v[124:127], v[140:143]
    ds_read_b64_tr_b16 v[130:131], v14 offset:12288
    v_mfma_f32_16x16x32_bf16 v[144:147], v[52:55], v[120:123], v[144:147]
    ds_read_b64_tr_b16 v[132:133], v15 offset:8192
    v_mfma_f32_16x16x32_bf16 v[148:151], v[52:55], v[124:127], v[148:151]
    ds_read_b64_tr_b16 v[134:135], v15 offset:12288
    v_mfma_f32_16x16x32_bf16 v[152:155], v[56:59], v[120:123], v[152:155]
    ds_read_b128 v[84:87], v20 offset:9216
    v_mfma_f32_16x16x32_bf16 v[156:159], v[56:59], v[124:127], v[156:159]
    s_waitcnt lgkmcnt(8)
    v_mfma_f32_16x16x32_bf16 v[160:163], v[60:63], v[120:123], v[160:163]
    ds_read_b128 v[88:91], v20 offset:10240
    v_mfma_f32_16x16x32_bf16 v[164:167], v[60:63], v[124:127], v[164:167]
    ds_read_b128 v[92:95], v20 offset:11264
    v_mfma_f32_16x16x32_bf16 v[168:171], v[64:67], v[120:123], v[168:171]
    ds_read_b128 v[96:99], v20 offset:12288
    v_mfma_f32_16x16x32_bf16 v[172:175], v[64:67], v[124:127], v[172:175]
    ds_read_b128 v[100:103], v20 offset:13312
    v_mfma_f32_16x16x32_bf16 v[176:179], v[68:71], v[120:123], v[176:179]
    ds_read_b128 v[104:107], v20 offset:14336
    v_mfma_f32_16x16x32_bf16 v[180:183], v[68:71], v[124:127], v[180:183]
    s_waitcnt lgkmcnt(10)
    v_mfma_f32_16x16x32_bf16 v[184:187], v[72:75], v[120:123], v[184:187]
    ds_read_b128 v[108:111], v20 offset:15360
    v_mfma_f32_16x16x32_bf16 v[188:191], v[72:75], v[124:127], v[188:191]
    ds_read_b128 v[112:115], v20 offset:16384
    v_mfma_f32_16x16x32_bf16 v[192:195], v[76:79], v[120:123], v[192:195]
    ds_read_b128 v[116:119], v20 offset:17408
    v_mfma_f32_16x16x32_bf16 v[196:199], v[76:79], v[124:127], v[196:199]
    v_mfma_f32_16x16x32_bf16 v[200:203], v[80:83], v[120:123], v[200:203]
    v_mfma_f32_16x16x32_bf16 v[204:207], v[80:83], v[124:127], v[204:207]
    s_barrier
    s_waitcnt lgkmcnt(6)
    v_mfma_f32_16x16x32_bf16 v[136:139], v[84:87], v[128:131], v[136:139]
    ds_read_b64_tr_b16 v[120:121], v16 offset:0
    v_mfma_f32_16x16x32_bf16 v[140:143], v[84:87], v[132:135], v[140:143]
    ds_read_b64_tr_b16 v[122:123], v16 offset:4096
    v_mfma_f32_16x16x32_bf16 v[144:147], v[88:91], v[128:131], v[144:147]
    ds_read_b64_tr_b16 v[124:125], v17 offset:0
    v_mfma_f32_16x16x32_bf16 v[148:151], v[88:91], v[132:135], v[148:151]
    ds_read_b64_tr_b16 v[126:127], v17 offset:4096
    v_mfma_f32_16x16x32_bf16 v[152:155], v[92:95], v[128:131], v[152:155]
    ds_read_b128 v[48:51], v21 offset:0
    v_mfma_f32_16x16x32_bf16 v[156:159], v[92:95], v[132:135], v[156:159]
    s_waitcnt lgkmcnt(8)
    v_mfma_f32_16x16x32_bf16 v[160:163], v[96:99], v[128:131], v[160:163]
    ds_read_b128 v[52:55], v21 offset:1024
    v_mfma_f32_16x16x32_bf16 v[164:167], v[96:99], v[132:135], v[164:167]
    ds_read_b128 v[56:59], v21 offset:2048
    v_mfma_f32_16x16x32_bf16 v[168:171], v[100:103], v[128:131], v[168:171]
    ds_read_b128 v[60:63], v21 offset:3072
    v_mfma_f32_16x16x32_bf16 v[172:175], v[100:103], v[132:135], v[172:175]
    ds_read_b128 v[64:67], v21 offset:4096
    v_mfma_f32_16x16x32_bf16 v[176:179], v[104:107], v[128:131], v[176:179]
    ds_read_b128 v[68:71], v21 offset:5120
    v_mfma_f32_16x16x32_bf16 v[180:183], v[104:107], v[132:135], v[180:183]
    s_waitcnt lgkmcnt(10)
    v_mfma_f32_16x16x32_bf16 v[184:187], v[108:111], v[128:131], v[184:187]
    ds_read_b128 v[72:75], v21 offset:6144
    v_mfma_f32_16x16x32_bf16 v[188:191], v[108:111], v[132:135], v[188:191]
    ds_read_b128 v[76:79], v21 offset:7168
    v_mfma_f32_16x16x32_bf16 v[192:195], v[112:115], v[128:131], v[192:195]
    ds_read_b128 v[80:83], v21 offset:8192
    v_mfma_f32_16x16x32_bf16 v[196:199], v[112:115], v[132:135], v[196:199]
    v_mfma_f32_16x16x32_bf16 v[200:203], v[116:119], v[128:131], v[200:203]
    v_mfma_f32_16x16x32_bf16 v[204:207], v[116:119], v[132:135], v[204:207]
    s_waitcnt lgkmcnt(6)
    v_mfma_f32_16x16x32_bf16 v[136:139], v[48:51], v[120:123], v[136:139]
    ds_read_b64_tr_b16 v[128:129], v16 offset:8192
    v_mfma_f32_16x16x32_bf16 v[140:143], v[48:51], v[124:127], v[140:143]
    ds_read_b64_tr_b16 v[130:131], v16 offset:12288
    v_mfma_f32_16x16x32_bf16 v[144:147], v[52:55], v[120:123], v[144:147]
    ds_read_b64_tr_b16 v[132:133], v17 offset:8192
    v_mfma_f32_16x16x32_bf16 v[148:151], v[52:55], v[124:127], v[148:151]
    ds_read_b64_tr_b16 v[134:135], v17 offset:12288
    v_mfma_f32_16x16x32_bf16 v[152:155], v[56:59], v[120:123], v[152:155]
    ds_read_b128 v[84:87], v21 offset:9216
    v_mfma_f32_16x16x32_bf16 v[156:159], v[56:59], v[124:127], v[156:159]
    s_waitcnt lgkmcnt(8)
    v_mfma_f32_16x16x32_bf16 v[160:163], v[60:63], v[120:123], v[160:163]
    ds_read_b128 v[88:91], v21 offset:10240
    v_mfma_f32_16x16x32_bf16 v[164:167], v[60:63], v[124:127], v[164:167]
    ds_read_b128 v[92:95], v21 offset:11264
    v_mfma_f32_16x16x32_bf16 v[168:171], v[64:67], v[120:123], v[168:171]
    ds_read_b128 v[96:99], v21 offset:12288
    v_mfma_f32_16x16x32_bf16 v[172:175], v[64:67], v[124:127], v[172:175]
    ds_read_b128 v[100:103], v21 offset:13312
    v_mfma_f32_16x16x32_bf16 v[176:179], v[68:71], v[120:123], v[176:179]
    ds_read_b128 v[104:107], v21 offset:14336
    v_mfma_f32_16x16x32_bf16 v[180:183], v[68:71], v[124:127], v[180:183]
    s_waitcnt lgkmcnt(10)
    v_mfma_f32_16x16x32_bf16 v[184:187], v[72:75], v[120:123], v[184:187]
    ds_read_b128 v[108:111], v21 offset:15360
    v_mfma_f32_16x16x32_bf16 v[188:191], v[72:75], v[124:127], v[188:191]
    ds_read_b128 v[112:115], v21 offset:16384
    v_mfma_f32_16x16x32_bf16 v[192:195], v[76:79], v[120:123], v[192:195]
    ds_read_b128 v[116:119], v21 offset:17408
    v_mfma_f32_16x16x32_bf16 v[196:199], v[76:79], v[124:127], v[196:199]
    v_mfma_f32_16x16x32_bf16 v[200:203], v[80:83], v[120:123], v[200:203]
    v_mfma_f32_16x16x32_bf16 v[204:207], v[80:83], v[124:127], v[204:207]
    s_barrier
    s_waitcnt lgkmcnt(6)
    v_mfma_f32_16x16x32_bf16 v[136:139], v[84:87], v[128:131], v[136:139]
    ds_read_b64_tr_b16 v[120:121], v10 offset:0
    v_mfma_f32_16x16x32_bf16 v[140:143], v[84:87], v[132:135], v[140:143]
    ds_read_b64_tr_b16 v[122:123], v10 offset:4096
    v_mfma_f32_16x16x32_bf16 v[144:147], v[88:91], v[128:131], v[144:147]
    ds_read_b64_tr_b16 v[124:125], v11 offset:0
    v_mfma_f32_16x16x32_bf16 v[148:151], v[88:91], v[132:135], v[148:151]
    ds_read_b64_tr_b16 v[126:127], v11 offset:4096
    v_mfma_f32_16x16x32_bf16 v[152:155], v[92:95], v[128:131], v[152:155]
    ds_read_b128 v[48:51], v18 offset:0
    v_mfma_f32_16x16x32_bf16 v[156:159], v[92:95], v[132:135], v[156:159]
    s_waitcnt lgkmcnt(8)
    v_mfma_f32_16x16x32_bf16 v[160:163], v[96:99], v[128:131], v[160:163]
    ds_read_b128 v[52:55], v18 offset:1024
    v_mfma_f32_16x16x32_bf16 v[164:167], v[96:99], v[132:135], v[164:167]
    ds_read_b128 v[56:59], v18 offset:2048
    v_mfma_f32_16x16x32_bf16 v[168:171], v[100:103], v[128:131], v[168:171]
    ds_read_b128 v[60:63], v18 offset:3072
    v_mfma_f32_16x16x32_bf16 v[172:175], v[100:103], v[132:135], v[172:175]
    ds_read_b128 v[64:67], v18 offset:4096
    v_mfma_f32_16x16x32_bf16 v[176:179], v[104:107], v[128:131], v[176:179]
    ds_read_b128 v[68:71], v18 offset:5120
    v_mfma_f32_16x16x32_bf16 v[180:183], v[104:107], v[132:135], v[180:183]
    s_waitcnt lgkmcnt(10)
    v_mfma_f32_16x16x32_bf16 v[184:187], v[108:111], v[128:131], v[184:187]
    ds_read_b128 v[72:75], v18 offset:6144
    v_mfma_f32_16x16x32_bf16 v[188:191], v[108:111], v[132:135], v[188:191]
    ds_read_b128 v[76:79], v18 offset:7168
    v_mfma_f32_16x16x32_bf16 v[192:195], v[112:115], v[128:131], v[192:195]
    ds_read_b128 v[80:83], v18 offset:8192
    v_mfma_f32_16x16x32_bf16 v[196:199], v[112:115], v[132:135], v[196:199]
    v_mfma_f32_16x16x32_bf16 v[200:203], v[116:119], v[128:131], v[200:203]
    v_mfma_f32_16x16x32_bf16 v[204:207], v[116:119], v[132:135], v[204:207]
    s_sub_u32 s36, s36, 1
    s_cmp_lg_u32 s36, 0
    s_cbranch_scc1 CL_m_92
    s_waitcnt lgkmcnt(6)
    v_mfma_f32_16x16x32_bf16 v[136:139], v[48:51], v[120:123], v[136:139]
    ds_read_b64_tr_b16 v[128:129], v10 offset:8192
    v_mfma_f32_16x16x32_bf16 v[140:143], v[48:51], v[124:127], v[140:143]
    ds_read_b64_tr_b16 v[130:131], v10 offset:12288
    v_mfma_f32_16x16x32_bf16 v[144:147], v[52:55], v[120:123], v[144:147]
    ds_read_b64_tr_b16 v[132:133], v11 offset:8192
    v_mfma_f32_16x16x32_bf16 v[148:151], v[52:55], v[124:127], v[148:151]
    ds_read_b64_tr_b16 v[134:135], v11 offset:12288
    v_mfma_f32_16x16x32_bf16 v[152:155], v[56:59], v[120:123], v[152:155]
    ds_read_b128 v[84:87], v18 offset:9216
    v_mfma_f32_16x16x32_bf16 v[156:159], v[56:59], v[124:127], v[156:159]
    s_waitcnt lgkmcnt(8)
    v_mfma_f32_16x16x32_bf16 v[160:163], v[60:63], v[120:123], v[160:163]
    ds_read_b128 v[88:91], v18 offset:10240
    v_mfma_f32_16x16x32_bf16 v[164:167], v[60:63], v[124:127], v[164:167]
    ds_read_b128 v[92:95], v18 offset:11264
    v_mfma_f32_16x16x32_bf16 v[168:171], v[64:67], v[120:123], v[168:171]
    ds_read_b128 v[96:99], v18 offset:12288
    v_mfma_f32_16x16x32_bf16 v[172:175], v[64:67], v[124:127], v[172:175]
    ds_read_b128 v[100:103], v18 offset:13312
    v_mfma_f32_16x16x32_bf16 v[176:179], v[68:71], v[120:123], v[176:179]
    ds_read_b128 v[104:107], v18 offset:14336
    v_mfma_f32_16x16x32_bf16 v[180:183], v[68:71], v[124:127], v[180:183]
    s_waitcnt lgkmcnt(10)
    v_mfma_f32_16x16x32_bf16 v[184:187], v[72:75], v[120:123], v[184:187]
    ds_read_b128 v[108:111], v18 offset:15360
    v_mfma_f32_16x16x32_bf16 v[188:191], v[72:75], v[124:127], v[188:191]
    ds_read_b128 v[112:115], v18 offset:16384
    v_mfma_f32_16x16x32_bf16 v[192:195], v[76:79], v[120:123], v[192:195]
    ds_read_b128 v[116:119], v18 offset:17408
    v_mfma_f32_16x16x32_bf16 v[196:199], v[76:79], v[124:127], v[196:199]
    v_mfma_f32_16x16x32_bf16 v[200:203], v[80:83], v[120:123], v[200:203]
    v_mfma_f32_16x16x32_bf16 v[204:207], v[80:83], v[124:127], v[204:207]
    s_barrier
    s_waitcnt lgkmcnt(6)
    v_mfma_f32_16x16x32_bf16 v[136:139], v[84:87], v[128:131], v[136:139]
    ds_read_b64_tr_b16 v[120:121], v12 offset:0
    v_mfma_f32_16x16x32_bf16 v[140:143], v[84:87], v[132:135], v[140:143]
    ds_read_b64_tr_b16 v[122:123], v12 offset:4096
    v_mfma_f32_16x16x32_bf16 v[144:147], v[88:91], v[128:131], v[144:147]
    ds_read_b64_tr_b16 v[124:125], v13 offset:0
    v_mfma_f32_16x16x32_bf16 v[148:151], v[88:91], v[132:135], v[148:151]
    ds_read_b64_tr_b16 v[126:127], v13 offset:4096
    v_mfma_f32_16x16x32_bf16 v[152:155], v[92:95], v[128:131], v[152:155]
    ds_read_b128 v[48:51], v19 offset:0
    v_mfma_f32_16x16x32_bf16 v[156:159], v[92:95], v[132:135], v[156:159]
    s_waitcnt lgkmcnt(8)
    v_mfma_f32_16x16x32_bf16 v[160:163], v[96:99], v[128:131], v[160:163]
    ds_read_b128 v[52:55], v19 offset:1024
    v_mfma_f32_16x16x32_bf16 v[164:167], v[96:99], v[132:135], v[164:167]
    ds_read_b128 v[56:59], v19 offset:2048
    v_mfma_f32_16x16x32_bf16 v[168:171], v[100:103], v[128:131], v[168:171]
    ds_read_b128 v[60:63], v19 offset:3072
    v_mfma_f32_16x16x32_bf16 v[172:175], v[100:103], v[132:135], v[172:175]
    ds_read_b128 v[64:67], v19 offset:4096
    v_mfma_f32_16x16x32_bf16 v[176:179], v[104:107], v[128:131], v[176:179]
    ds_read_b128 v[68:71], v19 offset:5120
    v_mfma_f32_16x16x32_bf16 v[180:183], v[104:107], v[132:135], v[180:183]
    s_waitcnt lgkmcnt(10)
    v_mfma_f32_16x16x32_bf16 v[184:187], v[108:111], v[128:131], v[184:187]
    ds_read_b128 v[72:75], v19 offset:6144
    v_mfma_f32_16x16x32_bf16 v[188:191], v[108:111], v[132:135], v[188:191]
    ds_read_b128 v[76:79], v19 offset:7168
    v_mfma_f32_16x16x32_bf16 v[192:195], v[112:115], v[128:131], v[192:195]
    ds_read_b128 v[80:83], v19 offset:8192
    v_mfma_f32_16x16x32_bf16 v[196:199], v[112:115], v[132:135], v[196:199]
    v_mfma_f32_16x16x32_bf16 v[200:203], v[116:119], v[128:131], v[200:203]
    v_mfma_f32_16x16x32_bf16 v[204:207], v[116:119], v[132:135], v[204:207]
    s_waitcnt lgkmcnt(6)
    v_mfma_f32_16x16x32_bf16 v[136:139], v[48:51], v[120:123], v[136:139]
    ds_read_b64_tr_b16 v[128:129], v12 offset:8192
    v_mfma_f32_16x16x32_bf16 v[140:143], v[48:51], v[124:127], v[140:143]
    ds_read_b64_tr_b16 v[130:131], v12 offset:12288
    v_mfma_f32_16x16x32_bf16 v[144:147], v[52:55], v[120:123], v[144:147]
    ds_read_b64_tr_b16 v[132:133], v13 offset:8192
    v_mfma_f32_16x16x32_bf16 v[148:151], v[52:55], v[124:127], v[148:151]
    ds_read_b64_tr_b16 v[134:135], v13 offset:12288
    v_mfma_f32_16x16x32_bf16 v[152:155], v[56:59], v[120:123], v[152:155]
    ds_read_b128 v[84:87], v19 offset:9216
    v_mfma_f32_16x16x32_bf16 v[156:159], v[56:59], v[124:127], v[156:159]
    s_waitcnt lgkmcnt(8)
    v_mfma_f32_16x16x32_bf16 v[160:163], v[60:63], v[120:123], v[160:163]
    ds_read_b128 v[88:91], v19 offset:10240
    v_mfma_f32_16x16x32_bf16 v[164:167], v[60:63], v[124:127], v[164:167]
    ds_read_b128 v[92:95], v19 offset:11264
    v_mfma_f32_16x16x32_bf16 v[168:171], v[64:67], v[120:123], v[168:171]
    ds_read_b128 v[96:99], v19 offset:12288
    v_mfma_f32_16x16x32_bf16 v[172:175], v[64:67], v[124:127], v[172:175]
    ds_read_b128 v[100:103], v19 offset:13312
    v_mfma_f32_16x16x32_bf16 v[176:179], v[68:71], v[120:123], v[176:179]
    ds_read_b128 v[104:107], v19 offset:14336
    v_mfma_f32_16x16x32_bf16 v[180:183], v[68:71], v[124:127], v[180:183]
    s_waitcnt lgkmcnt(10)
    v_mfma_f32_16x16x32_bf16 v[184:187], v[72:75], v[120:123], v[184:187]
    ds_read_b128 v[108:111], v19 offset:15360
    v_mfma_f32_16x16x32_bf16 v[188:191], v[72:75], v[124:127], v[188:191]
    ds_read_b128 v[112:115], v19 offset:16384
    v_mfma_f32_16x16x32_bf16 v[192:195], v[76:79], v[120:123], v[192:195]
    ds_read_b128 v[116:119], v19 offset:17408
    v_mfma_f32_16x16x32_bf16 v[196:199], v[76:79], v[124:127], v[196:199]
    v_mfma_f32_16x16x32_bf16 v[200:203], v[80:83], v[120:123], v[200:203]
    v_mfma_f32_16x16x32_bf16 v[204:207], v[80:83], v[124:127], v[204:207]
    s_waitcnt lgkmcnt(6)
    v_mfma_f32_16x16x32_bf16 v[136:139], v[84:87], v[128:131], v[136:139]
    v_mfma_f32_16x16x32_bf16 v[140:143], v[84:87], v[132:135], v[140:143]
    v_mfma_f32_16x16x32_bf16 v[144:147], v[88:91], v[128:131], v[144:147]
    v_mfma_f32_16x16x32_bf16 v[148:151], v[88:91], v[132:135], v[148:151]
    v_mfma_f32_16x16x32_bf16 v[152:155], v[92:95], v[128:131], v[152:155]
    v_mfma_f32_16x16x32_bf16 v[156:159], v[92:95], v[132:135], v[156:159]
    s_waitcnt lgkmcnt(3)
    v_mfma_f32_16x16x32_bf16 v[160:163], v[96:99], v[128:131], v[160:163]
    v_mfma_f32_16x16x32_bf16 v[164:167], v[96:99], v[132:135], v[164:167]
    v_mfma_f32_16x16x32_bf16 v[168:171], v[100:103], v[128:131], v[168:171]
    v_mfma_f32_16x16x32_bf16 v[172:175], v[100:103], v[132:135], v[172:175]
    v_mfma_f32_16x16x32_bf16 v[176:179], v[104:107], v[128:131], v[176:179]
    v_mfma_f32_16x16x32_bf16 v[180:183], v[104:107], v[132:135], v[180:183]
    s_waitcnt lgkmcnt(0)
    v_mfma_f32_16x16x32_bf16 v[184:187], v[108:111], v[128:131], v[184:187]
    v_mfma_f32_16x16x32_bf16 v[188:191], v[108:111], v[132:135], v[188:191]
    v_mfma_f32_16x16x32_bf16 v[192:195], v[112:115], v[128:131], v[192:195]
    v_mfma_f32_16x16x32_bf16 v[196:199], v[112:115], v[132:135], v[196:199]
    v_mfma_f32_16x16x32_bf16 v[200:203], v[116:119], v[128:131], v[200:203]
    v_mfma_f32_16x16x32_bf16 v[204:207], v[116:119], v[132:135], v[204:207]
    v_lshlrev_b32 v10, 4, v1
    v_lshlrev_b32 v11, 3, v1
    v_mov_b32 v12, 0
    v_mov_b32 v7, 1
    s_waitcnt vmcnt(0)
    s_cmp_ge_u32 s26, 2
    s_cbranch_scc1 A1_m_93
    v_cvt_pk_bf16_f32 v48, v176, v177
    v_cvt_pk_bf16_f32 v49, v178, v179
    v_cvt_pk_bf16_f32 v50, v184, v185
    v_cvt_pk_bf16_f32 v51, v186, v187
    buffer_store_dwordx4 v[48:51], v10, s[20:23], s46 offen offset:0 sc0 sc1
    v_cvt_pk_bf16_f32 v52, v192, v193
    v_cvt_pk_bf16_f32 v53, v194, v195
    v_cvt_pk_bf16_f32 v54, v200, v201
    v_cvt_pk_bf16_f32 v55, v202, v203
    buffer_store_dwordx4 v[52:55], v10, s[20:23], s46 offen offset:1024 sc0 sc1
    v_cvt_pk_bf16_f32 v56, v180, v181
    v_cvt_pk_bf16_f32 v57, v182, v183
    v_cvt_pk_bf16_f32 v58, v188, v189
    v_cvt_pk_bf16_f32 v59, v190, v191
    buffer_store_dwordx4 v[56:59], v10, s[20:23], s47 offen offset:0 sc0 sc1
    v_cvt_pk_bf16_f32 v60, v196, v197
    v_cvt_pk_bf16_f32 v61, v198, v199
    v_cvt_pk_bf16_f32 v62, v204, v205
    v_cvt_pk_bf16_f32 v63, v206, v207
    buffer_store_dwordx4 v[60:63], v10, s[20:23], s47 offen offset:1024 sc0 sc1
    v_cvt_pk_bf16_f32 v64, v140, v141
    v_cvt_pk_bf16_f32 v65, v142, v143
    v_cvt_pk_bf16_f32 v66, v148, v149
    v_cvt_pk_bf16_f32 v67, v150, v151
    buffer_store_dwordx4 v[64:67], v10, s[20:23], s45 offen offset:0 sc0 sc1
    v_cvt_pk_bf16_f32 v68, v156, v157
    v_cvt_pk_bf16_f32 v69, v158, v159
    v_cvt_pk_bf16_f32 v70, v164, v165
    v_cvt_pk_bf16_f32 v71, v166, v167
    buffer_store_dwordx4 v[68:71], v10, s[20:23], s45 offen offset:1024 sc0 sc1
    v_cvt_pk_bf16_f32 v72, v172, v173
    v_cvt_pk_bf16_f32 v73, v174, v175
    buffer_store_dwordx2 v[72:73], v11, s[20:23], s45 offen offset:2048 sc0 sc1
    v_mfma_f32_16x16x32_bf16 v[136:139], v[28:31], v[24:27], v[136:139]
    v_mfma_f32_16x16x32_bf16 v[144:147], v[32:35], v[24:27], v[144:147]
    v_mfma_f32_16x16x32_bf16 v[152:155], v[36:39], v[24:27], v[152:155]
    v_mfma_f32_16x16x32_bf16 v[160:163], v[40:43], v[24:27], v[160:163]
    v_mfma_f32_16x16x32_bf16 v[168:171], v[44:47], v[24:27], v[168:171]
    v_lshlrev_b32 v22, 16, v22
    v_mul_u32_u24 v13, 1152, v4
    v_lshl_add_u32 v13, v3, 3, v13
    s_add_u32 s30, s33, 10240
    s_add_u32 s31, s33, 20480
    s_waitcnt vmcnt(0)
    s_mov_b64 exec, 1
    buffer_store_dword v7, v12, s[20:23], s34 offen sc0 sc1
    s_mov_b64 exec, -1
    s_waitcnt vmcnt(0)
    v_pk_add_f32 v[136:137], v[136:137], v[22:23] op_sel:[0,0] op_sel_hi:[1,0]
    v_pk_add_f32 v[138:139], v[138:139], v[22:23] op_sel:[0,0] op_sel_hi:[1,0]
    v_pk_add_f32 v[144:145], v[144:145], v[22:23] op_sel:[0,0] op_sel_hi:[1,0]
    v_pk_add_f32 v[146:147], v[146:147], v[22:23] op_sel:[0,0] op_sel_hi:[1,0]
    v_pk_add_f32 v[152:153], v[152:153], v[22:23] op_sel:[0,0] op_sel_hi:[1,0]
    v_pk_add_f32 v[154:155], v[154:155], v[22:23] op_sel:[0,0] op_sel_hi:[1,0]
    v_pk_add_f32 v[160:161], v[160:161], v[22:23] op_sel:[0,0] op_sel_hi:[1,0]
    v_pk_add_f32 v[162:163], v[162:163], v[22:23] op_sel:[0,0] op_sel_hi:[1,0]
    v_pk_add_f32 v[168:169], v[168:169], v[22:23] op_sel:[0,0] op_sel_hi:[1,0]
    v_pk_add_f32 v[170:171], v[170:171], v[22:23] op_sel:[0,0] op_sel_hi:[1,0]
    v_lshlrev_b32 v5, 7, v1
    s_mov_b64 exec, 0xf
    s_mov_b32 s37, 0x40000
POLL_m_94:
    buffer_load_dword v28, v5, s[20:23], s35 offen sc0 sc1
    s_waitcnt vmcnt(0)
    v_cmp_eq_u32 vcc, 0, v28
    s_sub_u32 s37, s37, 1
    s_cmp_eq_u32 s37, 0
    s_cbranch_scc1 GO_m_95
    s_cbranch_vccz GO_m_95
    s_sleep 1
    s_branch POLL_m_94
GO_m_95:
    s_mov_b64 exec, -1
    buffer_load_dwordx4 v[88:91], v10, s[20:23], s33 offen offset:0 sc0 sc1
    buffer_load_dwordx4 v[92:95], v10, s[20:23], s30 offen offset:0 sc0 sc1
    buffer_load_dwordx4 v[96:99], v10, s[20:23], s31 offen offset:0 sc0 sc1
    buffer_load_dwordx4 v[100:103], v10, s[20:23], s33 offen offset:1024 sc0 sc1
    buffer_load_dwordx4 v[104:107], v10, s[20:23], s30 offen offset:1024 sc0 sc1
    buffer_load_dwordx4 v[108:111], v10, s[20:23], s31 offen offset:1024 sc0 sc1
    buffer_load_dwordx2 v[112:113], v11, s[20:23], s33 offen offset:2048 sc0 sc1
    buffer_load_dwordx2 v[116:117], v11, s[20:23], s30 offen offset:2048 sc0 sc1
    buffer_load_dwordx2 v[120:121], v11, s[20:23], s31 offen offset:2048 sc0 sc1
    s_mul_i32 s30, s28, 2816
    s_add_u32 s30, s30, 104448
    v_mul_u32_u24 v13, 176, v4
    v_lshl_add_u32 v13, v3, 3, v13
    v_add_u32 v13, s30, v13
    v_add_u32 v5, 0, v1
    v_mul_u32_u24 v6, 6554, v5
    v_lshrrev_b32 v6, 16, v6
    v_mul_u32_u24 v7, 10, v6
    v_sub_u32 v5, v5, v7
    v_lshlrev_b32 v5, 4, v5
    v_mul_u32_u24 v7, 176, v6
    v_add3_u32 v28, v7, v5, s30
    v_mul_u32_u24 v7, 1152, v6
    v_add_u32 v32, v7, v5
    v_add_u32 v5, 64, v1
    v_mul_u32_u24 v6, 6554, v5
    v_lshrrev_b32 v6, 16, v6
    v_mul_u32_u24 v7, 10, v6
    v_sub_u32 v5, v5, v7
    v_lshlrev_b32 v5, 4, v5
    v_mul_u32_u24 v7, 176, v6
    v_add3_u32 v29, v7, v5, s30
    v_mul_u32_u24 v7, 1152, v6
    v_add_u32 v33, v7, v5
    v_add_u32 v5, 128, v1
    v_mul_u32_u24 v6, 6554, v5
    v_lshrrev_b32 v6, 16, v6
    v_mul_u32_u24 v7, 10, v6
    v_sub_u32 v5, v5, v7
    v_lshlrev_b32 v5, 4, v5
    v_mul_u32_u24 v7, 176, v6
    v_add3_u32 v30, v7, v5, s30
    v_mul_u32_u24 v7, 1152, v6
    v_add_u32 v34, v7, v5
    s_waitcnt vmcnt(6)
    v_lshlrev_b32 v48, 16, v88
    v_and_b32 v49, 0xffff0000, v88
    v_lshlrev_b32 v50, 16, v89
    v_and_b32 v51, 0xffff0000, v89
    v_lshlrev_b32 v52, 16, v92
    v_and_b32 v53, 0xffff0000, v92
    v_lshlrev_b32 v54, 16, v93
    v_and_b32 v55, 0xffff0000, v93
    v_lshlrev_b32 v56, 16, v96
    v_and_b32 v57, 0xffff0000, v96
    v_lshlrev_b32 v58, 16, v97
    v_and_b32 v59, 0xffff0000, v97
    v_pk_add_f32 v[136:137], v[136:137], v[48:49]
    v_pk_add_f32 v[138:139], v[138:139], v[50:51]
    v_pk_add_f32 v[136:137], v[136:137], v[52:53]
    v_pk_add_f32 v[138:139], v[138:139], v[54:55]
    v_pk_add_f32 v[136:137], v[136:137], v[56:57]
    v_pk_add_f32 v[138:139], v[138:139], v[58:59]
    v_cvt_pk_bf16_f32 v136, v136, v137
    v_cvt_pk_bf16_f32 v137, v138, v139
    ds_write_b64 v13, v[136:137] offset:0
    v_lshlrev_b32 v48, 16, v90
    v_and_b32 v49, 0xffff0000, v90
    v_lshlrev_b32 v50, 16, v91
    v_and_b32 v51, 0xffff0000, v91
    v_lshlrev_b32 v52, 16, v94
    v_and_b32 v53, 0xffff0000, v94
    v_lshlrev_b32 v54, 16, v95
    v_and_b32 v55, 0xffff0000, v95
    v_lshlrev_b32 v56, 16, v98
    v_and_b32 v57, 0xffff0000, v98
    v_lshlrev_b32 v58, 16, v99
    v_and_b32 v59, 0xffff0000, v99
    v_pk_add_f32 v[144:145], v[144:145], v[48:49]
    v_pk_add_f32 v[146:147], v[146:147], v[50:51]
    v_pk_add_f32 v[144:145], v[144:145], v[52:53]
    v_pk_add_f32 v[146:147], v[146:147], v[54:55]
    v_pk_add_f32 v[144:145], v[144:145], v[56:57]
    v_pk_add_f32 v[146:147], v[146:147], v[58:59]
    v_cvt_pk_bf16_f32 v144, v144, v145
    v_cvt_pk_bf16_f32 v145, v146, v147
    ds_write_b64 v13, v[144:145] offset:32
    s_waitcnt vmcnt(3)
    v_lshlrev_b32 v48, 16, v100
    v_and_b32 v49, 0xffff0000, v100
    v_lshlrev_b32 v50, 16, v101
    v_and_b32 v51, 0xffff0000, v101
    v_lshlrev_b32 v52, 16, v104
    v_and_b32 v53, 0xffff0000, v104
    v_lshlrev_b32 v54, 16, v105
    v_and_b32 v55, 0xffff0000, v105
    v_lshlrev_b32 v56, 16, v108
    v_and_b32 v57, 0xffff0000, v108
    v_lshlrev_b32 v58, 16, v109
    v_and_b32 v59, 0xffff0000, v109
    v_pk_add_f32 v[152:153], v[152:153], v[48:49]
    v_pk_add_f32 v[154:155], v[154:155], v[50:51]
    v_pk_add_f32 v[152:153], v[152:153], v[52:53]
    v_pk_add_f32 v[154:155], v[154:155], v[54:55]
    v_pk_add_f32 v[152:153], v[152:153], v[56:57]
    v_pk_add_f32 v[154:155], v[154:155], v[58:59]
    v_cvt_pk_bf16_f32 v152, v152, v153
    v_cvt_pk_bf16_f32 v153, v154, v155
    ds_write_b64 v13, v[152:153] offset:64
    v_lshlrev_b32 v48, 16, v102
    v_and_b32 v49, 0xffff0000, v102
    v_lshlrev_b32 v50, 16, v103
    v_and_b32 v51, 0xffff0000, v103
    v_lshlrev_b32 v52, 16, v106
    v_and_b32 v53, 0xffff0000, v106
    v_lshlrev_b32 v54, 16, v107
    v_and_b32 v55, 0xffff0000, v107
    v_lshlrev_b32 v56, 16, v110
    v_and_b32 v57, 0xffff0000, v110
    v_lshlrev_b32 v58, 16, v111
    v_and_b32 v59, 0xffff0000, v111
    v_pk_add_f32 v[160:161], v[160:161], v[48:49]
    v_pk_add_f32 v[162:163], v[162:163], v[50:51]
    v_pk_add_f32 v[160:161], v[160:161], v[52:53]
    v_pk_add_f32 v[162:163], v[162:163], v[54:55]
    v_pk_add_f32 v[160:161], v[160:161], v[56:57]
    v_pk_add_f32 v[162:163], v[162:163], v[58:59]
    v_cvt_pk_bf16_f32 v160, v160, v161
    v_cvt_pk_bf16_f32 v161, v162, v163
    ds_write_b64 v13, v[160:161] offset:96
    s_waitcnt vmcnt(0)
    v_lshlrev_b32 v48, 16, v112
    v_and_b32 v49, 0xffff0000, v112
    v_lshlrev_b32 v50, 16, v113
    v_and_b32 v51, 0xffff0000, v113
    v_lshlrev_b32 v52, 16, v116
    v_and_b32 v53, 0xffff0000, v116
    v_lshlrev_b32 v54, 16, v117
    v_and_b32 v55, 0xffff0000, v117
    v_lshlrev_b32 v56, 16, v120
    v_and_b32 v57, 0xffff0000, v120
    v_lshlrev_b32 v58, 16, v121
    v_and_b32 v59, 0xffff0000, v121
    v_pk_add_f32 v[168:169], v[168:169], v[48:49]
    v_pk_add_f32 v[170:171], v[170:171], v[50:51]
    v_pk_add_f32 v[168:169], v[168:169], v[52:53]
    v_pk_add_f32 v[170:171], v[170:171], v[54:55]
    v_pk_add_f32 v[168:169], v[168:169], v[56:57]
    v_pk_add_f32 v[170:171], v[170:171], v[58:59]
    v_cvt_pk_bf16_f32 v168, v168, v169
    v_cvt_pk_bf16_f32 v169, v170, v171
    ds_write_b64 v13, v[168:169] offset:128
    s_waitcnt lgkmcnt(0)
    ds_read_b128 v[64:67], v28
    ds_read_b128 v[68:71], v29
    ds_read_b128 v[72:75], v30
    s_waitcnt lgkmcnt(2)
    buffer_store_dwordx4 v[64:67], v32, s[40:43], s48 offen offset:0 nt
    s_waitcnt lgkmcnt(1)
    buffer_store_dwordx4 v[68:71], v33, s[40:43], s48 offen offset:0 nt
    s_waitcnt lgkmcnt(0)
    s_mov_b32 exec_hi, 0
    buffer_store_dwordx4 v[72:75], v34, s[40:43], s48 offen offset:0 nt
    s_endpgm
A1_m_93:
    v_cvt_pk_bf16_f32 v48, v136, v137
    v_cvt_pk_bf16_f32 v49, v138, v139
    v_cvt_pk_bf16_f32 v50, v144, v145
    v_cvt_pk_bf16_f32 v51, v146, v147
    buffer_store_dwordx4 v[48:51], v10, s[20:23], s46 offen offset:0 sc0 sc1
    v_cvt_pk_bf16_f32 v52, v152, v153
    v_cvt_pk_bf16_f32 v53, v154, v155
    v_cvt_pk_bf16_f32 v54, v160, v161
    v_cvt_pk_bf16_f32 v55, v162, v163
    buffer_store_dwordx4 v[52:55], v10, s[20:23], s46 offen offset:1024 sc0 sc1
    v_cvt_pk_bf16_f32 v56, v168, v169
    v_cvt_pk_bf16_f32 v57, v170, v171
    buffer_store_dwordx2 v[56:57], v11, s[20:23], s46 offen offset:2048 sc0 sc1
    v_cvt_pk_bf16_f32 v60, v140, v141
    v_cvt_pk_bf16_f32 v61, v142, v143
    v_cvt_pk_bf16_f32 v62, v148, v149
    v_cvt_pk_bf16_f32 v63, v150, v151
    buffer_store_dwordx4 v[60:63], v10, s[20:23], s47 offen offset:0 sc0 sc1
    v_cvt_pk_bf16_f32 v64, v156, v157
    v_cvt_pk_bf16_f32 v65, v158, v159
    v_cvt_pk_bf16_f32 v66, v164, v165
    v_cvt_pk_bf16_f32 v67, v166, v167
    buffer_store_dwordx4 v[64:67], v10, s[20:23], s47 offen offset:1024 sc0 sc1
    v_cvt_pk_bf16_f32 v68, v172, v173
    v_cvt_pk_bf16_f32 v69, v174, v175
    buffer_store_dwordx2 v[68:69], v11, s[20:23], s47 offen offset:2048 sc0 sc1
    v_cvt_pk_bf16_f32 v72, v180, v181
    v_cvt_pk_bf16_f32 v73, v182, v183
    v_cvt_pk_bf16_f32 v74, v188, v189
    v_cvt_pk_bf16_f32 v75, v190, v191
    buffer_store_dwordx4 v[72:75], v10, s[20:23], s45 offen offset:0 sc0 sc1
    v_cvt_pk_bf16_f32 v76, v196, v197
    v_cvt_pk_bf16_f32 v77, v198, v199
    v_cvt_pk_bf16_f32 v78, v204, v205
    v_cvt_pk_bf16_f32 v79, v206, v207
    buffer_store_dwordx4 v[76:79], v10, s[20:23], s45 offen offset:1024 sc0 sc1
    v_mfma_f32_16x16x32_bf16 v[176:179], v[28:31], v[24:27], v[176:179]
    v_mfma_f32_16x16x32_bf16 v[184:187], v[32:35], v[24:27], v[184:187]
    v_mfma_f32_16x16x32_bf16 v[192:195], v[36:39], v[24:27], v[192:195]
    v_mfma_f32_16x16x32_bf16 v[200:203], v[40:43], v[24:27], v[200:203]
    v_lshlrev_b32 v22, 16, v22
    v_mul_u32_u24 v13, 1152, v4
    v_lshl_add_u32 v13, v3, 3, v13
    s_add_u32 s30, s33, 10240
    s_add_u32 s31, s33, 20480
    s_waitcnt vmcnt(0)
    s_mov_b64 exec, 1
    buffer_store_dword v7, v12, s[20:23], s34 offen sc0 sc1
    s_mov_b64 exec, -1
    s_waitcnt vmcnt(0)
    v_pk_add_f32 v[176:177], v[176:177], v[22:23] op_sel:[0,0] op_sel_hi:[1,0]
    v_pk_add_f32 v[178:179], v[178:179], v[22:23] op_sel:[0,0] op_sel_hi:[1,0]
    v_pk_add_f32 v[184:185], v[184:185], v[22:23] op_sel:[0,0] op_sel_hi:[1,0]
    v_pk_add_f32 v[186:187], v[186:187], v[22:23] op_sel:[0,0] op_sel_hi:[1,0]
    v_pk_add_f32 v[192:193], v[192:193], v[22:23] op_sel:[0,0] op_sel_hi:[1,0]
    v_pk_add_f32 v[194:195], v[194:195], v[22:23] op_sel:[0,0] op_sel_hi:[1,0]
    v_pk_add_f32 v[200:201], v[200:201], v[22:23] op_sel:[0,0] op_sel_hi:[1,0]
    v_pk_add_f32 v[202:203], v[202:203], v[22:23] op_sel:[0,0] op_sel_hi:[1,0]
    v_lshlrev_b32 v5, 7, v1
    s_mov_b64 exec, 0xf
    s_mov_b32 s37, 0x40000
POLL_m_96:
    buffer_load_dword v28, v5, s[20:23], s35 offen sc0 sc1
    s_waitcnt vmcnt(0)
    v_cmp_eq_u32 vcc, 0, v28
    s_sub_u32 s37, s37, 1
    s_cmp_eq_u32 s37, 0
    s_cbranch_scc1 GO_m_97
    s_cbranch_vccz GO_m_97
    s_sleep 1
    s_branch POLL_m_96
GO_m_97:
    s_mov_b64 exec, -1
    buffer_load_dwordx4 v[88:91], v10, s[20:23], s33 offen offset:0 sc0 sc1
    buffer_load_dwordx4 v[92:95], v10, s[20:23], s30 offen offset:0 sc0 sc1
    buffer_load_dwordx4 v[96:99], v10, s[20:23], s31 offen offset:0 sc0 sc1
    buffer_load_dwordx4 v[100:103], v10, s[20:23], s33 offen offset:1024 sc0 sc1
    buffer_load_dwordx4 v[104:107], v10, s[20:23], s30 offen offset:1024 sc0 sc1
    buffer_load_dwordx4 v[108:111], v10, s[20:23], s31 offen offset:1024 sc0 sc1
    s_mul_i32 s30, s28, 2816
    s_add_u32 s30, s30, 104448
    v_mul_u32_u24 v13, 176, v4
    v_lshl_add_u32 v13, v3, 3, v13
    v_add_u32 v13, s30, v13
    v_add_u32 v5, 0, v1
    v_mul_u32_u24 v6, 8192, v5
    v_lshrrev_b32 v6, 16, v6
    v_mul_u32_u24 v7, 8, v6
    v_sub_u32 v5, v5, v7
    v_lshlrev_b32 v5, 4, v5
    v_mul_u32_u24 v7, 176, v6
    v_add3_u32 v28, v7, v5, s30
    v_mul_u32_u24 v7, 1152, v6
    v_add_u32 v32, v7, v5
    v_add_u32 v5, 64, v1
    v_mul_u32_u24 v6, 8192, v5
    v_lshrrev_b32 v6, 16, v6
    v_mul_u32_u24 v7, 8, v6
    v_sub_u32 v5, v5, v7
    v_lshlrev_b32 v5, 4, v5
    v_mul_u32_u24 v7, 176, v6
    v_add3_u32 v29, v7, v5, s30
    v_mul_u32_u24 v7, 1152, v6
    v_add_u32 v33, v7, v5
    s_waitcnt vmcnt(3)
    v_lshlrev_b32 v48, 16, v88
    v_and_b32 v49, 0xffff0000, v88
    v_lshlrev_b32 v50, 16, v89
    v_and_b32 v51, 0xffff0000, v89
    v_lshlrev_b32 v52, 16, v92
    v_and_b32 v53, 0xffff0000, v92
    v_lshlrev_b32 v54, 16, v93
    v_and_b32 v55, 0xffff0000, v93
    v_lshlrev_b32 v56, 16, v96
    v_and_b32 v57, 0xffff0000, v96
    v_lshlrev_b32 v58, 16, v97
    v_and_b32 v59, 0xffff0000, v97
    v_pk_add_f32 v[176:177], v[176:177], v[48:49]
    v_pk_add_f32 v[178:179], v[178:179], v[50:51]
    v_pk_add_f32 v[176:177], v[176:177], v[52:53]
    v_pk_add_f32 v[178:179], v[178:179], v[54:55]
    v_pk_add_f32 v[176:177], v[176:177], v[56:57]
    v_pk_add_f32 v[178:179], v[178:179], v[58:59]
    v_cvt_pk_bf16_f32 v176, v176, v177
    v_cvt_pk_bf16_f32 v177, v178, v179
    ds_write_b64 v13, v[176:177] offset:0
    v_lshlrev_b32 v48, 16, v90
    v_and_b32 v49, 0xffff0000, v90
    v_lshlrev_b32 v50, 16, v91
    v_and_b32 v51, 0xffff0000, v91
    v_lshlrev_b32 v52, 16, v94
    v_and_b32 v53, 0xffff0000, v94
    v_lshlrev_b32 v54, 16, v95
    v_and_b32 v55, 0xffff0000, v95
    v_lshlrev_b32 v56, 16, v98
    v_and_b32 v57, 0xffff0000, v98
    v_lshlrev_b32 v58, 16, v99
    v_and_b32 v59, 0xffff0000, v99
    v_pk_add_f32 v[184:185], v[184:185], v[48:49]
    v_pk_add_f32 v[186:187], v[186:187], v[50:51]
    v_pk_add_f32 v[184:185], v[184:185], v[52:53]
    v_pk_add_f32 v[186:187], v[186:187], v[54:55]
    v_pk_add_f32 v[184:185], v[184:185], v[56:57]
    v_pk_add_f32 v[186:187], v[186:187], v[58:59]
    v_cvt_pk_bf16_f32 v184, v184, v185
    v_cvt_pk_bf16_f32 v185, v186, v187
    ds_write_b64 v13, v[184:185] offset:32
    s_waitcnt vmcnt(0)
    v_lshlrev_b32 v48, 16, v100
    v_and_b32 v49, 0xffff0000, v100
    v_lshlrev_b32 v50, 16, v101
    v_and_b32 v51, 0xffff0000, v101
    v_lshlrev_b32 v52, 16, v104
    v_and_b32 v53, 0xffff0000, v104
    v_lshlrev_b32 v54, 16, v105
    v_and_b32 v55, 0xffff0000, v105
    v_lshlrev_b32 v56, 16, v108
    v_and_b32 v57, 0xffff0000, v108
    v_lshlrev_b32 v58, 16, v109
    v_and_b32 v59, 0xffff0000, v109
    v_pk_add_f32 v[192:193], v[192:193], v[48:49]
    v_pk_add_f32 v[194:195], v[194:195], v[50:51]
    v_pk_add_f32 v[192:193], v[192:193], v[52:53]
    v_pk_add_f32 v[194:195], v[194:195], v[54:55]
    v_pk_add_f32 v[192:193], v[192:193], v[56:57]
    v_pk_add_f32 v[194:195], v[194:195], v[58:59]
    v_cvt_pk_bf16_f32 v192, v192, v193
    v_cvt_pk_bf16_f32 v193, v194, v195
    ds_write_b64 v13, v[192:193] offset:64
    v_lshlrev_b32 v48, 16, v102
    v_and_b32 v49, 0xffff0000, v102
    v_lshlrev_b32 v50, 16, v103
    v_and_b32 v51, 0xffff0000, v103
    v_lshlrev_b32 v52, 16, v106
    v_and_b32 v53, 0xffff0000, v106
    v_lshlrev_b32 v54, 16, v107
    v_and_b32 v55, 0xffff0000, v107
    v_lshlrev_b32 v56, 16, v110
    v_and_b32 v57, 0xffff0000, v110
    v_lshlrev_b32 v58, 16, v111
    v_and_b32 v59, 0xffff0000, v111
    v_pk_add_f32 v[200:201], v[200:201], v[48:49]
    v_pk_add_f32 v[202:203], v[202:203], v[50:51]
    v_pk_add_f32 v[200:201], v[200:201], v[52:53]
    v_pk_add_f32 v[202:203], v[202:203], v[54:55]
    v_pk_add_f32 v[200:201], v[200:201], v[56:57]
    v_pk_add_f32 v[202:203], v[202:203], v[58:59]
    v_cvt_pk_bf16_f32 v200, v200, v201
    v_cvt_pk_bf16_f32 v201, v202, v203
    ds_write_b64 v13, v[200:201] offset:96
    s_waitcnt lgkmcnt(0)
    ds_read_b128 v[64:67], v28
    ds_read_b128 v[68:71], v29
    s_waitcnt lgkmcnt(1)
    buffer_store_dwordx4 v[64:67], v32, s[40:43], s48 offen offset:160 nt
    s_waitcnt lgkmcnt(0)
    buffer_store_dwordx4 v[68:71], v33, s[40:43], s48 offen offset:160 nt
    s_endpgm
P5PROD_m_89:
    s_and_b32 s29, s28, 1
    s_sub_u32 s38, 1, s26
    s_and_b32 s38, s38, 3
    s_cmp_eq_u32 s38, 0
    s_cselect_b32 s39, 6, 7
    s_mov_b32 s40, 0
    s_cmp_le_u32 s38, 0
    s_addc_u32 s40, s40, 0
    s_mov_b32 s41, 1
    s_cmp_le_u32 s38, 1
    s_addc_u32 s41, s41, 0
    s_mov_b32 s42, 2
    s_cmp_le_u32 s38, 2
    s_addc_u32 s42, s42, 0
    s_mov_b32 s43, 3
    s_cmp_le_u32 s38, 3
    s_addc_u32 s43, s43, 0
    s_cmp_le_u32 s38, 0
    s_addc_u32 s43, s43, 0
    s_mov_b32 s44, 4
    s_cmp_le_u32 s38, 4
    s_addc_u32 s44, s44, 0
    s_cmp_le_u32 s38, 1
    s_addc_u32 s44, s44, 0
    s_mov_b32 s45, 5
    s_cmp_le_u32 s38, 5
    s_addc_u32 s45, s45, 0
    s_cmp_le_u32 s38, 2
    s_addc_u32 s45, s45, 0
    s_mov_b32 s46, 6
    s_cmp_le_u32 s38, 6
    s_addc_u32 s46, s46, 0
    s_cmp_le_u32 s38, 3
    s_addc_u32 s46, s46, 0
    s_cmp_le_u32 s38, 0
    s_addc_u32 s46, s46, 0
    s_sub_u32 s30, 6, s39
    s_lshl_b32 s30, s30, 2
    s_add_u32 s30, s30, s38
    s_cmp_le_u32 s39, 6
    s_cselect_b32 s46, s30, s46
    s_mov_b32 s47, 7
    s_cmp_le_u32 s38, 7
    s_addc_u32 s47, s47, 0
    s_cmp_le_u32 s38, 4
    s_addc_u32 s47, s47, 0
    s_cmp_le_u32 s38, 1
    s_addc_u32 s47, s47, 0
    s_sub_u32 s30, 7, s39
    s_lshl_b32 s30, s30, 2
    s_add_u32 s30, s30, s38
    s_cmp_le_u32 s39, 7
    s_cselect_b32 s47, s30, s47
    s_mov_b32 s48, 8
    s_cmp_le_u32 s38, 8
    s_addc_u32 s48, s48, 0
    s_cmp_le_u32 s38, 5
    s_addc_u32 s48, s48, 0
    s_cmp_le_u32 s38, 2
    s_addc_u32 s48, s48, 0
    s_sub_u32 s30, 8, s39
    s_lshl_b32 s30, s30, 2
    s_add_u32 s30, s30, s38
    s_cmp_le_u32 s39, 8
    s_cselect_b32 s48, s30, s48
    s_cmp_ge_u32 s28, 6
    s_cbranch_scc1 P5PA_m_90
    v_add_u32 v5, 0, v3
    v_lshlrev_b32 v6, 1, v5
    v_xor_b32 v6, v6, v4
    v_lshlrev_b32 v6, 4, v6
    v_lshl_add_u32 v10, v5, 12, v6
    v_add_u32 v5, 4, v3
    v_lshlrev_b32 v6, 1, v5
    v_xor_b32 v6, v6, v4
    v_lshlrev_b32 v6, 4, v6
    v_lshl_add_u32 v11, v5, 12, v6
    v_add_u32 v12, 32768, v10
    v_add_u32 v13, 32768, v11
    v_add_u32 v14, 32768, v12
    v_add_u32 v15, 32768, v13
    v_add_u32 v16, 32768, v14
    v_add_u32 v17, 32768, v15
    s_mul_i32 s32, s26, 4718592
    s_lshl_b32 s30, s29, 17
    s_add_u32 s32, s32, s30
    s_lshl_b32 s30, s24, 8
    s_add_u32 s32, s32, s30
    s_lshl_b32 s34, s29, 13
    s_mov_b32 s12, s76
    s_and_b32 s13, s77, 0xffff
    s_mov_b32 s14, 18874368
    s_mov_b32 s15, 0x20000
    s_lshl_b32 s33, s40, 19
    s_add_u32 s33, s33, s32
    s_add_u32 m0, s34, 0
    s_nop 0
    buffer_load_dwordx4 v10, s[12:15], s33 offen lds
    s_add_u32 m0, s34, 1024
    s_nop 0
    buffer_load_dwordx4 v11, s[12:15], s33 offen lds
    s_add_u32 m0, s34, 2048
    s_nop 0
    buffer_load_dwordx4 v12, s[12:15], s33 offen lds
    s_add_u32 m0, s34, 3072
    s_nop 0
    buffer_load_dwordx4 v13, s[12:15], s33 offen lds
    s_add_u32 m0, s34, 4096
    s_nop 0
    buffer_load_dwordx4 v14, s[12:15], s33 offen lds
    s_add_u32 m0, s34, 5120
    s_nop 0
    buffer_load_dwordx4 v15, s[12:15], s33 offen lds
    s_add_u32 m0, s34, 6144
    s_nop 0
    buffer_load_dwordx4 v16, s[12:15], s33 offen lds
    s_add_u32 m0, s34, 7168
    s_nop 0
    buffer_load_dwordx4 v17, s[12:15], s33 offen lds
    s_lshl_b32 s33, s40, 19
    s_add_u32 s33, s33, s32
    s_add_u32 s33, s33, 262144
    s_add_u32 m0, s34, 34816
    s_nop 0
    buffer_load_dwordx4 v10, s[12:15], s33 offen lds
    s_add_u32 m0, s34, 35840
    s_nop 0
    buffer_load_dwordx4 v11, s[12:15], s33 offen lds
    s_add_u32 m0, s34, 36864
    s_nop 0
    buffer_load_dwordx4 v12, s[12:15], s33 offen lds
    s_add_u32 m0, s34, 37888
    s_nop 0
    buffer_load_dwordx4 v13, s[12:15], s33 offen lds
    s_add_u32 m0, s34, 38912
    s_nop 0
    buffer_load_dwordx4 v14, s[12:15], s33 offen lds
    s_add_u32 m0, s34, 39936
    s_nop 0
    buffer_load_dwordx4 v15, s[12:15], s33 offen lds
    s_add_u32 m0, s34, 40960
    s_nop 0
    buffer_load_dwordx4 v16, s[12:15], s33 offen lds
    s_add_u32 m0, s34, 41984
    s_nop 0
    buffer_load_dwordx4 v17, s[12:15], s33 offen lds
    s_waitcnt vmcnt(8)
    s_barrier
    s_lshl_b32 s33, s41, 19
    s_add_u32 s33, s33, s32
    s_add_u32 m0, s34, 69632
    s_nop 0
    buffer_load_dwordx4 v10, s[12:15], s33 offen lds
    s_add_u32 m0, s34, 70656
    s_nop 0
    buffer_load_dwordx4 v11, s[12:15], s33 offen lds
    s_add_u32 m0, s34, 71680
    s_nop 0
    buffer_load_dwordx4 v12, s[12:15], s33 offen lds
    s_add_u32 m0, s34, 72704
    s_nop 0
    buffer_load_dwordx4 v13, s[12:15], s33 offen lds
    s_add_u32 m0, s34, 73728
    s_nop 0
    buffer_load_dwordx4 v14, s[12:15], s33 offen lds
    s_add_u32 m0, s34, 74752
    s_nop 0
    buffer_load_dwordx4 v15, s[12:15], s33 offen lds
    s_add_u32 m0, s34, 75776
    s_nop 0
    buffer_load_dwordx4 v16, s[12:15], s33 offen lds
    s_add_u32 m0, s34, 76800
    s_nop 0
    buffer_load_dwordx4 v17, s[12:15], s33 offen lds
    s_lshl_b32 s33, s41, 19
    s_add_u32 s33, s33, s32
    s_add_u32 s33, s33, 262144
    s_add_u32 m0, s34, 104448
    s_nop 0
    buffer_load_dwordx4 v10, s[12:15], s33 offen lds
    s_add_u32 m0, s34, 105472
    s_nop 0
    buffer_load_dwordx4 v11, s[12:15], s33 offen lds
    s_add_u32 m0, s34, 106496
    s_nop 0
    buffer_load_dwordx4 v12, s[12:15], s33 offen lds
    s_add_u32 m0, s34, 107520
    s_nop 0
    buffer_load_dwordx4 v13, s[12:15], s33 offen lds
    s_add_u32 m0, s34, 108544
    s_nop 0
    buffer_load_dwordx4 v14, s[12:15], s33 offen lds
    s_add_u32 m0, s34, 109568
    s_nop 0
    buffer_load_dwordx4 v15, s[12:15], s33 offen lds
    s_add_u32 m0, s34, 110592
    s_nop 0
    buffer_load_dwordx4 v16, s[12:15], s33 offen lds
    s_add_u32 m0, s34, 111616
    s_nop 0
    buffer_load_dwordx4 v17, s[12:15], s33 offen lds
    s_waitcnt vmcnt(16)
    s_barrier
    s_waitcnt vmcnt(8)
    s_barrier
    s_lshl_b32 s33, s42, 19
    s_add_u32 s33, s33, s32
    s_add_u32 m0, s34, 0
    s_nop 0
    buffer_load_dwordx4 v10, s[12:15], s33 offen lds
    s_add_u32 m0, s34, 1024
    s_nop 0
    buffer_load_dwordx4 v11, s[12:15], s33 offen lds
    s_add_u32 m0, s34, 2048
    s_nop 0
    buffer_load_dwordx4 v12, s[12:15], s33 offen lds
    s_add_u32 m0, s34, 3072
    s_nop 0
    buffer_load_dwordx4 v13, s[12:15], s33 offen lds
    s_add_u32 m0, s34, 4096
    s_nop 0
    buffer_load_dwordx4 v14, s[12:15], s33 offen lds
    s_add_u32 m0, s34, 5120
    s_nop 0
    buffer_load_dwordx4 v15, s[12:15], s33 offen lds
    s_add_u32 m0, s34, 6144
    s_nop 0
    buffer_load_dwordx4 v16, s[12:15], s33 offen lds
    s_add_u32 m0, s34, 7168
    s_nop 0
    buffer_load_dwordx4 v17, s[12:15], s33 offen lds
    s_waitcnt vmcnt(8)
    s_barrier
    s_lshl_b32 s33, s42, 19
    s_add_u32 s33, s33, s32
    s_add_u32 s33, s33, 262144
    s_add_u32 m0, s34, 34816
    s_nop 0
    buffer_load_dwordx4 v10, s[12:15], s33 offen lds
    s_add_u32 m0, s34, 35840
    s_nop 0
    buffer_load_dwordx4 v11, s[12:15], s33 offen lds
    s_add_u32 m0, s34, 36864
    s_nop 0
    buffer_load_dwordx4 v12, s[12:15], s33 offen lds
    s_add_u32 m0, s34, 37888
    s_nop 0
    buffer_load_dwordx4 v13, s[12:15], s33 offen lds
    s_add_u32 m0, s34, 38912
    s_nop 0
    buffer_load_dwordx4 v14, s[12:15], s33 offen lds
    s_add_u32 m0, s34, 39936
    s_nop 0
    buffer_load_dwordx4 v15, s[12:15], s33 offen lds
    s_add_u32 m0, s34, 40960
    s_nop 0
    buffer_load_dwordx4 v16, s[12:15], s33 offen lds
    s_add_u32 m0, s34, 41984
    s_nop 0
    buffer_load_dwordx4 v17, s[12:15], s33 offen lds
    s_waitcnt vmcnt(8)
    s_barrier
    s_lshl_b32 s33, s43, 19
    s_add_u32 s33, s33, s32
    s_add_u32 m0, s34, 69632
    s_nop 0
    buffer_load_dwordx4 v10, s[12:15], s33 offen lds
    s_add_u32 m0, s34, 70656
    s_nop 0
    buffer_load_dwordx4 v11, s[12:15], s33 offen lds
    s_add_u32 m0, s34, 71680
    s_nop 0
    buffer_load_dwordx4 v12, s[12:15], s33 offen lds
    s_add_u32 m0, s34, 72704
    s_nop 0
    buffer_load_dwordx4 v13, s[12:15], s33 offen lds
    s_add_u32 m0, s34, 73728
    s_nop 0
    buffer_load_dwordx4 v14, s[12:15], s33 offen lds
    s_add_u32 m0, s34, 74752
    s_nop 0
    buffer_load_dwordx4 v15, s[12:15], s33 offen lds
    s_add_u32 m0, s34, 75776
    s_nop 0
    buffer_load_dwordx4 v16, s[12:15], s33 offen lds
    s_add_u32 m0, s34, 76800
    s_nop 0
    buffer_load_dwordx4 v17, s[12:15], s33 offen lds
    s_waitcnt vmcnt(8)
    s_barrier
    s_lshl_b32 s33, s43, 19
    s_add_u32 s33, s33, s32
    s_add_u32 s33, s33, 262144
    s_add_u32 m0, s34, 104448
    s_nop 0
    buffer_load_dwordx4 v10, s[12:15], s33 offen lds
    s_add_u32 m0, s34, 105472
    s_nop 0
    buffer_load_dwordx4 v11, s[12:15], s33 offen lds
    s_add_u32 m0, s34, 106496
    s_nop 0
    buffer_load_dwordx4 v12, s[12:15], s33 offen lds
    s_add_u32 m0, s34, 107520
    s_nop 0
    buffer_load_dwordx4 v13, s[12:15], s33 offen lds
    s_add_u32 m0, s34, 108544
    s_nop 0
    buffer_load_dwordx4 v14, s[12:15], s33 offen lds
    s_add_u32 m0, s34, 109568
    s_nop 0
    buffer_load_dwordx4 v15, s[12:15], s33 offen lds
    s_add_u32 m0, s34, 110592
    s_nop 0
    buffer_load_dwordx4 v16, s[12:15], s33 offen lds
    s_add_u32 m0, s34, 111616
    s_nop 0
    buffer_load_dwordx4 v17, s[12:15], s33 offen lds
    s_waitcnt vmcnt(8)
    s_barrier
    s_lshl_b32 s33, s44, 19
    s_add_u32 s33, s33, s32
    s_add_u32 m0, s34, 0
    s_nop 0
    buffer_load_dwordx4 v10, s[12:15], s33 offen lds
    s_add_u32 m0, s34, 1024
    s_nop 0
    buffer_load_dwordx4 v11, s[12:15], s33 offen lds
    s_add_u32 m0, s34, 2048
    s_nop 0
    buffer_load_dwordx4 v12, s[12:15], s33 offen lds
    s_add_u32 m0, s34, 3072
    s_nop 0
    buffer_load_dwordx4 v13, s[12:15], s33 offen lds
    s_add_u32 m0, s34, 4096
    s_nop 0
    buffer_load_dwordx4 v14, s[12:15], s33 offen lds
    s_add_u32 m0, s34, 5120
    s_nop 0
    buffer_load_dwordx4 v15, s[12:15], s33 offen lds
    s_add_u32 m0, s34, 6144
    s_nop 0
    buffer_load_dwordx4 v16, s[12:15], s33 offen lds
    s_add_u32 m0, s34, 7168
    s_nop 0
    buffer_load_dwordx4 v17, s[12:15], s33 offen lds
    s_waitcnt vmcnt(8)
    s_barrier
    s_lshl_b32 s33, s44, 19
    s_add_u32 s33, s33, s32
    s_add_u32 s33, s33, 262144
    s_add_u32 m0, s34, 34816
    s_nop 0
    buffer_load_dwordx4 v10, s[12:15], s33 offen lds
    s_add_u32 m0, s34, 35840
    s_nop 0
    buffer_load_dwordx4 v11, s[12:15], s33 offen lds
    s_add_u32 m0, s34, 36864
    s_nop 0
    buffer_load_dwordx4 v12, s[12:15], s33 offen lds
    s_add_u32 m0, s34, 37888
    s_nop 0
    buffer_load_dwordx4 v13, s[12:15], s33 offen lds
    s_add_u32 m0, s34, 38912
    s_nop 0
    buffer_load_dwordx4 v14, s[12:15], s33 offen lds
    s_add_u32 m0, s34, 39936
    s_nop 0
    buffer_load_dwordx4 v15, s[12:15], s33 offen lds
    s_add_u32 m0, s34, 40960
    s_nop 0
    buffer_load_dwordx4 v16, s[12:15], s33 offen lds
    s_add_u32 m0, s34, 41984
    s_nop 0
    buffer_load_dwordx4 v17, s[12:15], s33 offen lds
    s_waitcnt vmcnt(8)
    s_barrier
    s_lshl_b32 s33, s45, 19
    s_add_u32 s33, s33, s32
    s_add_u32 m0, s34, 69632
    s_nop 0
    buffer_load_dwordx4 v10, s[12:15], s33 offen lds
    s_add_u32 m0, s34, 70656
    s_nop 0
    buffer_load_dwordx4 v11, s[12:15], s33 offen lds
    s_add_u32 m0, s34, 71680
    s_nop 0
    buffer_load_dwordx4 v12, s[12:15], s33 offen lds
    s_add_u32 m0, s34, 72704
    s_nop 0
    buffer_load_dwordx4 v13, s[12:15], s33 offen lds
    s_add_u32 m0, s34, 73728
    s_nop 0
    buffer_load_dwordx4 v14, s[12:15], s33 offen lds
    s_add_u32 m0, s34, 74752
    s_nop 0
    buffer_load_dwordx4 v15, s[12:15], s33 offen lds
    s_add_u32 m0, s34, 75776
    s_nop 0
    buffer_load_dwordx4 v16, s[12:15], s33 offen lds
    s_add_u32 m0, s34, 76800
    s_nop 0
    buffer_load_dwordx4 v17, s[12:15], s33 offen lds
    s_waitcnt vmcnt(8)
    s_barrier
    s_lshl_b32 s33, s45, 19
    s_add_u32 s33, s33, s32
    s_add_u32 s33, s33, 262144
    s_add_u32 m0, s34, 104448
    s_nop 0
    buffer_load_dwordx4 v10, s[12:15], s33 offen lds
    s_add_u32 m0, s34, 105472
    s_nop 0
    buffer_load_dwordx4 v11, s[12:15], s33 offen lds
    s_add_u32 m0, s34, 106496
    s_nop 0
    buffer_load_dwordx4 v12, s[12:15], s33 offen lds
    s_add_u32 m0, s34, 107520
    s_nop 0
    buffer_load_dwordx4 v13, s[12:15], s33 offen lds
    s_add_u32 m0, s34, 108544
    s_nop 0
    buffer_load_dwordx4 v14, s[12:15], s33 offen lds
    s_add_u32 m0, s34, 109568
    s_nop 0
    buffer_load_dwordx4 v15, s[12:15], s33 offen lds
    s_add_u32 m0, s34, 110592
    s_nop 0
    buffer_load_dwordx4 v16, s[12:15], s33 offen lds
    s_add_u32 m0, s34, 111616
    s_nop 0
    buffer_load_dwordx4 v17, s[12:15], s33 offen lds
    s_waitcnt vmcnt(8)
    s_barrier
    s_lshl_b32 s33, s46, 19
    s_add_u32 s33, s33, s32
    s_add_u32 m0, s34, 0
    s_nop 0
    buffer_load_dwordx4 v10, s[12:15], s33 offen lds
    s_add_u32 m0, s34, 1024
    s_nop 0
    buffer_load_dwordx4 v11, s[12:15], s33 offen lds
    s_add_u32 m0, s34, 2048
    s_nop 0
    buffer_load_dwordx4 v12, s[12:15], s33 offen lds
    s_add_u32 m0, s34, 3072
    s_nop 0
    buffer_load_dwordx4 v13, s[12:15], s33 offen lds
    s_add_u32 m0, s34, 4096
    s_nop 0
    buffer_load_dwordx4 v14, s[12:15], s33 offen lds
    s_add_u32 m0, s34, 5120
    s_nop 0
    buffer_load_dwordx4 v15, s[12:15], s33 offen lds
    s_add_u32 m0, s34, 6144
    s_nop 0
    buffer_load_dwordx4 v16, s[12:15], s33 offen lds
    s_add_u32 m0, s34, 7168
    s_nop 0
    buffer_load_dwordx4 v17, s[12:15], s33 offen lds
    s_waitcnt vmcnt(8)
    s_barrier
    s_lshl_b32 s33, s46, 19
    s_add_u32 s33, s33, s32
    s_add_u32 s33, s33, 262144
    s_add_u32 m0, s34, 34816
    s_nop 0
    buffer_load_dwordx4 v10, s[12:15], s33 offen lds
    s_add_u32 m0, s34, 35840
    s_nop 0
    buffer_load_dwordx4 v11, s[12:15], s33 offen lds
    s_add_u32 m0, s34, 36864
    s_nop 0
    buffer_load_dwordx4 v12, s[12:15], s33 offen lds
    s_add_u32 m0, s34, 37888
    s_nop 0
    buffer_load_dwordx4 v13, s[12:15], s33 offen lds
    s_add_u32 m0, s34, 38912
    s_nop 0
    buffer_load_dwordx4 v14, s[12:15], s33 offen lds
    s_add_u32 m0, s34, 39936
    s_nop 0
    buffer_load_dwordx4 v15, s[12:15], s33 offen lds
    s_add_u32 m0, s34, 40960
    s_nop 0
    buffer_load_dwordx4 v16, s[12:15], s33 offen lds
    s_add_u32 m0, s34, 41984
    s_nop 0
    buffer_load_dwordx4 v17, s[12:15], s33 offen lds
    s_waitcnt vmcnt(8)
    s_barrier
    s_lshl_b32 s33, s47, 19
    s_add_u32 s33, s33, s32
    s_add_u32 m0, s34, 69632
    s_nop 0
    buffer_load_dwordx4 v10, s[12:15], s33 offen lds
    s_add_u32 m0, s34, 70656
    s_nop 0
    buffer_load_dwordx4 v11, s[12:15], s33 offen lds
    s_add_u32 m0, s34, 71680
    s_nop 0
    buffer_load_dwordx4 v12, s[12:15], s33 offen lds
    s_add_u32 m0, s34, 72704
    s_nop 0
    buffer_load_dwordx4 v13, s[12:15], s33 offen lds
    s_add_u32 m0, s34, 73728
    s_nop 0
    buffer_load_dwordx4 v14, s[12:15], s33 offen lds
    s_add_u32 m0, s34, 74752
    s_nop 0
    buffer_load_dwordx4 v15, s[12:15], s33 offen lds
    s_add_u32 m0, s34, 75776
    s_nop 0
    buffer_load_dwordx4 v16, s[12:15], s33 offen lds
    s_add_u32 m0, s34, 76800
    s_nop 0
    buffer_load_dwordx4 v17, s[12:15], s33 offen lds
    s_waitcnt vmcnt(8)
    s_barrier
    s_lshl_b32 s33, s47, 19
    s_add_u32 s33, s33, s32
    s_add_u32 s33, s33, 262144
    s_add_u32 m0, s34, 104448
    s_nop 0
    buffer_load_dwordx4 v10, s[12:15], s33 offen lds
    s_add_u32 m0, s34, 105472
    s_nop 0
    buffer_load_dwordx4 v11, s[12:15], s33 offen lds
    s_add_u32 m0, s34, 106496
    s_nop 0
    buffer_load_dwordx4 v12, s[12:15], s33 offen lds
    s_add_u32 m0, s34, 107520
    s_nop 0
    buffer_load_dwordx4 v13, s[12:15], s33 offen lds
    s_add_u32 m0, s34, 108544
    s_nop 0
    buffer_load_dwordx4 v14, s[12:15], s33 offen lds
    s_add_u32 m0, s34, 109568
    s_nop 0
    buffer_load_dwordx4 v15, s[12:15], s33 offen lds
    s_add_u32 m0, s34, 110592
    s_nop 0
    buffer_load_dwordx4 v16, s[12:15], s33 offen lds
    s_add_u32 m0, s34, 111616
    s_nop 0
    buffer_load_dwordx4 v17, s[12:15], s33 offen lds
    s_waitcnt vmcnt(8)
    s_barrier
    s_lshl_b32 s33, s48, 19
    s_add_u32 s33, s33, s32
    s_add_u32 m0, s34, 0
    s_nop 0
    buffer_load_dwordx4 v10, s[12:15], s33 offen lds
    s_add_u32 m0, s34, 1024
    s_nop 0
    buffer_load_dwordx4 v11, s[12:15], s33 offen lds
    s_add_u32 m0, s34, 2048
    s_nop 0
    buffer_load_dwordx4 v12, s[12:15], s33 offen lds
    s_add_u32 m0, s34, 3072
    s_nop 0
    buffer_load_dwordx4 v13, s[12:15], s33 offen lds
    s_add_u32 m0, s34, 4096
    s_nop 0
    buffer_load_dwordx4 v14, s[12:15], s33 offen lds
    s_add_u32 m0, s34, 5120
    s_nop 0
    buffer_load_dwordx4 v15, s[12:15], s33 offen lds
    s_add_u32 m0, s34, 6144
    s_nop 0
    buffer_load_dwordx4 v16, s[12:15], s33 offen lds
    s_add_u32 m0, s34, 7168
    s_nop 0
    buffer_load_dwordx4 v17, s[12:15], s33 offen lds
    s_waitcnt vmcnt(8)
    s_barrier
    s_lshl_b32 s33, s48, 19
    s_add_u32 s33, s33, s32
    s_add_u32 s33, s33, 262144
    s_add_u32 m0, s34, 34816
    s_nop 0
    buffer_load_dwordx4 v10, s[12:15], s33 offen lds
    s_add_u32 m0, s34, 35840
    s_nop 0
    buffer_load_dwordx4 v11, s[12:15], s33 offen lds
    s_add_u32 m0, s34, 36864
    s_nop 0
    buffer_load_dwordx4 v12, s[12:15], s33 offen lds
    s_add_u32 m0, s34, 37888
    s_nop 0
    buffer_load_dwordx4 v13, s[12:15], s33 offen lds
    s_add_u32 m0, s34, 38912
    s_nop 0
    buffer_load_dwordx4 v14, s[12:15], s33 offen lds
    s_add_u32 m0, s34, 39936
    s_nop 0
    buffer_load_dwordx4 v15, s[12:15], s33 offen lds
    s_add_u32 m0, s34, 40960
    s_nop 0
    buffer_load_dwordx4 v16, s[12:15], s33 offen lds
    s_add_u32 m0, s34, 41984
    s_nop 0
    buffer_load_dwordx4 v17, s[12:15], s33 offen lds
    s_waitcnt vmcnt(8)
    s_barrier
    s_waitcnt vmcnt(0)
    s_barrier
    s_branch FIN_m_91
P5PA_m_90:
    v_lshlrev_b32 v10, 4, v1
    v_add_u32 v11, 147456, v10
    v_add_u32 v12, 147456, v11
    v_add_u32 v13, 147456, v12
    v_add_u32 v14, 147456, v13
    v_add_u32 v15, 147456, v14
    v_add_u32 v16, 147456, v15
    v_add_u32 v17, 147456, v16
    v_add_u32 v18, 147456, v17
    s_mul_i32 s33, s25, 1327104
    s_mul_i32 s30, s26, 36864
    s_add_u32 s33, s33, s30
    s_lshl_b32 s30, s29, 10
    s_add_u32 s33, s33, s30
    s_add_u32 s33, s33, 25165824
    s_mul_i32 s35, s29, 9216
    s_add_u32 s35, s35, 16384
    s_mul_i32 s30, s25, 3
    s_lshr_b32 s30, s30, 1
    s_mul_i32 s31, s26, 6
    s_add_u32 s30, s30, s31
    s_mul_i32 s30, s30, 1152
    s_add_u32 s30, s30, 21258240
    v_lshlrev_b32 v5, 7, v1
    s_mov_b32 s49, s30
    s_cmp_eq_u32 s28, 7
    s_cbranch_scc1 W7_m_98
    s_cmp_ge_u32 s2, 216
    s_cbranch_scc1 NG_m_100
    s_mov_b32 s37, 0x400000
LW_m_102:
    v_mov_b32 v20, 160776
    ds_read_b32 v20, v20
    s_waitcnt lgkmcnt(0)
    v_readfirstlane_b32 s31, v20
    s_nop 0
    s_cmp_ge_u32 s31, 5
    s_cbranch_scc1 LG_m_103
    s_sub_u32 s37, s37, 1
    s_cmp_eq_u32 s37, 0
    s_cbranch_scc1 LG_m_103
    s_sleep 1
    s_branch LW_m_102
LG_m_103:
    s_branch NG_m_101
NG_m_100:
    s_lshl_b32 exec_lo, 1, s40
    s_mov_b32 exec_hi, 0
    s_mov_b32 s37, 0x40000
POLL_m_104:
    buffer_load_dword v20, v5, s[20:23], s30 offen sc0 sc1
    s_waitcnt vmcnt(0)
    v_cmp_eq_u32 vcc, 0, v20
    s_sub_u32 s37, s37, 1
    s_cmp_eq_u32 s37, 0
    s_cbranch_scc1 GO_m_105
    s_cbranch_vccz GO_m_105
    s_sleep 8
    s_branch POLL_m_104
GO_m_105:
NG_m_101:
    s_lshl_b32 s31, 1, s40
    s_lshl_b32 s51, 1, s41
    s_or_b32 s31, s31, s51
    s_mul_i32 exec_lo, s31, 0x201
    s_mov_b32 exec_hi, 0
    s_mov_b32 s37, 0x40000
POLL_m_106:
    buffer_load_dword v20, v5, s[20:23], s30 offen sc0 sc1
    s_waitcnt vmcnt(0)
    v_cmp_eq_u32 vcc, 0, v20
    s_sub_u32 s37, s37, 1
    s_cmp_eq_u32 s37, 0
    s_cbranch_scc1 GO_m_107
    s_cbranch_vccz GO_m_107
    s_sleep 1
    s_branch POLL_m_106
GO_m_107:
    s_mov_b64 exec, -1
    v_mov_b32 v20, 160796
    v_mov_b32 v21, 1
    ds_write_b32 v20, v21
    s_branch WD_m_99
W7_m_98:
    s_mov_b32 s37, 0x400000
LW_m_108:
    v_mov_b32 v20, 160796
    ds_read_b32 v20, v20
    s_waitcnt lgkmcnt(0)
    v_readfirstlane_b32 s31, v20
    s_nop 0
    s_cmp_ge_u32 s31, 1
    s_cbranch_scc1 LG_m_109
    s_sub_u32 s37, s37, 1
    s_cmp_eq_u32 s37, 0
    s_cbranch_scc1 LG_m_109
    s_sleep 1
    s_branch LW_m_108
LG_m_109:
WD_m_99:
    s_lshl_b32 s32, s40, 12
    s_add_u32 s32, s32, s33
    s_add_u32 m0, s35, 0
    s_nop 0
    buffer_load_dwordx4 v10, s[20:23], s32 offen sc1 lds
    s_add_u32 m0, s35, 1024
    s_nop 0
    buffer_load_dwordx4 v11, s[20:23], s32 offen sc1 lds
    s_add_u32 m0, s35, 2048
    s_nop 0
    buffer_load_dwordx4 v12, s[20:23], s32 offen sc1 lds
    s_add_u32 m0, s35, 3072
    s_nop 0
    buffer_load_dwordx4 v13, s[20:23], s32 offen sc1 lds
    s_add_u32 m0, s35, 4096
    s_nop 0
    buffer_load_dwordx4 v14, s[20:23], s32 offen sc1 lds
    s_add_u32 m0, s35, 5120
    s_nop 0
    buffer_load_dwordx4 v15, s[20:23], s32 offen sc1 lds
    s_add_u32 m0, s35, 6144
    s_nop 0
    buffer_load_dwordx4 v16, s[20:23], s32 offen sc1 lds
    s_add_u32 m0, s35, 7168
    s_nop 0
    buffer_load_dwordx4 v17, s[20:23], s32 offen sc1 lds
    s_add_u32 m0, s35, 8192
    s_nop 0
    buffer_load_dwordx4 v18, s[20:23], s32 offen sc1 lds
    s_lshl_b32 s32, s40, 12
    s_add_u32 s32, s32, s33
    s_add_u32 s32, s32, 2048
    s_add_u32 m0, s35, 34816
    s_nop 0
    buffer_load_dwordx4 v10, s[20:23], s32 offen sc1 lds
    s_add_u32 m0, s35, 35840
    s_nop 0
    buffer_load_dwordx4 v11, s[20:23], s32 offen sc1 lds
    s_add_u32 m0, s35, 36864
    s_nop 0
    buffer_load_dwordx4 v12, s[20:23], s32 offen sc1 lds
    s_add_u32 m0, s35, 37888
    s_nop 0
    buffer_load_dwordx4 v13, s[20:23], s32 offen sc1 lds
    s_add_u32 m0, s35, 38912
    s_nop 0
    buffer_load_dwordx4 v14, s[20:23], s32 offen sc1 lds
    s_add_u32 m0, s35, 39936
    s_nop 0
    buffer_load_dwordx4 v15, s[20:23], s32 offen sc1 lds
    s_add_u32 m0, s35, 40960
    s_nop 0
    buffer_load_dwordx4 v16, s[20:23], s32 offen sc1 lds
    s_add_u32 m0, s35, 41984
    s_nop 0
    buffer_load_dwordx4 v17, s[20:23], s32 offen sc1 lds
    s_add_u32 m0, s35, 43008
    s_nop 0
    buffer_load_dwordx4 v18, s[20:23], s32 offen sc1 lds
    s_waitcnt vmcnt(9)
    s_barrier
    s_lshl_b32 s32, s41, 12
    s_add_u32 s32, s32, s33
    s_add_u32 m0, s35, 69632
    s_nop 0
    buffer_load_dwordx4 v10, s[20:23], s32 offen sc1 lds
    s_add_u32 m0, s35, 70656
    s_nop 0
    buffer_load_dwordx4 v11, s[20:23], s32 offen sc1 lds
    s_add_u32 m0, s35, 71680
    s_nop 0
    buffer_load_dwordx4 v12, s[20:23], s32 offen sc1 lds
    s_add_u32 m0, s35, 72704
    s_nop 0
    buffer_load_dwordx4 v13, s[20:23], s32 offen sc1 lds
    s_add_u32 m0, s35, 73728
    s_nop 0
    buffer_load_dwordx4 v14, s[20:23], s32 offen sc1 lds
    s_add_u32 m0, s35, 74752
    s_nop 0
    buffer_load_dwordx4 v15, s[20:23], s32 offen sc1 lds
    s_add_u32 m0, s35, 75776
    s_nop 0
    buffer_load_dwordx4 v16, s[20:23], s32 offen sc1 lds
    s_add_u32 m0, s35, 76800
    s_nop 0
    buffer_load_dwordx4 v17, s[20:23], s32 offen sc1 lds
    s_add_u32 m0, s35, 77824
    s_nop 0
    buffer_load_dwordx4 v18, s[20:23], s32 offen sc1 lds
    s_lshl_b32 s32, s41, 12
    s_add_u32 s32, s32, s33
    s_add_u32 s32, s32, 2048
    s_add_u32 m0, s35, 104448
    s_nop 0
    buffer_load_dwordx4 v10, s[20:23], s32 offen sc1 lds
    s_add_u32 m0, s35, 105472
    s_nop 0
    buffer_load_dwordx4 v11, s[20:23], s32 offen sc1 lds
    s_add_u32 m0, s35, 106496
    s_nop 0
    buffer_load_dwordx4 v12, s[20:23], s32 offen sc1 lds
    s_add_u32 m0, s35, 107520
    s_nop 0
    buffer_load_dwordx4 v13, s[20:23], s32 offen sc1 lds
    s_add_u32 m0, s35, 108544
    s_nop 0
    buffer_load_dwordx4 v14, s[20:23], s32 offen sc1 lds
    s_add_u32 m0, s35, 109568
    s_nop 0
    buffer_load_dwordx4 v15, s[20:23], s32 offen sc1 lds
    s_add_u32 m0, s35, 110592
    s_nop 0
    buffer_load_dwordx4 v16, s[20:23], s32 offen sc1 lds
    s_add_u32 m0, s35, 111616
    s_nop 0
    buffer_load_dwordx4 v17, s[20:23], s32 offen sc1 lds
    s_add_u32 m0, s35, 112640
    s_nop 0
    buffer_load_dwordx4 v18, s[20:23], s32 offen sc1 lds
    s_waitcnt vmcnt(18)
    s_barrier
    s_waitcnt vmcnt(9)
    s_barrier
    s_lshl_b32 s31, 0x111, s38
    s_and_b32 s31, s31, 0x1ff
    s_mul_i32 s31, s31, 0x201
    s_andn2_b32 exec_lo, 0x3ffff, s31
    s_mov_b32 exec_hi, 0
    s_mov_b32 s37, 0x40000
POLL_m_110:
    buffer_load_dword v20, v5, s[20:23], s49 offen sc0 sc1
    s_waitcnt vmcnt(0)
    v_cmp_eq_u32 vcc, 0, v20
    s_sub_u32 s37, s37, 1
    s_cmp_eq_u32 s37, 0
    s_cbranch_scc1 GO_m_111
    s_cbranch_vccz GO_m_111
    s_sleep 1
    s_branch POLL_m_110
GO_m_111:
    s_mov_b64 exec, -1
    s_lshl_b32 s32, s42, 12
    s_add_u32 s32, s32, s33
    s_add_u32 m0, s35, 0
    s_nop 0
    buffer_load_dwordx4 v10, s[20:23], s32 offen sc1 lds
    s_add_u32 m0, s35, 1024
    s_nop 0
    buffer_load_dwordx4 v11, s[20:23], s32 offen sc1 lds
    s_add_u32 m0, s35, 2048
    s_nop 0
    buffer_load_dwordx4 v12, s[20:23], s32 offen sc1 lds
    s_add_u32 m0, s35, 3072
    s_nop 0
    buffer_load_dwordx4 v13, s[20:23], s32 offen sc1 lds
    s_add_u32 m0, s35, 4096
    s_nop 0
    buffer_load_dwordx4 v14, s[20:23], s32 offen sc1 lds
    s_add_u32 m0, s35, 5120
    s_nop 0
    buffer_load_dwordx4 v15, s[20:23], s32 offen sc1 lds
    s_add_u32 m0, s35, 6144
    s_nop 0
    buffer_load_dwordx4 v16, s[20:23], s32 offen sc1 lds
    s_add_u32 m0, s35, 7168
    s_nop 0
    buffer_load_dwordx4 v17, s[20:23], s32 offen sc1 lds
    s_add_u32 m0, s35, 8192
    s_nop 0
    buffer_load_dwordx4 v18, s[20:23], s32 offen sc1 lds
    s_waitcnt vmcnt(9)
    s_barrier
    s_lshl_b32 s32, s42, 12
    s_add_u32 s32, s32, s33
    s_add_u32 s32, s32, 2048
    s_add_u32 m0, s35, 34816
    s_nop 0
    buffer_load_dwordx4 v10, s[20:23], s32 offen sc1 lds
    s_add_u32 m0, s35, 35840
    s_nop 0
    buffer_load_dwordx4 v11, s[20:23], s32 offen sc1 lds
    s_add_u32 m0, s35, 36864
    s_nop 0
    buffer_load_dwordx4 v12, s[20:23], s32 offen sc1 lds
    s_add_u32 m0, s35, 37888
    s_nop 0
    buffer_load_dwordx4 v13, s[20:23], s32 offen sc1 lds
    s_add_u32 m0, s35, 38912
    s_nop 0
    buffer_load_dwordx4 v14, s[20:23], s32 offen sc1 lds
    s_add_u32 m0, s35, 39936
    s_nop 0
    buffer_load_dwordx4 v15, s[20:23], s32 offen sc1 lds
    s_add_u32 m0, s35, 40960
    s_nop 0
    buffer_load_dwordx4 v16, s[20:23], s32 offen sc1 lds
    s_add_u32 m0, s35, 41984
    s_nop 0
    buffer_load_dwordx4 v17, s[20:23], s32 offen sc1 lds
    s_add_u32 m0, s35, 43008
    s_nop 0
    buffer_load_dwordx4 v18, s[20:23], s32 offen sc1 lds
    s_waitcnt vmcnt(9)
    s_barrier
    s_lshl_b32 s32, s43, 12
    s_add_u32 s32, s32, s33
    s_add_u32 m0, s35, 69632
    s_nop 0
    buffer_load_dwordx4 v10, s[20:23], s32 offen sc1 lds
    s_add_u32 m0, s35, 70656
    s_nop 0
    buffer_load_dwordx4 v11, s[20:23], s32 offen sc1 lds
    s_add_u32 m0, s35, 71680
    s_nop 0
    buffer_load_dwordx4 v12, s[20:23], s32 offen sc1 lds
    s_add_u32 m0, s35, 72704
    s_nop 0
    buffer_load_dwordx4 v13, s[20:23], s32 offen sc1 lds
    s_add_u32 m0, s35, 73728
    s_nop 0
    buffer_load_dwordx4 v14, s[20:23], s32 offen sc1 lds
    s_add_u32 m0, s35, 74752
    s_nop 0
    buffer_load_dwordx4 v15, s[20:23], s32 offen sc1 lds
    s_add_u32 m0, s35, 75776
    s_nop 0
    buffer_load_dwordx4 v16, s[20:23], s32 offen sc1 lds
    s_add_u32 m0, s35, 76800
    s_nop 0
    buffer_load_dwordx4 v17, s[20:23], s32 offen sc1 lds
    s_add_u32 m0, s35, 77824
    s_nop 0
    buffer_load_dwordx4 v18, s[20:23], s32 offen sc1 lds
    s_waitcnt vmcnt(9)
    s_barrier
    s_lshl_b32 s32, s43, 12
    s_add_u32 s32, s32, s33
    s_add_u32 s32, s32, 2048
    s_add_u32 m0, s35, 104448
    s_nop 0
    buffer_load_dwordx4 v10, s[20:23], s32 offen sc1 lds
    s_add_u32 m0, s35, 105472
    s_nop 0
    buffer_load_dwordx4 v11, s[20:23], s32 offen sc1 lds
    s_add_u32 m0, s35, 106496
    s_nop 0
    buffer_load_dwordx4 v12, s[20:23], s32 offen sc1 lds
    s_add_u32 m0, s35, 107520
    s_nop 0
    buffer_load_dwordx4 v13, s[20:23], s32 offen sc1 lds
    s_add_u32 m0, s35, 108544
    s_nop 0
    buffer_load_dwordx4 v14, s[20:23], s32 offen sc1 lds
    s_add_u32 m0, s35, 109568
    s_nop 0
    buffer_load_dwordx4 v15, s[20:23], s32 offen sc1 lds
    s_add_u32 m0, s35, 110592
    s_nop 0
    buffer_load_dwordx4 v16, s[20:23], s32 offen sc1 lds
    s_add_u32 m0, s35, 111616
    s_nop 0
    buffer_load_dwordx4 v17, s[20:23], s32 offen sc1 lds
    s_add_u32 m0, s35, 112640
    s_nop 0
    buffer_load_dwordx4 v18, s[20:23], s32 offen sc1 lds
    s_waitcnt vmcnt(9)
    s_barrier
    s_lshl_b32 s32, s44, 12
    s_add_u32 s32, s32, s33
    s_add_u32 m0, s35, 0
    s_nop 0
    buffer_load_dwordx4 v10, s[20:23], s32 offen sc1 lds
    s_add_u32 m0, s35, 1024
    s_nop 0
    buffer_load_dwordx4 v11, s[20:23], s32 offen sc1 lds
    s_add_u32 m0, s35, 2048
    s_nop 0
    buffer_load_dwordx4 v12, s[20:23], s32 offen sc1 lds
    s_add_u32 m0, s35, 3072
    s_nop 0
    buffer_load_dwordx4 v13, s[20:23], s32 offen sc1 lds
    s_add_u32 m0, s35, 4096
    s_nop 0
    buffer_load_dwordx4 v14, s[20:23], s32 offen sc1 lds
    s_add_u32 m0, s35, 5120
    s_nop 0
    buffer_load_dwordx4 v15, s[20:23], s32 offen sc1 lds
    s_add_u32 m0, s35, 6144
    s_nop 0
    buffer_load_dwordx4 v16, s[20:23], s32 offen sc1 lds
    s_add_u32 m0, s35, 7168
    s_nop 0
    buffer_load_dwordx4 v17, s[20:23], s32 offen sc1 lds
    s_add_u32 m0, s35, 8192
    s_nop 0
    buffer_load_dwordx4 v18, s[20:23], s32 offen sc1 lds
    s_waitcnt vmcnt(9)
    s_barrier
    s_lshl_b32 s32, s44, 12
    s_add_u32 s32, s32, s33
    s_add_u32 s32, s32, 2048
    s_add_u32 m0, s35, 34816
    s_nop 0
    buffer_load_dwordx4 v10, s[20:23], s32 offen sc1 lds
    s_add_u32 m0, s35, 35840
    s_nop 0
    buffer_load_dwordx4 v11, s[20:23], s32 offen sc1 lds
    s_add_u32 m0, s35, 36864
    s_nop 0
    buffer_load_dwordx4 v12, s[20:23], s32 offen sc1 lds
    s_add_u32 m0, s35, 37888
    s_nop 0
    buffer_load_dwordx4 v13, s[20:23], s32 offen sc1 lds
    s_add_u32 m0, s35, 38912
    s_nop 0
    buffer_load_dwordx4 v14, s[20:23], s32 offen sc1 lds
    s_add_u32 m0, s35, 39936
    s_nop 0
    buffer_load_dwordx4 v15, s[20:23], s32 offen sc1 lds
    s_add_u32 m0, s35, 40960
    s_nop 0
    buffer_load_dwordx4 v16, s[20:23], s32 offen sc1 lds
    s_add_u32 m0, s35, 41984
    s_nop 0
    buffer_load_dwordx4 v17, s[20:23], s32 offen sc1 lds
    s_add_u32 m0, s35, 43008
    s_nop 0
    buffer_load_dwordx4 v18, s[20:23], s32 offen sc1 lds
    s_waitcnt vmcnt(9)
    s_barrier
    s_lshl_b32 s32, s45, 12
    s_add_u32 s32, s32, s33
    s_add_u32 m0, s35, 69632
    s_nop 0
    buffer_load_dwordx4 v10, s[20:23], s32 offen sc1 lds
    s_add_u32 m0, s35, 70656
    s_nop 0
    buffer_load_dwordx4 v11, s[20:23], s32 offen sc1 lds
    s_add_u32 m0, s35, 71680
    s_nop 0
    buffer_load_dwordx4 v12, s[20:23], s32 offen sc1 lds
    s_add_u32 m0, s35, 72704
    s_nop 0
    buffer_load_dwordx4 v13, s[20:23], s32 offen sc1 lds
    s_add_u32 m0, s35, 73728
    s_nop 0
    buffer_load_dwordx4 v14, s[20:23], s32 offen sc1 lds
    s_add_u32 m0, s35, 74752
    s_nop 0
    buffer_load_dwordx4 v15, s[20:23], s32 offen sc1 lds
    s_add_u32 m0, s35, 75776
    s_nop 0
    buffer_load_dwordx4 v16, s[20:23], s32 offen sc1 lds
    s_add_u32 m0, s35, 76800
    s_nop 0
    buffer_load_dwordx4 v17, s[20:23], s32 offen sc1 lds
    s_add_u32 m0, s35, 77824
    s_nop 0
    buffer_load_dwordx4 v18, s[20:23], s32 offen sc1 lds
    s_waitcnt vmcnt(9)
    s_barrier
    s_lshl_b32 s32, s45, 12
    s_add_u32 s32, s32, s33
    s_add_u32 s32, s32, 2048
    s_add_u32 m0, s35, 104448
    s_nop 0
    buffer_load_dwordx4 v10, s[20:23], s32 offen sc1 lds
    s_add_u32 m0, s35, 105472
    s_nop 0
    buffer_load_dwordx4 v11, s[20:23], s32 offen sc1 lds
    s_add_u32 m0, s35, 106496
    s_nop 0
    buffer_load_dwordx4 v12, s[20:23], s32 offen sc1 lds
    s_add_u32 m0, s35, 107520
    s_nop 0
    buffer_load_dwordx4 v13, s[20:23], s32 offen sc1 lds
    s_add_u32 m0, s35, 108544
    s_nop 0
    buffer_load_dwordx4 v14, s[20:23], s32 offen sc1 lds
    s_add_u32 m0, s35, 109568
    s_nop 0
    buffer_load_dwordx4 v15, s[20:23], s32 offen sc1 lds
    s_add_u32 m0, s35, 110592
    s_nop 0
    buffer_load_dwordx4 v16, s[20:23], s32 offen sc1 lds
    s_add_u32 m0, s35, 111616
    s_nop 0
    buffer_load_dwordx4 v17, s[20:23], s32 offen sc1 lds
    s_add_u32 m0, s35, 112640
    s_nop 0
    buffer_load_dwordx4 v18, s[20:23], s32 offen sc1 lds
    s_waitcnt vmcnt(9)
    s_barrier
    s_mov_b64 exec, 0x3ffff
    s_mov_b32 s37, 0x40000
POLL_m_112:
    buffer_load_dword v20, v5, s[20:23], s49 offen sc0 sc1
    s_waitcnt vmcnt(0)
    v_cmp_eq_u32 vcc, 0, v20
    s_sub_u32 s37, s37, 1
    s_cmp_eq_u32 s37, 0
    s_cbranch_scc1 GO_m_113
    s_cbranch_vccz GO_m_113
    s_sleep 1
    s_branch POLL_m_112
GO_m_113:
    s_mov_b64 exec, -1
    s_lshl_b32 s32, s46, 12
    s_add_u32 s32, s32, s33
    s_add_u32 m0, s35, 0
    s_nop 0
    buffer_load_dwordx4 v10, s[20:23], s32 offen sc1 lds
    s_add_u32 m0, s35, 1024
    s_nop 0
    buffer_load_dwordx4 v11, s[20:23], s32 offen sc1 lds
    s_add_u32 m0, s35, 2048
    s_nop 0
    buffer_load_dwordx4 v12, s[20:23], s32 offen sc1 lds
    s_add_u32 m0, s35, 3072
    s_nop 0
    buffer_load_dwordx4 v13, s[20:23], s32 offen sc1 lds
    s_add_u32 m0, s35, 4096
    s_nop 0
    buffer_load_dwordx4 v14, s[20:23], s32 offen sc1 lds
    s_add_u32 m0, s35, 5120
    s_nop 0
    buffer_load_dwordx4 v15, s[20:23], s32 offen sc1 lds
    s_add_u32 m0, s35, 6144
    s_nop 0
    buffer_load_dwordx4 v16, s[20:23], s32 offen sc1 lds
    s_add_u32 m0, s35, 7168
    s_nop 0
    buffer_load_dwordx4 v17, s[20:23], s32 offen sc1 lds
    s_add_u32 m0, s35, 8192
    s_nop 0
    buffer_load_dwordx4 v18, s[20:23], s32 offen sc1 lds
    s_waitcnt vmcnt(9)
    s_barrier
    s_lshl_b32 s32, s46, 12
    s_add_u32 s32, s32, s33
    s_add_u32 s32, s32, 2048
    s_add_u32 m0, s35, 34816
    s_nop 0
    buffer_load_dwordx4 v10, s[20:23], s32 offen sc1 lds
    s_add_u32 m0, s35, 35840
    s_nop 0
    buffer_load_dwordx4 v11, s[20:23], s32 offen sc1 lds
    s_add_u32 m0, s35, 36864
    s_nop 0
    buffer_load_dwordx4 v12, s[20:23], s32 offen sc1 lds
    s_add_u32 m0, s35, 37888
    s_nop 0
    buffer_load_dwordx4 v13, s[20:23], s32 offen sc1 lds
    s_add_u32 m0, s35, 38912
    s_nop 0
    buffer_load_dwordx4 v14, s[20:23], s32 offen sc1 lds
    s_add_u32 m0, s35, 39936
    s_nop 0
    buffer_load_dwordx4 v15, s[20:23], s32 offen sc1 lds
    s_add_u32 m0, s35, 40960
    s_nop 0
    buffer_load_dwordx4 v16, s[20:23], s32 offen sc1 lds
    s_add_u32 m0, s35, 41984
    s_nop 0
    buffer_load_dwordx4 v17, s[20:23], s32 offen sc1 lds
    s_add_u32 m0, s35, 43008
    s_nop 0
    buffer_load_dwordx4 v18, s[20:23], s32 offen sc1 lds
    s_waitcnt vmcnt(9)
    s_barrier
    s_lshl_b32 s32, s47, 12
    s_add_u32 s32, s32, s33
    s_add_u32 m0, s35, 69632
    s_nop 0
    buffer_load_dwordx4 v10, s[20:23], s32 offen sc1 lds
    s_add_u32 m0, s35, 70656
    s_nop 0
    buffer_load_dwordx4 v11, s[20:23], s32 offen sc1 lds
    s_add_u32 m0, s35, 71680
    s_nop 0
    buffer_load_dwordx4 v12, s[20:23], s32 offen sc1 lds
    s_add_u32 m0, s35, 72704
    s_nop 0
    buffer_load_dwordx4 v13, s[20:23], s32 offen sc1 lds
    s_add_u32 m0, s35, 73728
    s_nop 0
    buffer_load_dwordx4 v14, s[20:23], s32 offen sc1 lds
    s_add_u32 m0, s35, 74752
    s_nop 0
    buffer_load_dwordx4 v15, s[20:23], s32 offen sc1 lds
    s_add_u32 m0, s35, 75776
    s_nop 0
    buffer_load_dwordx4 v16, s[20:23], s32 offen sc1 lds
    s_add_u32 m0, s35, 76800
    s_nop 0
    buffer_load_dwordx4 v17, s[20:23], s32 offen sc1 lds
    s_add_u32 m0, s35, 77824
    s_nop 0
    buffer_load_dwordx4 v18, s[20:23], s32 offen sc1 lds
    s_waitcnt vmcnt(9)
    s_barrier
    s_lshl_b32 s32, s47, 12
    s_add_u32 s32, s32, s33
    s_add_u32 s32, s32, 2048
    s_add_u32 m0, s35, 104448
    s_nop 0
    buffer_load_dwordx4 v10, s[20:23], s32 offen sc1 lds
    s_add_u32 m0, s35, 105472
    s_nop 0
    buffer_load_dwordx4 v11, s[20:23], s32 offen sc1 lds
    s_add_u32 m0, s35, 106496
    s_nop 0
    buffer_load_dwordx4 v12, s[20:23], s32 offen sc1 lds
    s_add_u32 m0, s35, 107520
    s_nop 0
    buffer_load_dwordx4 v13, s[20:23], s32 offen sc1 lds
    s_add_u32 m0, s35, 108544
    s_nop 0
    buffer_load_dwordx4 v14, s[20:23], s32 offen sc1 lds
    s_add_u32 m0, s35, 109568
    s_nop 0
    buffer_load_dwordx4 v15, s[20:23], s32 offen sc1 lds
    s_add_u32 m0, s35, 110592
    s_nop 0
    buffer_load_dwordx4 v16, s[20:23], s32 offen sc1 lds
    s_add_u32 m0, s35, 111616
    s_nop 0
    buffer_load_dwordx4 v17, s[20:23], s32 offen sc1 lds
    s_add_u32 m0, s35, 112640
    s_nop 0
    buffer_load_dwordx4 v18, s[20:23], s32 offen sc1 lds
    s_waitcnt vmcnt(9)
    s_barrier
    s_lshl_b32 s32, s48, 12
    s_add_u32 s32, s32, s33
    s_add_u32 m0, s35, 0
    s_nop 0
    buffer_load_dwordx4 v10, s[20:23], s32 offen sc1 lds
    s_add_u32 m0, s35, 1024
    s_nop 0
    buffer_load_dwordx4 v11, s[20:23], s32 offen sc1 lds
    s_add_u32 m0, s35, 2048
    s_nop 0
    buffer_load_dwordx4 v12, s[20:23], s32 offen sc1 lds
    s_add_u32 m0, s35, 3072
    s_nop 0
    buffer_load_dwordx4 v13, s[20:23], s32 offen sc1 lds
    s_add_u32 m0, s35, 4096
    s_nop 0
    buffer_load_dwordx4 v14, s[20:23], s32 offen sc1 lds
    s_add_u32 m0, s35, 5120
    s_nop 0
    buffer_load_dwordx4 v15, s[20:23], s32 offen sc1 lds
    s_add_u32 m0, s35, 6144
    s_nop 0
    buffer_load_dwordx4 v16, s[20:23], s32 offen sc1 lds
    s_add_u32 m0, s35, 7168
    s_nop 0
    buffer_load_dwordx4 v17, s[20:23], s32 offen sc1 lds
    s_add_u32 m0, s35, 8192
    s_nop 0
    buffer_load_dwordx4 v18, s[20:23], s32 offen sc1 lds
    s_waitcnt vmcnt(9)
    s_barrier
    s_lshl_b32 s32, s48, 12
    s_add_u32 s32, s32, s33
    s_add_u32 s32, s32, 2048
    s_add_u32 m0, s35, 34816
    s_nop 0
    buffer_load_dwordx4 v10, s[20:23], s32 offen sc1 lds
    s_add_u32 m0, s35, 35840
    s_nop 0
    buffer_load_dwordx4 v11, s[20:23], s32 offen sc1 lds
    s_add_u32 m0, s35, 36864
    s_nop 0
    buffer_load_dwordx4 v12, s[20:23], s32 offen sc1 lds
    s_add_u32 m0, s35, 37888
    s_nop 0
    buffer_load_dwordx4 v13, s[20:23], s32 offen sc1 lds
    s_add_u32 m0, s35, 38912
    s_nop 0
    buffer_load_dwordx4 v14, s[20:23], s32 offen sc1 lds
    s_add_u32 m0, s35, 39936
    s_nop 0
    buffer_load_dwordx4 v15, s[20:23], s32 offen sc1 lds
    s_add_u32 m0, s35, 40960
    s_nop 0
    buffer_load_dwordx4 v16, s[20:23], s32 offen sc1 lds
    s_add_u32 m0, s35, 41984
    s_nop 0
    buffer_load_dwordx4 v17, s[20:23], s32 offen sc1 lds
    s_add_u32 m0, s35, 43008
    s_nop 0
    buffer_load_dwordx4 v18, s[20:23], s32 offen sc1 lds
    s_waitcnt vmcnt(9)
    s_barrier
    s_waitcnt vmcnt(0)
    s_barrier
    s_branch FIN_m_91
FIN_m_91:
    s_endpgm
END_m_1:
    s_endpgm
L_text_end:
.section .rodata,"a"
.p2align 6
.amdhsa_kernel sequential_preLN__sliding_block__mixer_token_mlp__prompt_kernel
  .amdhsa_next_free_vgpr 244
  .amdhsa_next_free_sgpr 95
  .amdhsa_accum_offset 244
  .amdhsa_group_segment_fixed_size 0
  .amdhsa_kernarg_size 88
  .amdhsa_user_sgpr_count 2
  .amdhsa_user_sgpr_kernarg_segment_ptr 1
  .amdhsa_system_sgpr_workgroup_id_x 1
.end_amdhsa_kernel
```
